```python
import torch

def _softmax(x, axis=-1):
    return torch.softmax(x, dim=axis)
def _gelu(x):
    return torch.nn.functional.gelu(x, approximate="tanh")
def _silu(x):
    return torch.nn.functional.silu(x)
def _sigmoid(x):
    return torch.sigmoid(x)
def _layernorm(x, axis=-1, eps=1e-5):
    m = x.mean(dim=axis, keepdim=True)
    v = x.var(dim=axis, keepdim=True, unbiased=False)
    return (x - m) / torch.sqrt(v + eps)
def _scatter_add(tgt, idx, src, axis=0):
    return tgt.clone().index_add_(axis, idx, src)
def _segment_sum(src, seg, n):
    out = torch.zeros((n,) + src.shape[1:], dtype=src.dtype)
    return out.index_add_(0, seg, src)
def _pad(x, pw):
    flat = tuple(v for pair in reversed(pw) for v in pair)
    return torch.nn.functional.pad(x, flat)

kernel_name = 'interleave_layers__ssm_conv_h3__glu_gated_swiglu__prompt'

def setup_inputs():

    _w = (lambda a: (lambda t: t.to(torch.bfloat16) if t.is_floating_point() else t)(torch.as_tensor(a)))
    def _A_setup():
        B, S, D = 1, 2048, 576
        ks = 4
        return {
            "q": _w((lambda *s: torch.randn(*s, dtype=torch.bfloat16) * 0.05)(B, S, D)),
            "k": _w((lambda *s: torch.randn(*s, dtype=torch.bfloat16) * 0.2)(B, S, D)),
            "v": _w((lambda *s: torch.randn(*s, dtype=torch.bfloat16) * 0.2)(B, S, D)),
            "shift_k": _w((lambda *s: torch.randn(*s, dtype=torch.bfloat16) * 0.2)(D, ks) * 0.5),
            "ssm_k": _w((lambda *s: torch.randn(*s, dtype=torch.bfloat16) * 0.4)(D, S) * (1.0 / S ** 0.5)),
            "ssm_D": _w((lambda *s: torch.randn(*s, dtype=torch.bfloat16) * 0.2)(D)),
        }
    _A_in = _A_setup()

    def _B_setup():
        B, S, D, F = 1, 2048, 576, 4608
        return {
            "x": _w((lambda *s: torch.randn(*s, dtype=torch.bfloat16) * 0.05)(B, S, D)),
            "w1": _w((lambda *s: torch.randn(*s, dtype=torch.bfloat16) * 0.2)(D, F) * (2.0 / D) ** 0.5),
            "w3": _w((lambda *s: torch.randn(*s, dtype=torch.bfloat16) * 0.2)(D, F) * (2.0 / D) ** 0.5),
            "w2": _w((lambda *s: torch.randn(*s, dtype=torch.bfloat16) * 0.2)(F, D) * (2.0 / F) ** 0.5),
        }
    _B_in = _B_setup()

    return {
        "A_q": _A_in["q"],
        "A_k": _A_in["k"],
        "A_v": _A_in["v"],
        "A_shift_k": _A_in["shift_k"],
        "A_ssm_k": _A_in["ssm_k"],
        "A_ssm_D": _A_in["ssm_D"],
        "B_x": _B_in["x"],
        "B_w1": _B_in["w1"],
        "B_w3": _B_in["w3"],
        "B_w2": _B_in["w2"],
    }

def reference(A_q, A_k, A_v, A_shift_k, A_ssm_k, A_ssm_D, B_x, B_w1, B_w3, B_w2):
    def _A_ref(q, k, v, shift_k, ssm_k, ssm_D):
        B, S, D = q.shape
        ks = shift_k.shape[-1]
        k_pad = _pad(k, ((0, 0), (ks - 1, 0), (0, 0)))
        k_shift = torch.zeros_like(k)
        for t in range(ks):
            k_shift = k_shift + k_pad[:, t:t + S, :] * shift_k[:, ks - 1 - t][None, None, :]
        kv = k_shift * v
        L = 2 * S
        kv_pad = _pad(kv, ((0, 0), (0, S), (0, 0)))
        kf_pad = _pad(ssm_k, ((0, 0), (0, S)))
        kv_f = (lambda x, axes=(-2,-1): torch.fft.rfft2(x.float(), dim=axes))(kv_pad[:, None, :, :], axes=(1, 2))
        kf_f = (lambda x, axes=(-2,-1): torch.fft.rfft2(x.float(), dim=axes))(kf_pad[:, None, :], axes=(1, 2))
        kf_f = (lambda x, *d: x.permute(*d))(kf_f, 1, 2, 0)
        y_f = kv_f * kf_f[None, :, :, :]
        y = (lambda x, s, axes=(-2,-1): torch.fft.irfft2(x, s=s, dim=axes).to(torch.bfloat16))(y_f, (1, L), axes=(1, 2))[:, 0, :S, :]
        y = y + kv * ssm_D[None, None, :]
        return q * y

    def _B_ref(x, w1, w3, w2):
        gate = torch.einsum("bsd,df->bsf", x, w1)
        up = torch.einsum("bsd,df->bsf", x, w3)
        h = _silu(gate) * up
        out = torch.einsum("bsf,fd->bsd", h, w2)
        return out

    x = A_q
    x = x + _A_ref(_layernorm(x, axis=-1), A_k, A_v, A_shift_k, A_ssm_k, A_ssm_D)
    x = x + _B_ref(_layernorm(x, axis=-1), B_w1, B_w3, B_w2)
    x = x + _A_ref(_layernorm(x, axis=-1), A_k, A_v, A_shift_k, A_ssm_k, A_ssm_D)
    x = x + _B_ref(_layernorm(x, axis=-1), B_w1, B_w3, B_w2)
    return x
```

```asm
; @launch kernel=conv_kernel grid=(1008,1,1) block=(256,1,1) lds=123904
; @launch kernel=rowa_kernel grid=(512,1,1) block=(64,1,1) lds=0
; @launch kernel=gemm1_kernel grid=(256,1,1) block=(512,1,1) lds=147456
; @launch kernel=gemm2_kernel grid=(256,1,1) block=(512,1,1) lds=147456
; @launch kernel=rowb_kernel grid=(128,1,1) block=(256,1,1) lds=4096
; @launch kernel=gemm1_kernel grid=(256,1,1) block=(512,1,1) lds=147456
; @launch kernel=gemm2_kernel grid=(256,1,1) block=(512,1,1) lds=147456
; @launch kernel=rowc_kernel grid=(128,1,1) block=(256,1,1) lds=4096
.amdgcn_target "amdgcn-amd-amdhsa--gfx950"
.text
.globl conv_kernel
.p2align 8
.type conv_kernel,@function
conv_kernel:
    s_cmp_ge_u32 s2, 1008
    s_cbranch_scc1 conv_kernel_done
    s_cmp_ge_u32 s2, 144
    s_cbranch_scc1 prep_path
    s_load_dwordx4 s[4:7], s[0:1], 8
    s_load_dwordx4 s[8:11], s[0:1], 24
    s_load_dwordx2 s[12:13], s[0:1], 40
    s_load_dwordx2 s[14:15], s[0:1], 96
    s_mov_b32 s40, 0xffff0000
    s_mov_b32 s41, 0xffff
    s_waitcnt lgkmcnt(0)
    s_lshl_b32 s3, s2, 5
    s_add_u32 s16, s8, s3
    s_addc_u32 s17, s9, 0
    s_load_dwordx8 s[44:51], s[16:17], 0
    s_lshl_b32 s3, s2, 3
    s_add_u32 s16, s12, s3
    s_addc_u32 s17, s13, 0
    s_load_dwordx2 s[52:53], s[16:17], 0
    s_mov_b32 s20, s4
    s_mov_b32 s21, s5
    s_mov_b32 s22, 0x240000
    s_mov_b32 s23, 0x00020000
    s_mov_b32 s24, s6
    s_mov_b32 s25, s7
    s_mov_b32 s26, 0x240000
    s_mov_b32 s27, 0x00020000
    s_mov_b32 s32, s14
    s_mov_b32 s33, s15
    s_mov_b32 s34, 0x240000
    s_mov_b32 s35, 0x00020000
    v_lshrrev_b32 v1, 6, v0
    s_nop 0
    v_readfirstlane_b32 s42, v1
    s_nop 3
    s_lshl_b32 s3, s2, 2
    s_add_u32 s3, s3, s42
    s_lshl_b32 s3, s3, 12
    s_add_u32 s28, s10, s3
    s_addc_u32 s29, s11, 0
    s_mov_b32 s30, 4096
    s_mov_b32 s31, 0x00020000
    v_and_b32 v2, 63, v0
    v_lshlrev_b32 v3, 4, v2
    v_sub_u32 v3, 4080, v3
    buffer_load_dwordx4 v[100:103], v3, s[28:31], 0 offen
    buffer_load_dwordx2 v[104:105], v3, s[28:31], 0 offen offset:16
    v_subrev_u32 v4, 1024, v3
    buffer_load_dwordx4 v[106:109], v4, s[28:31], 0 offen
    buffer_load_dwordx2 v[110:111], v4, s[28:31], 0 offen offset:16
    v_subrev_u32 v4, 2048, v3
    buffer_load_dwordx4 v[112:115], v4, s[28:31], 0 offen
    buffer_load_dwordx2 v[116:117], v4, s[28:31], 0 offen offset:16
    v_subrev_u32 v4, 3072, v3
    buffer_load_dwordx4 v[118:121], v4, s[28:31], 0 offen
    buffer_load_dwordx2 v[122:123], v4, s[28:31], 0 offen offset:16
    v_subrev_u32 v4, 4096, v3
    buffer_load_dwordx4 v[124:127], v4, s[28:31], 0 offen
    buffer_load_dwordx2 v[128:129], v4, s[28:31], 0 offen offset:16
    s_movk_i32 s43, 1152
    v_lshlrev_b32 v5, 3, v0
    v_subrev_u32 v5, 3, v5
    v_mul_lo_u32 v5, v5, s43
    s_lshl_b32 s3, s2, 3
    v_add_u32 v5, s3, v5
    buffer_load_dwordx2 v[130:131], v5, s[20:23], 0 offen
    v_add_u32 v6, 1152, v5
    buffer_load_dwordx2 v[132:133], v6, s[20:23], 0 offen
    v_add_u32 v6, 2304, v5
    buffer_load_dwordx2 v[134:135], v6, s[20:23], 0 offen
    v_add_u32 v6, 3456, v5
    buffer_load_dwordx2 v[136:137], v6, s[20:23], 0 offen
    v_add_u32 v6, 4608, v5
    buffer_load_dwordx2 v[138:139], v6, s[20:23], 0 offen
    v_add_u32 v6, 5760, v5
    buffer_load_dwordx2 v[140:141], v6, s[20:23], 0 offen
    v_add_u32 v6, 6912, v5
    buffer_load_dwordx2 v[142:143], v6, s[20:23], 0 offen
    v_add_u32 v6, 8064, v5
    buffer_load_dwordx2 v[144:145], v6, s[20:23], 0 offen
    v_add_u32 v6, 9216, v5
    buffer_load_dwordx2 v[146:147], v6, s[20:23], 0 offen
    v_add_u32 v6, 10368, v5
    buffer_load_dwordx2 v[148:149], v6, s[20:23], 0 offen
    v_add_u32 v6, 11520, v5
    buffer_load_dwordx2 v[150:151], v6, s[20:23], 0 offen
    v_add_u32 v6, 3456, v5
    buffer_load_dwordx2 v[152:153], v6, s[24:27], 0 offen
    v_add_u32 v6, 4608, v5
    buffer_load_dwordx2 v[154:155], v6, s[24:27], 0 offen
    v_add_u32 v6, 5760, v5
    buffer_load_dwordx2 v[156:157], v6, s[24:27], 0 offen
    v_add_u32 v6, 6912, v5
    buffer_load_dwordx2 v[158:159], v6, s[24:27], 0 offen
    v_add_u32 v6, 8064, v5
    buffer_load_dwordx2 v[160:161], v6, s[24:27], 0 offen
    v_add_u32 v6, 9216, v5
    buffer_load_dwordx2 v[162:163], v6, s[24:27], 0 offen
    v_add_u32 v6, 10368, v5
    buffer_load_dwordx2 v[164:165], v6, s[24:27], 0 offen
    v_add_u32 v6, 11520, v5
    buffer_load_dwordx2 v[166:167], v6, s[24:27], 0 offen
    v_mov_b32 v8, 0
    v_mov_b32 v9, 0
    v_mov_b32 v10, 0
    v_mov_b32 v11, 0
    v_lshrrev_b32 v12, 6, v0
    s_movk_i32 s3, 10240
    v_mul_lo_u32 v12, v12, s3
    v_lshl_add_u32 v12, v2, 4, v12
    ds_write_b128 v12, v[8:11] offset:0
    ds_write_b128 v12, v[8:11] offset:1024
    ds_write_b128 v12, v[8:11] offset:2048
    ds_write_b128 v12, v[8:11] offset:3072
    ds_write_b128 v12, v[8:11] offset:4096
    s_waitcnt lgkmcnt(0)
    s_lshl_b32 s56, s44, 16
    s_and_b32 s57, s44, s40
    s_lshl_b32 s58, s45, 16
    s_and_b32 s59, s45, s40
    s_lshl_b32 s60, s46, 16
    s_and_b32 s61, s46, s40
    s_lshl_b32 s62, s47, 16
    s_and_b32 s63, s47, s40
    s_lshl_b32 s64, s48, 16
    s_and_b32 s65, s48, s40
    s_lshl_b32 s66, s49, 16
    s_and_b32 s67, s49, s40
    s_lshl_b32 s68, s50, 16
    s_and_b32 s69, s50, s40
    s_lshl_b32 s70, s51, 16
    s_and_b32 s71, s51, s40
    s_lshl_b32 s72, s52, 16
    s_and_b32 s73, s52, s40
    s_lshl_b32 s74, s53, 16
    s_and_b32 s75, s53, s40
    s_waitcnt vmcnt(19)
    s_movk_i32 s3, 20736
    s_mul_i32 s3, s3, s42
    v_lshlrev_b32 v13, 4, v2
    v_add_u32 v13, s3, v13
    v_alignbit_b32 v14, v105, v105, 16
    v_alignbit_b32 v15, v104, v104, 16
    v_alignbit_b32 v16, v103, v103, 16
    v_alignbit_b32 v17, v102, v102, 16
    v_bfi_b32 v18, s41, v105, v104
    v_bfi_b32 v19, s41, v104, v103
    v_bfi_b32 v20, s41, v103, v102
    v_bfi_b32 v21, s41, v102, v101
    v_alignbit_b32 v22, v104, v104, 16
    v_alignbit_b32 v23, v103, v103, 16
    v_alignbit_b32 v24, v102, v102, 16
    v_alignbit_b32 v25, v101, v101, 16
    v_bfi_b32 v26, s41, v104, v103
    v_bfi_b32 v27, s41, v103, v102
    v_bfi_b32 v28, s41, v102, v101
    v_bfi_b32 v29, s41, v101, v100
    ds_write_b128 v13, v[14:17] offset:40960
    ds_write_b128 v13, v[18:21] offset:46144
    ds_write_b128 v13, v[22:25] offset:51328
    ds_write_b128 v13, v[26:29] offset:56512
    v_alignbit_b32 v14, v111, v111, 16
    v_alignbit_b32 v15, v110, v110, 16
    v_alignbit_b32 v16, v109, v109, 16
    v_alignbit_b32 v17, v108, v108, 16
    v_bfi_b32 v18, s41, v111, v110
    v_bfi_b32 v19, s41, v110, v109
    v_bfi_b32 v20, s41, v109, v108
    v_bfi_b32 v21, s41, v108, v107
    v_alignbit_b32 v22, v110, v110, 16
    v_alignbit_b32 v23, v109, v109, 16
    v_alignbit_b32 v24, v108, v108, 16
    v_alignbit_b32 v25, v107, v107, 16
    v_bfi_b32 v26, s41, v110, v109
    v_bfi_b32 v27, s41, v109, v108
    v_bfi_b32 v28, s41, v108, v107
    v_bfi_b32 v29, s41, v107, v106
    ds_write_b128 v13, v[14:17] offset:41984
    ds_write_b128 v13, v[18:21] offset:47168
    ds_write_b128 v13, v[22:25] offset:52352
    ds_write_b128 v13, v[26:29] offset:57536
    v_alignbit_b32 v14, v117, v117, 16
    v_alignbit_b32 v15, v116, v116, 16
    v_alignbit_b32 v16, v115, v115, 16
    v_alignbit_b32 v17, v114, v114, 16
    v_bfi_b32 v18, s41, v117, v116
    v_bfi_b32 v19, s41, v116, v115
    v_bfi_b32 v20, s41, v115, v114
    v_bfi_b32 v21, s41, v114, v113
    v_alignbit_b32 v22, v116, v116, 16
    v_alignbit_b32 v23, v115, v115, 16
    v_alignbit_b32 v24, v114, v114, 16
    v_alignbit_b32 v25, v113, v113, 16
    v_bfi_b32 v26, s41, v116, v115
    v_bfi_b32 v27, s41, v115, v114
    v_bfi_b32 v28, s41, v114, v113
    v_bfi_b32 v29, s41, v113, v112
    ds_write_b128 v13, v[14:17] offset:43008
    ds_write_b128 v13, v[18:21] offset:48192
    ds_write_b128 v13, v[22:25] offset:53376
    ds_write_b128 v13, v[26:29] offset:58560
    v_alignbit_b32 v14, v123, v123, 16
    v_alignbit_b32 v15, v122, v122, 16
    v_alignbit_b32 v16, v121, v121, 16
    v_alignbit_b32 v17, v120, v120, 16
    v_bfi_b32 v18, s41, v123, v122
    v_bfi_b32 v19, s41, v122, v121
    v_bfi_b32 v20, s41, v121, v120
    v_bfi_b32 v21, s41, v120, v119
    v_alignbit_b32 v22, v122, v122, 16
    v_alignbit_b32 v23, v121, v121, 16
    v_alignbit_b32 v24, v120, v120, 16
    v_alignbit_b32 v25, v119, v119, 16
    v_bfi_b32 v26, s41, v122, v121
    v_bfi_b32 v27, s41, v121, v120
    v_bfi_b32 v28, s41, v120, v119
    v_bfi_b32 v29, s41, v119, v118
    ds_write_b128 v13, v[14:17] offset:44032
    ds_write_b128 v13, v[18:21] offset:49216
    ds_write_b128 v13, v[22:25] offset:54400
    ds_write_b128 v13, v[26:29] offset:59584
    v_alignbit_b32 v14, v129, v129, 16
    v_alignbit_b32 v15, v128, v128, 16
    v_alignbit_b32 v16, v127, v127, 16
    v_alignbit_b32 v17, v126, v126, 16
    v_bfi_b32 v18, s41, v129, v128
    v_bfi_b32 v19, s41, v128, v127
    v_bfi_b32 v20, s41, v127, v126
    v_bfi_b32 v21, s41, v126, v125
    v_alignbit_b32 v22, v128, v128, 16
    v_alignbit_b32 v23, v127, v127, 16
    v_alignbit_b32 v24, v126, v126, 16
    v_alignbit_b32 v25, v125, v125, 16
    v_bfi_b32 v26, s41, v128, v127
    v_bfi_b32 v27, s41, v127, v126
    v_bfi_b32 v28, s41, v126, v125
    v_bfi_b32 v29, s41, v125, v124
    ds_write_b128 v13, v[14:17] offset:45056
    ds_write_b128 v13, v[18:21] offset:50240
    ds_write_b128 v13, v[22:25] offset:55424
    ds_write_b128 v13, v[26:29] offset:60608
    s_waitcnt vmcnt(0)
    v_lshlrev_b32 v30, 16, v130
    v_and_b32 v31, s40, v130
    v_lshlrev_b32 v32, 16, v131
    v_and_b32 v33, s40, v131
    v_lshlrev_b32 v34, 16, v132
    v_and_b32 v35, s40, v132
    v_lshlrev_b32 v36, 16, v133
    v_and_b32 v37, s40, v133
    v_lshlrev_b32 v38, 16, v134
    v_and_b32 v39, s40, v134
    v_lshlrev_b32 v40, 16, v135
    v_and_b32 v41, s40, v135
    v_lshlrev_b32 v42, 16, v136
    v_and_b32 v43, s40, v136
    v_lshlrev_b32 v44, 16, v137
    v_and_b32 v45, s40, v137
    v_lshlrev_b32 v46, 16, v138
    v_and_b32 v47, s40, v138
    v_lshlrev_b32 v48, 16, v139
    v_and_b32 v49, s40, v139
    v_lshlrev_b32 v50, 16, v140
    v_and_b32 v51, s40, v140
    v_lshlrev_b32 v52, 16, v141
    v_and_b32 v53, s40, v141
    v_lshlrev_b32 v54, 16, v142
    v_and_b32 v55, s40, v142
    v_lshlrev_b32 v56, 16, v143
    v_and_b32 v57, s40, v143
    v_lshlrev_b32 v58, 16, v144
    v_and_b32 v59, s40, v144
    v_lshlrev_b32 v60, 16, v145
    v_and_b32 v61, s40, v145
    v_lshlrev_b32 v62, 16, v146
    v_and_b32 v63, s40, v146
    v_lshlrev_b32 v64, 16, v147
    v_and_b32 v65, s40, v147
    v_lshlrev_b32 v66, 16, v148
    v_and_b32 v67, s40, v148
    v_lshlrev_b32 v68, 16, v149
    v_and_b32 v69, s40, v149
    v_lshlrev_b32 v70, 16, v150
    v_and_b32 v71, s40, v150
    v_lshlrev_b32 v72, 16, v151
    v_and_b32 v73, s40, v151
    v_lshrrev_b32 v12, 2, v0
    v_mul_u32_u24 v12, 80, v12
    v_and_b32 v13, 3, v0
    v_lshl_add_u32 v12, v13, 4, v12
    v_mul_f32 v80, s59, v30
    v_mul_f32 v81, s59, v34
    v_cvt_pk_bf16_f32 v84, v80, v81
    v_lshlrev_b32 v80, 16, v84
    v_and_b32 v81, s40, v84
    v_mul_f32 v82, s58, v34
    v_mul_f32 v83, s58, v38
    v_cvt_pk_bf16_f32 v84, v82, v83
    v_lshlrev_b32 v82, 16, v84
    v_and_b32 v83, s40, v84
    v_add_f32 v80, v80, v82
    v_add_f32 v81, v81, v83
    v_cvt_pk_bf16_f32 v84, v80, v81
    v_lshlrev_b32 v80, 16, v84
    v_and_b32 v81, s40, v84
    v_mul_f32 v82, s57, v38
    v_mul_f32 v83, s57, v42
    v_cvt_pk_bf16_f32 v84, v82, v83
    v_lshlrev_b32 v82, 16, v84
    v_and_b32 v83, s40, v84
    v_add_f32 v80, v80, v82
    v_add_f32 v81, v81, v83
    v_cvt_pk_bf16_f32 v84, v80, v81
    v_lshlrev_b32 v80, 16, v84
    v_and_b32 v81, s40, v84
    v_mul_f32 v82, s56, v42
    v_mul_f32 v83, s56, v46
    v_cvt_pk_bf16_f32 v84, v82, v83
    v_lshlrev_b32 v82, 16, v84
    v_and_b32 v83, s40, v84
    v_add_f32 v80, v80, v82
    v_add_f32 v81, v81, v83
    v_cvt_pk_bf16_f32 v84, v80, v81
    v_lshlrev_b32 v80, 16, v84
    v_and_b32 v81, s40, v84
    v_lshlrev_b32 v82, 16, v152
    v_lshlrev_b32 v83, 16, v154
    v_mul_f32 v80, v80, v82
    v_mul_f32 v81, v81, v83
    v_cvt_pk_bf16_f32 v88, v80, v81
    v_mul_f32 v80, s59, v38
    v_mul_f32 v81, s59, v42
    v_cvt_pk_bf16_f32 v84, v80, v81
    v_lshlrev_b32 v80, 16, v84
    v_and_b32 v81, s40, v84
    v_mul_f32 v82, s58, v42
    v_mul_f32 v83, s58, v46
    v_cvt_pk_bf16_f32 v84, v82, v83
    v_lshlrev_b32 v82, 16, v84
    v_and_b32 v83, s40, v84
    v_add_f32 v80, v80, v82
    v_add_f32 v81, v81, v83
    v_cvt_pk_bf16_f32 v84, v80, v81
    v_lshlrev_b32 v80, 16, v84
    v_and_b32 v81, s40, v84
    v_mul_f32 v82, s57, v46
    v_mul_f32 v83, s57, v50
    v_cvt_pk_bf16_f32 v84, v82, v83
    v_lshlrev_b32 v82, 16, v84
    v_and_b32 v83, s40, v84
    v_add_f32 v80, v80, v82
    v_add_f32 v81, v81, v83
    v_cvt_pk_bf16_f32 v84, v80, v81
    v_lshlrev_b32 v80, 16, v84
    v_and_b32 v81, s40, v84
    v_mul_f32 v82, s56, v50
    v_mul_f32 v83, s56, v54
    v_cvt_pk_bf16_f32 v84, v82, v83
    v_lshlrev_b32 v82, 16, v84
    v_and_b32 v83, s40, v84
    v_add_f32 v80, v80, v82
    v_add_f32 v81, v81, v83
    v_cvt_pk_bf16_f32 v84, v80, v81
    v_lshlrev_b32 v80, 16, v84
    v_and_b32 v81, s40, v84
    v_lshlrev_b32 v82, 16, v156
    v_lshlrev_b32 v83, 16, v158
    v_mul_f32 v80, v80, v82
    v_mul_f32 v81, v81, v83
    v_cvt_pk_bf16_f32 v89, v80, v81
    v_mul_f32 v80, s59, v46
    v_mul_f32 v81, s59, v50
    v_cvt_pk_bf16_f32 v84, v80, v81
    v_lshlrev_b32 v80, 16, v84
    v_and_b32 v81, s40, v84
    v_mul_f32 v82, s58, v50
    v_mul_f32 v83, s58, v54
    v_cvt_pk_bf16_f32 v84, v82, v83
    v_lshlrev_b32 v82, 16, v84
    v_and_b32 v83, s40, v84
    v_add_f32 v80, v80, v82
    v_add_f32 v81, v81, v83
    v_cvt_pk_bf16_f32 v84, v80, v81
    v_lshlrev_b32 v80, 16, v84
    v_and_b32 v81, s40, v84
    v_mul_f32 v82, s57, v54
    v_mul_f32 v83, s57, v58
    v_cvt_pk_bf16_f32 v84, v82, v83
    v_lshlrev_b32 v82, 16, v84
    v_and_b32 v83, s40, v84
    v_add_f32 v80, v80, v82
    v_add_f32 v81, v81, v83
    v_cvt_pk_bf16_f32 v84, v80, v81
    v_lshlrev_b32 v80, 16, v84
    v_and_b32 v81, s40, v84
    v_mul_f32 v82, s56, v58
    v_mul_f32 v83, s56, v62
    v_cvt_pk_bf16_f32 v84, v82, v83
    v_lshlrev_b32 v82, 16, v84
    v_and_b32 v83, s40, v84
    v_add_f32 v80, v80, v82
    v_add_f32 v81, v81, v83
    v_cvt_pk_bf16_f32 v84, v80, v81
    v_lshlrev_b32 v80, 16, v84
    v_and_b32 v81, s40, v84
    v_lshlrev_b32 v82, 16, v160
    v_lshlrev_b32 v83, 16, v162
    v_mul_f32 v80, v80, v82
    v_mul_f32 v81, v81, v83
    v_cvt_pk_bf16_f32 v90, v80, v81
    v_mul_f32 v80, s59, v54
    v_mul_f32 v81, s59, v58
    v_cvt_pk_bf16_f32 v84, v80, v81
    v_lshlrev_b32 v80, 16, v84
    v_and_b32 v81, s40, v84
    v_mul_f32 v82, s58, v58
    v_mul_f32 v83, s58, v62
    v_cvt_pk_bf16_f32 v84, v82, v83
    v_lshlrev_b32 v82, 16, v84
    v_and_b32 v83, s40, v84
    v_add_f32 v80, v80, v82
    v_add_f32 v81, v81, v83
    v_cvt_pk_bf16_f32 v84, v80, v81
    v_lshlrev_b32 v80, 16, v84
    v_and_b32 v81, s40, v84
    v_mul_f32 v82, s57, v62
    v_mul_f32 v83, s57, v66
    v_cvt_pk_bf16_f32 v84, v82, v83
    v_lshlrev_b32 v82, 16, v84
    v_and_b32 v83, s40, v84
    v_add_f32 v80, v80, v82
    v_add_f32 v81, v81, v83
    v_cvt_pk_bf16_f32 v84, v80, v81
    v_lshlrev_b32 v80, 16, v84
    v_and_b32 v81, s40, v84
    v_mul_f32 v82, s56, v66
    v_mul_f32 v83, s56, v70
    v_cvt_pk_bf16_f32 v84, v82, v83
    v_lshlrev_b32 v82, 16, v84
    v_and_b32 v83, s40, v84
    v_add_f32 v80, v80, v82
    v_add_f32 v81, v81, v83
    v_cvt_pk_bf16_f32 v84, v80, v81
    v_lshlrev_b32 v80, 16, v84
    v_and_b32 v81, s40, v84
    v_lshlrev_b32 v82, 16, v164
    v_lshlrev_b32 v83, 16, v166
    v_mul_f32 v80, v80, v82
    v_mul_f32 v81, v81, v83
    v_cvt_pk_bf16_f32 v91, v80, v81
    ds_write_b128 v12, v[88:91] offset:5120
    v_mul_f32 v80, s63, v31
    v_mul_f32 v81, s63, v35
    v_cvt_pk_bf16_f32 v84, v80, v81
    v_lshlrev_b32 v80, 16, v84
    v_and_b32 v81, s40, v84
    v_mul_f32 v82, s62, v35
    v_mul_f32 v83, s62, v39
    v_cvt_pk_bf16_f32 v84, v82, v83
    v_lshlrev_b32 v82, 16, v84
    v_and_b32 v83, s40, v84
    v_add_f32 v80, v80, v82
    v_add_f32 v81, v81, v83
    v_cvt_pk_bf16_f32 v84, v80, v81
    v_lshlrev_b32 v80, 16, v84
    v_and_b32 v81, s40, v84
    v_mul_f32 v82, s61, v39
    v_mul_f32 v83, s61, v43
    v_cvt_pk_bf16_f32 v84, v82, v83
    v_lshlrev_b32 v82, 16, v84
    v_and_b32 v83, s40, v84
    v_add_f32 v80, v80, v82
    v_add_f32 v81, v81, v83
    v_cvt_pk_bf16_f32 v84, v80, v81
    v_lshlrev_b32 v80, 16, v84
    v_and_b32 v81, s40, v84
    v_mul_f32 v82, s60, v43
    v_mul_f32 v83, s60, v47
    v_cvt_pk_bf16_f32 v84, v82, v83
    v_lshlrev_b32 v82, 16, v84
    v_and_b32 v83, s40, v84
    v_add_f32 v80, v80, v82
    v_add_f32 v81, v81, v83
    v_cvt_pk_bf16_f32 v84, v80, v81
    v_lshlrev_b32 v80, 16, v84
    v_and_b32 v81, s40, v84
    v_and_b32 v82, s40, v152
    v_and_b32 v83, s40, v154
    v_mul_f32 v80, v80, v82
    v_mul_f32 v81, v81, v83
    v_cvt_pk_bf16_f32 v88, v80, v81
    v_mul_f32 v80, s63, v39
    v_mul_f32 v81, s63, v43
    v_cvt_pk_bf16_f32 v84, v80, v81
    v_lshlrev_b32 v80, 16, v84
    v_and_b32 v81, s40, v84
    v_mul_f32 v82, s62, v43
    v_mul_f32 v83, s62, v47
    v_cvt_pk_bf16_f32 v84, v82, v83
    v_lshlrev_b32 v82, 16, v84
    v_and_b32 v83, s40, v84
    v_add_f32 v80, v80, v82
    v_add_f32 v81, v81, v83
    v_cvt_pk_bf16_f32 v84, v80, v81
    v_lshlrev_b32 v80, 16, v84
    v_and_b32 v81, s40, v84
    v_mul_f32 v82, s61, v47
    v_mul_f32 v83, s61, v51
    v_cvt_pk_bf16_f32 v84, v82, v83
    v_lshlrev_b32 v82, 16, v84
    v_and_b32 v83, s40, v84
    v_add_f32 v80, v80, v82
    v_add_f32 v81, v81, v83
    v_cvt_pk_bf16_f32 v84, v80, v81
    v_lshlrev_b32 v80, 16, v84
    v_and_b32 v81, s40, v84
    v_mul_f32 v82, s60, v51
    v_mul_f32 v83, s60, v55
    v_cvt_pk_bf16_f32 v84, v82, v83
    v_lshlrev_b32 v82, 16, v84
    v_and_b32 v83, s40, v84
    v_add_f32 v80, v80, v82
    v_add_f32 v81, v81, v83
    v_cvt_pk_bf16_f32 v84, v80, v81
    v_lshlrev_b32 v80, 16, v84
    v_and_b32 v81, s40, v84
    v_and_b32 v82, s40, v156
    v_and_b32 v83, s40, v158
    v_mul_f32 v80, v80, v82
    v_mul_f32 v81, v81, v83
    v_cvt_pk_bf16_f32 v89, v80, v81
    v_mul_f32 v80, s63, v47
    v_mul_f32 v81, s63, v51
    v_cvt_pk_bf16_f32 v84, v80, v81
    v_lshlrev_b32 v80, 16, v84
    v_and_b32 v81, s40, v84
    v_mul_f32 v82, s62, v51
    v_mul_f32 v83, s62, v55
    v_cvt_pk_bf16_f32 v84, v82, v83
    v_lshlrev_b32 v82, 16, v84
    v_and_b32 v83, s40, v84
    v_add_f32 v80, v80, v82
    v_add_f32 v81, v81, v83
    v_cvt_pk_bf16_f32 v84, v80, v81
    v_lshlrev_b32 v80, 16, v84
    v_and_b32 v81, s40, v84
    v_mul_f32 v82, s61, v55
    v_mul_f32 v83, s61, v59
    v_cvt_pk_bf16_f32 v84, v82, v83
    v_lshlrev_b32 v82, 16, v84
    v_and_b32 v83, s40, v84
    v_add_f32 v80, v80, v82
    v_add_f32 v81, v81, v83
    v_cvt_pk_bf16_f32 v84, v80, v81
    v_lshlrev_b32 v80, 16, v84
    v_and_b32 v81, s40, v84
    v_mul_f32 v82, s60, v59
    v_mul_f32 v83, s60, v63
    v_cvt_pk_bf16_f32 v84, v82, v83
    v_lshlrev_b32 v82, 16, v84
    v_and_b32 v83, s40, v84
    v_add_f32 v80, v80, v82
    v_add_f32 v81, v81, v83
    v_cvt_pk_bf16_f32 v84, v80, v81
    v_lshlrev_b32 v80, 16, v84
    v_and_b32 v81, s40, v84
    v_and_b32 v82, s40, v160
    v_and_b32 v83, s40, v162
    v_mul_f32 v80, v80, v82
    v_mul_f32 v81, v81, v83
    v_cvt_pk_bf16_f32 v90, v80, v81
    v_mul_f32 v80, s63, v55
    v_mul_f32 v81, s63, v59
    v_cvt_pk_bf16_f32 v84, v80, v81
    v_lshlrev_b32 v80, 16, v84
    v_and_b32 v81, s40, v84
    v_mul_f32 v82, s62, v59
    v_mul_f32 v83, s62, v63
    v_cvt_pk_bf16_f32 v84, v82, v83
    v_lshlrev_b32 v82, 16, v84
    v_and_b32 v83, s40, v84
    v_add_f32 v80, v80, v82
    v_add_f32 v81, v81, v83
    v_cvt_pk_bf16_f32 v84, v80, v81
    v_lshlrev_b32 v80, 16, v84
    v_and_b32 v81, s40, v84
    v_mul_f32 v82, s61, v63
    v_mul_f32 v83, s61, v67
    v_cvt_pk_bf16_f32 v84, v82, v83
    v_lshlrev_b32 v82, 16, v84
    v_and_b32 v83, s40, v84
    v_add_f32 v80, v80, v82
    v_add_f32 v81, v81, v83
    v_cvt_pk_bf16_f32 v84, v80, v81
    v_lshlrev_b32 v80, 16, v84
    v_and_b32 v81, s40, v84
    v_mul_f32 v82, s60, v67
    v_mul_f32 v83, s60, v71
    v_cvt_pk_bf16_f32 v84, v82, v83
    v_lshlrev_b32 v82, 16, v84
    v_and_b32 v83, s40, v84
    v_add_f32 v80, v80, v82
    v_add_f32 v81, v81, v83
    v_cvt_pk_bf16_f32 v84, v80, v81
    v_lshlrev_b32 v80, 16, v84
    v_and_b32 v81, s40, v84
    v_and_b32 v82, s40, v164
    v_and_b32 v83, s40, v166
    v_mul_f32 v80, v80, v82
    v_mul_f32 v81, v81, v83
    v_cvt_pk_bf16_f32 v91, v80, v81
    ds_write_b128 v12, v[88:91] offset:15360
    v_mul_f32 v80, s67, v32
    v_mul_f32 v81, s67, v36
    v_cvt_pk_bf16_f32 v84, v80, v81
    v_lshlrev_b32 v80, 16, v84
    v_and_b32 v81, s40, v84
    v_mul_f32 v82, s66, v36
    v_mul_f32 v83, s66, v40
    v_cvt_pk_bf16_f32 v84, v82, v83
    v_lshlrev_b32 v82, 16, v84
    v_and_b32 v83, s40, v84
    v_add_f32 v80, v80, v82
    v_add_f32 v81, v81, v83
    v_cvt_pk_bf16_f32 v84, v80, v81
    v_lshlrev_b32 v80, 16, v84
    v_and_b32 v81, s40, v84
    v_mul_f32 v82, s65, v40
    v_mul_f32 v83, s65, v44
    v_cvt_pk_bf16_f32 v84, v82, v83
    v_lshlrev_b32 v82, 16, v84
    v_and_b32 v83, s40, v84
    v_add_f32 v80, v80, v82
    v_add_f32 v81, v81, v83
    v_cvt_pk_bf16_f32 v84, v80, v81
    v_lshlrev_b32 v80, 16, v84
    v_and_b32 v81, s40, v84
    v_mul_f32 v82, s64, v44
    v_mul_f32 v83, s64, v48
    v_cvt_pk_bf16_f32 v84, v82, v83
    v_lshlrev_b32 v82, 16, v84
    v_and_b32 v83, s40, v84
    v_add_f32 v80, v80, v82
    v_add_f32 v81, v81, v83
    v_cvt_pk_bf16_f32 v84, v80, v81
    v_lshlrev_b32 v80, 16, v84
    v_and_b32 v81, s40, v84
    v_lshlrev_b32 v82, 16, v153
    v_lshlrev_b32 v83, 16, v155
    v_mul_f32 v80, v80, v82
    v_mul_f32 v81, v81, v83
    v_cvt_pk_bf16_f32 v88, v80, v81
    v_mul_f32 v80, s67, v40
    v_mul_f32 v81, s67, v44
    v_cvt_pk_bf16_f32 v84, v80, v81
    v_lshlrev_b32 v80, 16, v84
    v_and_b32 v81, s40, v84
    v_mul_f32 v82, s66, v44
    v_mul_f32 v83, s66, v48
    v_cvt_pk_bf16_f32 v84, v82, v83
    v_lshlrev_b32 v82, 16, v84
    v_and_b32 v83, s40, v84
    v_add_f32 v80, v80, v82
    v_add_f32 v81, v81, v83
    v_cvt_pk_bf16_f32 v84, v80, v81
    v_lshlrev_b32 v80, 16, v84
    v_and_b32 v81, s40, v84
    v_mul_f32 v82, s65, v48
    v_mul_f32 v83, s65, v52
    v_cvt_pk_bf16_f32 v84, v82, v83
    v_lshlrev_b32 v82, 16, v84
    v_and_b32 v83, s40, v84
    v_add_f32 v80, v80, v82
    v_add_f32 v81, v81, v83
    v_cvt_pk_bf16_f32 v84, v80, v81
    v_lshlrev_b32 v80, 16, v84
    v_and_b32 v81, s40, v84
    v_mul_f32 v82, s64, v52
    v_mul_f32 v83, s64, v56
    v_cvt_pk_bf16_f32 v84, v82, v83
    v_lshlrev_b32 v82, 16, v84
    v_and_b32 v83, s40, v84
    v_add_f32 v80, v80, v82
    v_add_f32 v81, v81, v83
    v_cvt_pk_bf16_f32 v84, v80, v81
    v_lshlrev_b32 v80, 16, v84
    v_and_b32 v81, s40, v84
    v_lshlrev_b32 v82, 16, v157
    v_lshlrev_b32 v83, 16, v159
    v_mul_f32 v80, v80, v82
    v_mul_f32 v81, v81, v83
    v_cvt_pk_bf16_f32 v89, v80, v81
    v_mul_f32 v80, s67, v48
    v_mul_f32 v81, s67, v52
    v_cvt_pk_bf16_f32 v84, v80, v81
    v_lshlrev_b32 v80, 16, v84
    v_and_b32 v81, s40, v84
    v_mul_f32 v82, s66, v52
    v_mul_f32 v83, s66, v56
    v_cvt_pk_bf16_f32 v84, v82, v83
    v_lshlrev_b32 v82, 16, v84
    v_and_b32 v83, s40, v84
    v_add_f32 v80, v80, v82
    v_add_f32 v81, v81, v83
    v_cvt_pk_bf16_f32 v84, v80, v81
    v_lshlrev_b32 v80, 16, v84
    v_and_b32 v81, s40, v84
    v_mul_f32 v82, s65, v56
    v_mul_f32 v83, s65, v60
    v_cvt_pk_bf16_f32 v84, v82, v83
    v_lshlrev_b32 v82, 16, v84
    v_and_b32 v83, s40, v84
    v_add_f32 v80, v80, v82
    v_add_f32 v81, v81, v83
    v_cvt_pk_bf16_f32 v84, v80, v81
    v_lshlrev_b32 v80, 16, v84
    v_and_b32 v81, s40, v84
    v_mul_f32 v82, s64, v60
    v_mul_f32 v83, s64, v64
    v_cvt_pk_bf16_f32 v84, v82, v83
    v_lshlrev_b32 v82, 16, v84
    v_and_b32 v83, s40, v84
    v_add_f32 v80, v80, v82
    v_add_f32 v81, v81, v83
    v_cvt_pk_bf16_f32 v84, v80, v81
    v_lshlrev_b32 v80, 16, v84
    v_and_b32 v81, s40, v84
    v_lshlrev_b32 v82, 16, v161
    v_lshlrev_b32 v83, 16, v163
    v_mul_f32 v80, v80, v82
    v_mul_f32 v81, v81, v83
    v_cvt_pk_bf16_f32 v90, v80, v81
    v_mul_f32 v80, s67, v56
    v_mul_f32 v81, s67, v60
    v_cvt_pk_bf16_f32 v84, v80, v81
    v_lshlrev_b32 v80, 16, v84
    v_and_b32 v81, s40, v84
    v_mul_f32 v82, s66, v60
    v_mul_f32 v83, s66, v64
    v_cvt_pk_bf16_f32 v84, v82, v83
    v_lshlrev_b32 v82, 16, v84
    v_and_b32 v83, s40, v84
    v_add_f32 v80, v80, v82
    v_add_f32 v81, v81, v83
    v_cvt_pk_bf16_f32 v84, v80, v81
    v_lshlrev_b32 v80, 16, v84
    v_and_b32 v81, s40, v84
    v_mul_f32 v82, s65, v64
    v_mul_f32 v83, s65, v68
    v_cvt_pk_bf16_f32 v84, v82, v83
    v_lshlrev_b32 v82, 16, v84
    v_and_b32 v83, s40, v84
    v_add_f32 v80, v80, v82
    v_add_f32 v81, v81, v83
    v_cvt_pk_bf16_f32 v84, v80, v81
    v_lshlrev_b32 v80, 16, v84
    v_and_b32 v81, s40, v84
    v_mul_f32 v82, s64, v68
    v_mul_f32 v83, s64, v72
    v_cvt_pk_bf16_f32 v84, v82, v83
    v_lshlrev_b32 v82, 16, v84
    v_and_b32 v83, s40, v84
    v_add_f32 v80, v80, v82
    v_add_f32 v81, v81, v83
    v_cvt_pk_bf16_f32 v84, v80, v81
    v_lshlrev_b32 v80, 16, v84
    v_and_b32 v81, s40, v84
    v_lshlrev_b32 v82, 16, v165
    v_lshlrev_b32 v83, 16, v167
    v_mul_f32 v80, v80, v82
    v_mul_f32 v81, v81, v83
    v_cvt_pk_bf16_f32 v91, v80, v81
    ds_write_b128 v12, v[88:91] offset:25600
    v_mul_f32 v80, s71, v33
    v_mul_f32 v81, s71, v37
    v_cvt_pk_bf16_f32 v84, v80, v81
    v_lshlrev_b32 v80, 16, v84
    v_and_b32 v81, s40, v84
    v_mul_f32 v82, s70, v37
    v_mul_f32 v83, s70, v41
    v_cvt_pk_bf16_f32 v84, v82, v83
    v_lshlrev_b32 v82, 16, v84
    v_and_b32 v83, s40, v84
    v_add_f32 v80, v80, v82
    v_add_f32 v81, v81, v83
    v_cvt_pk_bf16_f32 v84, v80, v81
    v_lshlrev_b32 v80, 16, v84
    v_and_b32 v81, s40, v84
    v_mul_f32 v82, s69, v41
    v_mul_f32 v83, s69, v45
    v_cvt_pk_bf16_f32 v84, v82, v83
    v_lshlrev_b32 v82, 16, v84
    v_and_b32 v83, s40, v84
    v_add_f32 v80, v80, v82
    v_add_f32 v81, v81, v83
    v_cvt_pk_bf16_f32 v84, v80, v81
    v_lshlrev_b32 v80, 16, v84
    v_and_b32 v81, s40, v84
    v_mul_f32 v82, s68, v45
    v_mul_f32 v83, s68, v49
    v_cvt_pk_bf16_f32 v84, v82, v83
    v_lshlrev_b32 v82, 16, v84
    v_and_b32 v83, s40, v84
    v_add_f32 v80, v80, v82
    v_add_f32 v81, v81, v83
    v_cvt_pk_bf16_f32 v84, v80, v81
    v_lshlrev_b32 v80, 16, v84
    v_and_b32 v81, s40, v84
    v_and_b32 v82, s40, v153
    v_and_b32 v83, s40, v155
    v_mul_f32 v80, v80, v82
    v_mul_f32 v81, v81, v83
    v_cvt_pk_bf16_f32 v88, v80, v81
    v_mul_f32 v80, s71, v41
    v_mul_f32 v81, s71, v45
    v_cvt_pk_bf16_f32 v84, v80, v81
    v_lshlrev_b32 v80, 16, v84
    v_and_b32 v81, s40, v84
    v_mul_f32 v82, s70, v45
    v_mul_f32 v83, s70, v49
    v_cvt_pk_bf16_f32 v84, v82, v83
    v_lshlrev_b32 v82, 16, v84
    v_and_b32 v83, s40, v84
    v_add_f32 v80, v80, v82
    v_add_f32 v81, v81, v83
    v_cvt_pk_bf16_f32 v84, v80, v81
    v_lshlrev_b32 v80, 16, v84
    v_and_b32 v81, s40, v84
    v_mul_f32 v82, s69, v49
    v_mul_f32 v83, s69, v53
    v_cvt_pk_bf16_f32 v84, v82, v83
    v_lshlrev_b32 v82, 16, v84
    v_and_b32 v83, s40, v84
    v_add_f32 v80, v80, v82
    v_add_f32 v81, v81, v83
    v_cvt_pk_bf16_f32 v84, v80, v81
    v_lshlrev_b32 v80, 16, v84
    v_and_b32 v81, s40, v84
    v_mul_f32 v82, s68, v53
    v_mul_f32 v83, s68, v57
    v_cvt_pk_bf16_f32 v84, v82, v83
    v_lshlrev_b32 v82, 16, v84
    v_and_b32 v83, s40, v84
    v_add_f32 v80, v80, v82
    v_add_f32 v81, v81, v83
    v_cvt_pk_bf16_f32 v84, v80, v81
    v_lshlrev_b32 v80, 16, v84
    v_and_b32 v81, s40, v84
    v_and_b32 v82, s40, v157
    v_and_b32 v83, s40, v159
    v_mul_f32 v80, v80, v82
    v_mul_f32 v81, v81, v83
    v_cvt_pk_bf16_f32 v89, v80, v81
    v_mul_f32 v80, s71, v49
    v_mul_f32 v81, s71, v53
    v_cvt_pk_bf16_f32 v84, v80, v81
    v_lshlrev_b32 v80, 16, v84
    v_and_b32 v81, s40, v84
    v_mul_f32 v82, s70, v53
    v_mul_f32 v83, s70, v57
    v_cvt_pk_bf16_f32 v84, v82, v83
    v_lshlrev_b32 v82, 16, v84
    v_and_b32 v83, s40, v84
    v_add_f32 v80, v80, v82
    v_add_f32 v81, v81, v83
    v_cvt_pk_bf16_f32 v84, v80, v81
    v_lshlrev_b32 v80, 16, v84
    v_and_b32 v81, s40, v84
    v_mul_f32 v82, s69, v57
    v_mul_f32 v83, s69, v61
    v_cvt_pk_bf16_f32 v84, v82, v83
    v_lshlrev_b32 v82, 16, v84
    v_and_b32 v83, s40, v84
    v_add_f32 v80, v80, v82
    v_add_f32 v81, v81, v83
    v_cvt_pk_bf16_f32 v84, v80, v81
    v_lshlrev_b32 v80, 16, v84
    v_and_b32 v81, s40, v84
    v_mul_f32 v82, s68, v61
    v_mul_f32 v83, s68, v65
    v_cvt_pk_bf16_f32 v84, v82, v83
    v_lshlrev_b32 v82, 16, v84
    v_and_b32 v83, s40, v84
    v_add_f32 v80, v80, v82
    v_add_f32 v81, v81, v83
    v_cvt_pk_bf16_f32 v84, v80, v81
    v_lshlrev_b32 v80, 16, v84
    v_and_b32 v81, s40, v84
    v_and_b32 v82, s40, v161
    v_and_b32 v83, s40, v163
    v_mul_f32 v80, v80, v82
    v_mul_f32 v81, v81, v83
    v_cvt_pk_bf16_f32 v90, v80, v81
    v_mul_f32 v80, s71, v57
    v_mul_f32 v81, s71, v61
    v_cvt_pk_bf16_f32 v84, v80, v81
    v_lshlrev_b32 v80, 16, v84
    v_and_b32 v81, s40, v84
    v_mul_f32 v82, s70, v61
    v_mul_f32 v83, s70, v65
    v_cvt_pk_bf16_f32 v84, v82, v83
    v_lshlrev_b32 v82, 16, v84
    v_and_b32 v83, s40, v84
    v_add_f32 v80, v80, v82
    v_add_f32 v81, v81, v83
    v_cvt_pk_bf16_f32 v84, v80, v81
    v_lshlrev_b32 v80, 16, v84
    v_and_b32 v81, s40, v84
    v_mul_f32 v82, s69, v65
    v_mul_f32 v83, s69, v69
    v_cvt_pk_bf16_f32 v84, v82, v83
    v_lshlrev_b32 v82, 16, v84
    v_and_b32 v83, s40, v84
    v_add_f32 v80, v80, v82
    v_add_f32 v81, v81, v83
    v_cvt_pk_bf16_f32 v84, v80, v81
    v_lshlrev_b32 v80, 16, v84
    v_and_b32 v81, s40, v84
    v_mul_f32 v82, s68, v69
    v_mul_f32 v83, s68, v73
    v_cvt_pk_bf16_f32 v84, v82, v83
    v_lshlrev_b32 v82, 16, v84
    v_and_b32 v83, s40, v84
    v_add_f32 v80, v80, v82
    v_add_f32 v81, v81, v83
    v_cvt_pk_bf16_f32 v84, v80, v81
    v_lshlrev_b32 v80, 16, v84
    v_and_b32 v81, s40, v84
    v_and_b32 v82, s40, v165
    v_and_b32 v83, s40, v167
    v_mul_f32 v80, v80, v82
    v_mul_f32 v81, v81, v83
    v_cvt_pk_bf16_f32 v91, v80, v81
    ds_write_b128 v12, v[88:91] offset:35840
    s_waitcnt lgkmcnt(0)
    s_barrier
    v_and_b32 v3, 31, v2
    v_lshrrev_b32 v4, 5, v2
    v_sub_u32 v5, 2051, v3
    v_and_b32 v6, 3, v5
    v_sub_u32 v5, v5, v6
    v_lshl_add_u32 v5, v4, 3, v5
    v_subrev_u32 v5, 2016, v5
    v_lshlrev_b32 v5, 1, v5
    v_mul_u32_u24 v6, 5184, v6
    v_add_u32 v5, v5, v6
    s_movk_i32 s3, 20736
    s_mul_i32 s3, s3, s42
    s_add_u32 s3, s3, 40960
    v_add_u32 v5, s3, v5
    v_add_u32 v6, 1, v3
    v_mul_u32_u24 v6, 80, v6
    v_lshl_add_u32 v6, v4, 4, v6
    s_movk_i32 s3, 10240
    s_mul_i32 s3, s3, s42
    s_add_u32 s3, s3, 0
    v_add_u32 v6, s3, v6
    v_mov_b32 v64, 0
    v_mov_b32 v65, 0
    v_mov_b32 v66, 0
    v_mov_b32 v67, 0
    v_mov_b32 v68, 0
    v_mov_b32 v69, 0
    v_mov_b32 v70, 0
    v_mov_b32 v71, 0
    v_mov_b32 v72, 0
    v_mov_b32 v73, 0
    v_mov_b32 v74, 0
    v_mov_b32 v75, 0
    v_mov_b32 v76, 0
    v_mov_b32 v77, 0
    v_mov_b32 v78, 0
    v_mov_b32 v79, 0
    v_mov_b32 v80, 0
    v_mov_b32 v81, 0
    v_mov_b32 v82, 0
    v_mov_b32 v83, 0
    v_mov_b32 v84, 0
    v_mov_b32 v85, 0
    v_mov_b32 v86, 0
    v_mov_b32 v87, 0
    v_mov_b32 v88, 0
    v_mov_b32 v89, 0
    v_mov_b32 v90, 0
    v_mov_b32 v91, 0
    v_mov_b32 v92, 0
    v_mov_b32 v93, 0
    v_mov_b32 v94, 0
    v_mov_b32 v95, 0
    ds_read_b64 v[96:97], v5 offset:4032
    ds_read_b64 v[98:99], v5 offset:4040
    ds_read_b128 v[104:107], v6 offset:7600
    ds_read_b128 v[100:103], v6 offset:5040
    ds_read_b64 v[108:109], v5 offset:4064
    ds_read_b64 v[110:111], v5 offset:4072
    ds_read_b128 v[116:119], v6 offset:7632
    ds_read_b128 v[112:115], v6 offset:5072
    ds_read_b64 v[120:121], v5 offset:3968
    ds_read_b64 v[122:123], v5 offset:3976
    ds_read_b128 v[128:131], v6 offset:7520
    ds_read_b128 v[124:127], v6 offset:4960
    s_waitcnt lgkmcnt(8)
    v_mfma_f32_32x32x16_bf16 v[80:95], v[96:99], v[104:107], v[80:95]
    v_mfma_f32_32x32x16_bf16 v[64:79], v[96:99], v[100:103], v[64:79]
    ds_read_b64 v[132:133], v5 offset:4000
    ds_read_b64 v[134:135], v5 offset:4008
    ds_read_b128 v[140:143], v6 offset:7552
    ds_read_b128 v[136:139], v6 offset:4992
    s_waitcnt lgkmcnt(8)
    v_mfma_f32_32x32x16_bf16 v[80:95], v[108:111], v[116:119], v[80:95]
    v_mfma_f32_32x32x16_bf16 v[64:79], v[108:111], v[112:115], v[64:79]
    ds_read_b64 v[96:97], v5 offset:3904
    ds_read_b64 v[98:99], v5 offset:3912
    ds_read_b128 v[104:107], v6 offset:7440
    ds_read_b128 v[100:103], v6 offset:4880
    s_waitcnt lgkmcnt(8)
    v_mfma_f32_32x32x16_bf16 v[80:95], v[120:123], v[128:131], v[80:95]
    v_mfma_f32_32x32x16_bf16 v[64:79], v[120:123], v[124:127], v[64:79]
    ds_read_b64 v[108:109], v5 offset:3936
    ds_read_b64 v[110:111], v5 offset:3944
    ds_read_b128 v[116:119], v6 offset:7472
    ds_read_b128 v[112:115], v6 offset:4912
    s_waitcnt lgkmcnt(8)
    v_mfma_f32_32x32x16_bf16 v[80:95], v[132:135], v[140:143], v[80:95]
    v_mfma_f32_32x32x16_bf16 v[64:79], v[132:135], v[136:139], v[64:79]
    ds_read_b64 v[120:121], v5 offset:3840
    ds_read_b64 v[122:123], v5 offset:3848
    ds_read_b128 v[128:131], v6 offset:7360
    ds_read_b128 v[124:127], v6 offset:4800
    s_waitcnt lgkmcnt(8)
    v_mfma_f32_32x32x16_bf16 v[80:95], v[96:99], v[104:107], v[80:95]
    v_mfma_f32_32x32x16_bf16 v[64:79], v[96:99], v[100:103], v[64:79]
    ds_read_b64 v[132:133], v5 offset:3872
    ds_read_b64 v[134:135], v5 offset:3880
    ds_read_b128 v[140:143], v6 offset:7392
    ds_read_b128 v[136:139], v6 offset:4832
    s_waitcnt lgkmcnt(8)
    v_mfma_f32_32x32x16_bf16 v[80:95], v[108:111], v[116:119], v[80:95]
    v_mfma_f32_32x32x16_bf16 v[64:79], v[108:111], v[112:115], v[64:79]
    ds_read_b64 v[96:97], v5 offset:3776
    ds_read_b64 v[98:99], v5 offset:3784
    ds_read_b128 v[104:107], v6 offset:7280
    ds_read_b128 v[100:103], v6 offset:4720
    s_waitcnt lgkmcnt(8)
    v_mfma_f32_32x32x16_bf16 v[80:95], v[120:123], v[128:131], v[80:95]
    v_mfma_f32_32x32x16_bf16 v[64:79], v[120:123], v[124:127], v[64:79]
    ds_read_b64 v[108:109], v5 offset:3808
    ds_read_b64 v[110:111], v5 offset:3816
    ds_read_b128 v[116:119], v6 offset:7312
    ds_read_b128 v[112:115], v6 offset:4752
    s_waitcnt lgkmcnt(8)
    v_mfma_f32_32x32x16_bf16 v[80:95], v[132:135], v[140:143], v[80:95]
    v_mfma_f32_32x32x16_bf16 v[64:79], v[132:135], v[136:139], v[64:79]
    ds_read_b64 v[120:121], v5 offset:3712
    ds_read_b64 v[122:123], v5 offset:3720
    ds_read_b128 v[128:131], v6 offset:7200
    ds_read_b128 v[124:127], v6 offset:4640
    s_waitcnt lgkmcnt(8)
    v_mfma_f32_32x32x16_bf16 v[80:95], v[96:99], v[104:107], v[80:95]
    v_mfma_f32_32x32x16_bf16 v[64:79], v[96:99], v[100:103], v[64:79]
    ds_read_b64 v[132:133], v5 offset:3744
    ds_read_b64 v[134:135], v5 offset:3752
    ds_read_b128 v[140:143], v6 offset:7232
    ds_read_b128 v[136:139], v6 offset:4672
    s_waitcnt lgkmcnt(8)
    v_mfma_f32_32x32x16_bf16 v[80:95], v[108:111], v[116:119], v[80:95]
    v_mfma_f32_32x32x16_bf16 v[64:79], v[108:111], v[112:115], v[64:79]
    ds_read_b64 v[96:97], v5 offset:3648
    ds_read_b64 v[98:99], v5 offset:3656
    ds_read_b128 v[104:107], v6 offset:7120
    ds_read_b128 v[100:103], v6 offset:4560
    s_waitcnt lgkmcnt(8)
    v_mfma_f32_32x32x16_bf16 v[80:95], v[120:123], v[128:131], v[80:95]
    v_mfma_f32_32x32x16_bf16 v[64:79], v[120:123], v[124:127], v[64:79]
    ds_read_b64 v[108:109], v5 offset:3680
    ds_read_b64 v[110:111], v5 offset:3688
    ds_read_b128 v[116:119], v6 offset:7152
    ds_read_b128 v[112:115], v6 offset:4592
    s_waitcnt lgkmcnt(8)
    v_mfma_f32_32x32x16_bf16 v[80:95], v[132:135], v[140:143], v[80:95]
    v_mfma_f32_32x32x16_bf16 v[64:79], v[132:135], v[136:139], v[64:79]
    ds_read_b64 v[120:121], v5 offset:3584
    ds_read_b64 v[122:123], v5 offset:3592
    ds_read_b128 v[128:131], v6 offset:7040
    ds_read_b128 v[124:127], v6 offset:4480
    s_waitcnt lgkmcnt(8)
    v_mfma_f32_32x32x16_bf16 v[80:95], v[96:99], v[104:107], v[80:95]
    v_mfma_f32_32x32x16_bf16 v[64:79], v[96:99], v[100:103], v[64:79]
    ds_read_b64 v[132:133], v5 offset:3616
    ds_read_b64 v[134:135], v5 offset:3624
    ds_read_b128 v[140:143], v6 offset:7072
    ds_read_b128 v[136:139], v6 offset:4512
    s_waitcnt lgkmcnt(8)
    v_mfma_f32_32x32x16_bf16 v[80:95], v[108:111], v[116:119], v[80:95]
    v_mfma_f32_32x32x16_bf16 v[64:79], v[108:111], v[112:115], v[64:79]
    ds_read_b64 v[96:97], v5 offset:3520
    ds_read_b64 v[98:99], v5 offset:3528
    ds_read_b128 v[104:107], v6 offset:6960
    ds_read_b128 v[100:103], v6 offset:4400
    s_waitcnt lgkmcnt(8)
    v_mfma_f32_32x32x16_bf16 v[80:95], v[120:123], v[128:131], v[80:95]
    v_mfma_f32_32x32x16_bf16 v[64:79], v[120:123], v[124:127], v[64:79]
    ds_read_b64 v[108:109], v5 offset:3552
    ds_read_b64 v[110:111], v5 offset:3560
    ds_read_b128 v[116:119], v6 offset:6992
    ds_read_b128 v[112:115], v6 offset:4432
    s_waitcnt lgkmcnt(8)
    v_mfma_f32_32x32x16_bf16 v[80:95], v[132:135], v[140:143], v[80:95]
    v_mfma_f32_32x32x16_bf16 v[64:79], v[132:135], v[136:139], v[64:79]
    ds_read_b64 v[120:121], v5 offset:3456
    ds_read_b64 v[122:123], v5 offset:3464
    ds_read_b128 v[128:131], v6 offset:6880
    ds_read_b128 v[124:127], v6 offset:4320
    s_waitcnt lgkmcnt(8)
    v_mfma_f32_32x32x16_bf16 v[80:95], v[96:99], v[104:107], v[80:95]
    v_mfma_f32_32x32x16_bf16 v[64:79], v[96:99], v[100:103], v[64:79]
    ds_read_b64 v[132:133], v5 offset:3488
    ds_read_b64 v[134:135], v5 offset:3496
    ds_read_b128 v[140:143], v6 offset:6912
    ds_read_b128 v[136:139], v6 offset:4352
    s_waitcnt lgkmcnt(8)
    v_mfma_f32_32x32x16_bf16 v[80:95], v[108:111], v[116:119], v[80:95]
    v_mfma_f32_32x32x16_bf16 v[64:79], v[108:111], v[112:115], v[64:79]
    ds_read_b64 v[96:97], v5 offset:3392
    ds_read_b64 v[98:99], v5 offset:3400
    ds_read_b128 v[104:107], v6 offset:6800
    ds_read_b128 v[100:103], v6 offset:4240
    s_waitcnt lgkmcnt(8)
    v_mfma_f32_32x32x16_bf16 v[80:95], v[120:123], v[128:131], v[80:95]
    v_mfma_f32_32x32x16_bf16 v[64:79], v[120:123], v[124:127], v[64:79]
    ds_read_b64 v[108:109], v5 offset:3424
    ds_read_b64 v[110:111], v5 offset:3432
    ds_read_b128 v[116:119], v6 offset:6832
    ds_read_b128 v[112:115], v6 offset:4272
    s_waitcnt lgkmcnt(8)
    v_mfma_f32_32x32x16_bf16 v[80:95], v[132:135], v[140:143], v[80:95]
    v_mfma_f32_32x32x16_bf16 v[64:79], v[132:135], v[136:139], v[64:79]
    ds_read_b64 v[120:121], v5 offset:3328
    ds_read_b64 v[122:123], v5 offset:3336
    ds_read_b128 v[128:131], v6 offset:6720
    ds_read_b128 v[124:127], v6 offset:4160
    s_waitcnt lgkmcnt(8)
    v_mfma_f32_32x32x16_bf16 v[80:95], v[96:99], v[104:107], v[80:95]
    v_mfma_f32_32x32x16_bf16 v[64:79], v[96:99], v[100:103], v[64:79]
    ds_read_b64 v[132:133], v5 offset:3360
    ds_read_b64 v[134:135], v5 offset:3368
    ds_read_b128 v[140:143], v6 offset:6752
    ds_read_b128 v[136:139], v6 offset:4192
    s_waitcnt lgkmcnt(8)
    v_mfma_f32_32x32x16_bf16 v[80:95], v[108:111], v[116:119], v[80:95]
    v_mfma_f32_32x32x16_bf16 v[64:79], v[108:111], v[112:115], v[64:79]
    ds_read_b64 v[96:97], v5 offset:3264
    ds_read_b64 v[98:99], v5 offset:3272
    ds_read_b128 v[104:107], v6 offset:6640
    ds_read_b128 v[100:103], v6 offset:4080
    s_waitcnt lgkmcnt(8)
    v_mfma_f32_32x32x16_bf16 v[80:95], v[120:123], v[128:131], v[80:95]
    v_mfma_f32_32x32x16_bf16 v[64:79], v[120:123], v[124:127], v[64:79]
    ds_read_b64 v[108:109], v5 offset:3296
    ds_read_b64 v[110:111], v5 offset:3304
    ds_read_b128 v[116:119], v6 offset:6672
    ds_read_b128 v[112:115], v6 offset:4112
    s_waitcnt lgkmcnt(8)
    v_mfma_f32_32x32x16_bf16 v[80:95], v[132:135], v[140:143], v[80:95]
    v_mfma_f32_32x32x16_bf16 v[64:79], v[132:135], v[136:139], v[64:79]
    ds_read_b64 v[120:121], v5 offset:3200
    ds_read_b64 v[122:123], v5 offset:3208
    ds_read_b128 v[128:131], v6 offset:6560
    ds_read_b128 v[124:127], v6 offset:4000
    s_waitcnt lgkmcnt(8)
    v_mfma_f32_32x32x16_bf16 v[80:95], v[96:99], v[104:107], v[80:95]
    v_mfma_f32_32x32x16_bf16 v[64:79], v[96:99], v[100:103], v[64:79]
    ds_read_b64 v[132:133], v5 offset:3232
    ds_read_b64 v[134:135], v5 offset:3240
    ds_read_b128 v[140:143], v6 offset:6592
    ds_read_b128 v[136:139], v6 offset:4032
    s_waitcnt lgkmcnt(8)
    v_mfma_f32_32x32x16_bf16 v[80:95], v[108:111], v[116:119], v[80:95]
    v_mfma_f32_32x32x16_bf16 v[64:79], v[108:111], v[112:115], v[64:79]
    ds_read_b64 v[96:97], v5 offset:3136
    ds_read_b64 v[98:99], v5 offset:3144
    ds_read_b128 v[104:107], v6 offset:6480
    ds_read_b128 v[100:103], v6 offset:3920
    s_waitcnt lgkmcnt(8)
    v_mfma_f32_32x32x16_bf16 v[80:95], v[120:123], v[128:131], v[80:95]
    v_mfma_f32_32x32x16_bf16 v[64:79], v[120:123], v[124:127], v[64:79]
    ds_read_b64 v[108:109], v5 offset:3168
    ds_read_b64 v[110:111], v5 offset:3176
    ds_read_b128 v[116:119], v6 offset:6512
    ds_read_b128 v[112:115], v6 offset:3952
    s_waitcnt lgkmcnt(8)
    v_mfma_f32_32x32x16_bf16 v[80:95], v[132:135], v[140:143], v[80:95]
    v_mfma_f32_32x32x16_bf16 v[64:79], v[132:135], v[136:139], v[64:79]
    ds_read_b64 v[120:121], v5 offset:3072
    ds_read_b64 v[122:123], v5 offset:3080
    ds_read_b128 v[128:131], v6 offset:6400
    ds_read_b128 v[124:127], v6 offset:3840
    s_waitcnt lgkmcnt(8)
    v_mfma_f32_32x32x16_bf16 v[80:95], v[96:99], v[104:107], v[80:95]
    v_mfma_f32_32x32x16_bf16 v[64:79], v[96:99], v[100:103], v[64:79]
    ds_read_b64 v[132:133], v5 offset:3104
    ds_read_b64 v[134:135], v5 offset:3112
    ds_read_b128 v[140:143], v6 offset:6432
    ds_read_b128 v[136:139], v6 offset:3872
    s_waitcnt lgkmcnt(8)
    v_mfma_f32_32x32x16_bf16 v[80:95], v[108:111], v[116:119], v[80:95]
    v_mfma_f32_32x32x16_bf16 v[64:79], v[108:111], v[112:115], v[64:79]
    ds_read_b64 v[96:97], v5 offset:3008
    ds_read_b64 v[98:99], v5 offset:3016
    ds_read_b128 v[104:107], v6 offset:6320
    ds_read_b128 v[100:103], v6 offset:3760
    s_waitcnt lgkmcnt(8)
    v_mfma_f32_32x32x16_bf16 v[80:95], v[120:123], v[128:131], v[80:95]
    v_mfma_f32_32x32x16_bf16 v[64:79], v[120:123], v[124:127], v[64:79]
    ds_read_b64 v[108:109], v5 offset:3040
    ds_read_b64 v[110:111], v5 offset:3048
    ds_read_b128 v[116:119], v6 offset:6352
    ds_read_b128 v[112:115], v6 offset:3792
    s_waitcnt lgkmcnt(8)
    v_mfma_f32_32x32x16_bf16 v[80:95], v[132:135], v[140:143], v[80:95]
    v_mfma_f32_32x32x16_bf16 v[64:79], v[132:135], v[136:139], v[64:79]
    ds_read_b64 v[120:121], v5 offset:2944
    ds_read_b64 v[122:123], v5 offset:2952
    ds_read_b128 v[128:131], v6 offset:6240
    ds_read_b128 v[124:127], v6 offset:3680
    s_waitcnt lgkmcnt(8)
    v_mfma_f32_32x32x16_bf16 v[80:95], v[96:99], v[104:107], v[80:95]
    v_mfma_f32_32x32x16_bf16 v[64:79], v[96:99], v[100:103], v[64:79]
    ds_read_b64 v[132:133], v5 offset:2976
    ds_read_b64 v[134:135], v5 offset:2984
    ds_read_b128 v[140:143], v6 offset:6272
    ds_read_b128 v[136:139], v6 offset:3712
    s_waitcnt lgkmcnt(8)
    v_mfma_f32_32x32x16_bf16 v[80:95], v[108:111], v[116:119], v[80:95]
    v_mfma_f32_32x32x16_bf16 v[64:79], v[108:111], v[112:115], v[64:79]
    ds_read_b64 v[96:97], v5 offset:2880
    ds_read_b64 v[98:99], v5 offset:2888
    ds_read_b128 v[104:107], v6 offset:6160
    ds_read_b128 v[100:103], v6 offset:3600
    s_waitcnt lgkmcnt(8)
    v_mfma_f32_32x32x16_bf16 v[80:95], v[120:123], v[128:131], v[80:95]
    v_mfma_f32_32x32x16_bf16 v[64:79], v[120:123], v[124:127], v[64:79]
    ds_read_b64 v[108:109], v5 offset:2912
    ds_read_b64 v[110:111], v5 offset:2920
    ds_read_b128 v[116:119], v6 offset:6192
    ds_read_b128 v[112:115], v6 offset:3632
    s_waitcnt lgkmcnt(8)
    v_mfma_f32_32x32x16_bf16 v[80:95], v[132:135], v[140:143], v[80:95]
    v_mfma_f32_32x32x16_bf16 v[64:79], v[132:135], v[136:139], v[64:79]
    ds_read_b64 v[120:121], v5 offset:2816
    ds_read_b64 v[122:123], v5 offset:2824
    ds_read_b128 v[128:131], v6 offset:6080
    ds_read_b128 v[124:127], v6 offset:3520
    s_waitcnt lgkmcnt(8)
    v_mfma_f32_32x32x16_bf16 v[80:95], v[96:99], v[104:107], v[80:95]
    v_mfma_f32_32x32x16_bf16 v[64:79], v[96:99], v[100:103], v[64:79]
    ds_read_b64 v[132:133], v5 offset:2848
    ds_read_b64 v[134:135], v5 offset:2856
    ds_read_b128 v[140:143], v6 offset:6112
    ds_read_b128 v[136:139], v6 offset:3552
    s_waitcnt lgkmcnt(8)
    v_mfma_f32_32x32x16_bf16 v[80:95], v[108:111], v[116:119], v[80:95]
    v_mfma_f32_32x32x16_bf16 v[64:79], v[108:111], v[112:115], v[64:79]
    ds_read_b64 v[96:97], v5 offset:2752
    ds_read_b64 v[98:99], v5 offset:2760
    ds_read_b128 v[104:107], v6 offset:6000
    ds_read_b128 v[100:103], v6 offset:3440
    s_waitcnt lgkmcnt(8)
    v_mfma_f32_32x32x16_bf16 v[80:95], v[120:123], v[128:131], v[80:95]
    v_mfma_f32_32x32x16_bf16 v[64:79], v[120:123], v[124:127], v[64:79]
    ds_read_b64 v[108:109], v5 offset:2784
    ds_read_b64 v[110:111], v5 offset:2792
    ds_read_b128 v[116:119], v6 offset:6032
    ds_read_b128 v[112:115], v6 offset:3472
    s_waitcnt lgkmcnt(8)
    v_mfma_f32_32x32x16_bf16 v[80:95], v[132:135], v[140:143], v[80:95]
    v_mfma_f32_32x32x16_bf16 v[64:79], v[132:135], v[136:139], v[64:79]
    ds_read_b64 v[120:121], v5 offset:2688
    ds_read_b64 v[122:123], v5 offset:2696
    ds_read_b128 v[128:131], v6 offset:5920
    ds_read_b128 v[124:127], v6 offset:3360
    s_waitcnt lgkmcnt(8)
    v_mfma_f32_32x32x16_bf16 v[80:95], v[96:99], v[104:107], v[80:95]
    v_mfma_f32_32x32x16_bf16 v[64:79], v[96:99], v[100:103], v[64:79]
    ds_read_b64 v[132:133], v5 offset:2720
    ds_read_b64 v[134:135], v5 offset:2728
    ds_read_b128 v[140:143], v6 offset:5952
    ds_read_b128 v[136:139], v6 offset:3392
    s_waitcnt lgkmcnt(8)
    v_mfma_f32_32x32x16_bf16 v[80:95], v[108:111], v[116:119], v[80:95]
    v_mfma_f32_32x32x16_bf16 v[64:79], v[108:111], v[112:115], v[64:79]
    ds_read_b64 v[96:97], v5 offset:2624
    ds_read_b64 v[98:99], v5 offset:2632
    ds_read_b128 v[104:107], v6 offset:5840
    ds_read_b128 v[100:103], v6 offset:3280
    s_waitcnt lgkmcnt(8)
    v_mfma_f32_32x32x16_bf16 v[80:95], v[120:123], v[128:131], v[80:95]
    v_mfma_f32_32x32x16_bf16 v[64:79], v[120:123], v[124:127], v[64:79]
    ds_read_b64 v[108:109], v5 offset:2656
    ds_read_b64 v[110:111], v5 offset:2664
    ds_read_b128 v[116:119], v6 offset:5872
    ds_read_b128 v[112:115], v6 offset:3312
    s_waitcnt lgkmcnt(8)
    v_mfma_f32_32x32x16_bf16 v[80:95], v[132:135], v[140:143], v[80:95]
    v_mfma_f32_32x32x16_bf16 v[64:79], v[132:135], v[136:139], v[64:79]
    ds_read_b64 v[120:121], v5 offset:2560
    ds_read_b64 v[122:123], v5 offset:2568
    ds_read_b128 v[128:131], v6 offset:5760
    ds_read_b128 v[124:127], v6 offset:3200
    s_waitcnt lgkmcnt(8)
    v_mfma_f32_32x32x16_bf16 v[80:95], v[96:99], v[104:107], v[80:95]
    v_mfma_f32_32x32x16_bf16 v[64:79], v[96:99], v[100:103], v[64:79]
    ds_read_b64 v[132:133], v5 offset:2592
    ds_read_b64 v[134:135], v5 offset:2600
    ds_read_b128 v[140:143], v6 offset:5792
    ds_read_b128 v[136:139], v6 offset:3232
    s_waitcnt lgkmcnt(8)
    v_mfma_f32_32x32x16_bf16 v[80:95], v[108:111], v[116:119], v[80:95]
    v_mfma_f32_32x32x16_bf16 v[64:79], v[108:111], v[112:115], v[64:79]
    ds_read_b64 v[96:97], v5 offset:2496
    ds_read_b64 v[98:99], v5 offset:2504
    ds_read_b128 v[104:107], v6 offset:5680
    ds_read_b128 v[100:103], v6 offset:3120
    s_waitcnt lgkmcnt(8)
    v_mfma_f32_32x32x16_bf16 v[80:95], v[120:123], v[128:131], v[80:95]
    v_mfma_f32_32x32x16_bf16 v[64:79], v[120:123], v[124:127], v[64:79]
    ds_read_b64 v[108:109], v5 offset:2528
    ds_read_b64 v[110:111], v5 offset:2536
    ds_read_b128 v[116:119], v6 offset:5712
    ds_read_b128 v[112:115], v6 offset:3152
    s_waitcnt lgkmcnt(8)
    v_mfma_f32_32x32x16_bf16 v[80:95], v[132:135], v[140:143], v[80:95]
    v_mfma_f32_32x32x16_bf16 v[64:79], v[132:135], v[136:139], v[64:79]
    ds_read_b64 v[120:121], v5 offset:2432
    ds_read_b64 v[122:123], v5 offset:2440
    ds_read_b128 v[128:131], v6 offset:5600
    ds_read_b128 v[124:127], v6 offset:3040
    s_waitcnt lgkmcnt(8)
    v_mfma_f32_32x32x16_bf16 v[80:95], v[96:99], v[104:107], v[80:95]
    v_mfma_f32_32x32x16_bf16 v[64:79], v[96:99], v[100:103], v[64:79]
    ds_read_b64 v[132:133], v5 offset:2464
    ds_read_b64 v[134:135], v5 offset:2472
    ds_read_b128 v[140:143], v6 offset:5632
    ds_read_b128 v[136:139], v6 offset:3072
    s_waitcnt lgkmcnt(8)
    v_mfma_f32_32x32x16_bf16 v[80:95], v[108:111], v[116:119], v[80:95]
    v_mfma_f32_32x32x16_bf16 v[64:79], v[108:111], v[112:115], v[64:79]
    ds_read_b64 v[96:97], v5 offset:2368
    ds_read_b64 v[98:99], v5 offset:2376
    ds_read_b128 v[104:107], v6 offset:5520
    ds_read_b128 v[100:103], v6 offset:2960
    s_waitcnt lgkmcnt(8)
    v_mfma_f32_32x32x16_bf16 v[80:95], v[120:123], v[128:131], v[80:95]
    v_mfma_f32_32x32x16_bf16 v[64:79], v[120:123], v[124:127], v[64:79]
    ds_read_b64 v[108:109], v5 offset:2400
    ds_read_b64 v[110:111], v5 offset:2408
    ds_read_b128 v[116:119], v6 offset:5552
    ds_read_b128 v[112:115], v6 offset:2992
    s_waitcnt lgkmcnt(8)
    v_mfma_f32_32x32x16_bf16 v[80:95], v[132:135], v[140:143], v[80:95]
    v_mfma_f32_32x32x16_bf16 v[64:79], v[132:135], v[136:139], v[64:79]
    ds_read_b64 v[120:121], v5 offset:2304
    ds_read_b64 v[122:123], v5 offset:2312
    ds_read_b128 v[128:131], v6 offset:5440
    ds_read_b128 v[124:127], v6 offset:2880
    s_waitcnt lgkmcnt(8)
    v_mfma_f32_32x32x16_bf16 v[80:95], v[96:99], v[104:107], v[80:95]
    v_mfma_f32_32x32x16_bf16 v[64:79], v[96:99], v[100:103], v[64:79]
    ds_read_b64 v[132:133], v5 offset:2336
    ds_read_b64 v[134:135], v5 offset:2344
    ds_read_b128 v[140:143], v6 offset:5472
    ds_read_b128 v[136:139], v6 offset:2912
    s_waitcnt lgkmcnt(8)
    v_mfma_f32_32x32x16_bf16 v[80:95], v[108:111], v[116:119], v[80:95]
    v_mfma_f32_32x32x16_bf16 v[64:79], v[108:111], v[112:115], v[64:79]
    ds_read_b64 v[96:97], v5 offset:2240
    ds_read_b64 v[98:99], v5 offset:2248
    ds_read_b128 v[104:107], v6 offset:5360
    ds_read_b128 v[100:103], v6 offset:2800
    s_waitcnt lgkmcnt(8)
    v_mfma_f32_32x32x16_bf16 v[80:95], v[120:123], v[128:131], v[80:95]
    v_mfma_f32_32x32x16_bf16 v[64:79], v[120:123], v[124:127], v[64:79]
    ds_read_b64 v[108:109], v5 offset:2272
    ds_read_b64 v[110:111], v5 offset:2280
    ds_read_b128 v[116:119], v6 offset:5392
    ds_read_b128 v[112:115], v6 offset:2832
    s_waitcnt lgkmcnt(8)
    v_mfma_f32_32x32x16_bf16 v[80:95], v[132:135], v[140:143], v[80:95]
    v_mfma_f32_32x32x16_bf16 v[64:79], v[132:135], v[136:139], v[64:79]
    ds_read_b64 v[120:121], v5 offset:2176
    ds_read_b64 v[122:123], v5 offset:2184
    ds_read_b128 v[128:131], v6 offset:5280
    ds_read_b128 v[124:127], v6 offset:2720
    s_waitcnt lgkmcnt(8)
    v_mfma_f32_32x32x16_bf16 v[80:95], v[96:99], v[104:107], v[80:95]
    v_mfma_f32_32x32x16_bf16 v[64:79], v[96:99], v[100:103], v[64:79]
    ds_read_b64 v[132:133], v5 offset:2208
    ds_read_b64 v[134:135], v5 offset:2216
    ds_read_b128 v[140:143], v6 offset:5312
    ds_read_b128 v[136:139], v6 offset:2752
    s_waitcnt lgkmcnt(8)
    v_mfma_f32_32x32x16_bf16 v[80:95], v[108:111], v[116:119], v[80:95]
    v_mfma_f32_32x32x16_bf16 v[64:79], v[108:111], v[112:115], v[64:79]
    ds_read_b64 v[96:97], v5 offset:2112
    ds_read_b64 v[98:99], v5 offset:2120
    ds_read_b128 v[104:107], v6 offset:5200
    ds_read_b128 v[100:103], v6 offset:2640
    s_waitcnt lgkmcnt(8)
    v_mfma_f32_32x32x16_bf16 v[80:95], v[120:123], v[128:131], v[80:95]
    v_mfma_f32_32x32x16_bf16 v[64:79], v[120:123], v[124:127], v[64:79]
    ds_read_b64 v[108:109], v5 offset:2144
    ds_read_b64 v[110:111], v5 offset:2152
    ds_read_b128 v[116:119], v6 offset:5232
    ds_read_b128 v[112:115], v6 offset:2672
    s_waitcnt lgkmcnt(8)
    v_mfma_f32_32x32x16_bf16 v[80:95], v[132:135], v[140:143], v[80:95]
    v_mfma_f32_32x32x16_bf16 v[64:79], v[132:135], v[136:139], v[64:79]
    ds_read_b64 v[120:121], v5 offset:2048
    ds_read_b64 v[122:123], v5 offset:2056
    ds_read_b128 v[128:131], v6 offset:5120
    ds_read_b128 v[124:127], v6 offset:2560
    s_waitcnt lgkmcnt(8)
    v_mfma_f32_32x32x16_bf16 v[80:95], v[96:99], v[104:107], v[80:95]
    v_mfma_f32_32x32x16_bf16 v[64:79], v[96:99], v[100:103], v[64:79]
    ds_read_b64 v[132:133], v5 offset:2080
    ds_read_b64 v[134:135], v5 offset:2088
    ds_read_b128 v[140:143], v6 offset:5152
    ds_read_b128 v[136:139], v6 offset:2592
    s_waitcnt lgkmcnt(8)
    v_mfma_f32_32x32x16_bf16 v[80:95], v[108:111], v[116:119], v[80:95]
    v_mfma_f32_32x32x16_bf16 v[64:79], v[108:111], v[112:115], v[64:79]
    ds_read_b64 v[96:97], v5 offset:1984
    ds_read_b64 v[98:99], v5 offset:1992
    ds_read_b128 v[104:107], v6 offset:5040
    s_waitcnt lgkmcnt(7)
    v_mfma_f32_32x32x16_bf16 v[80:95], v[120:123], v[128:131], v[80:95]
    v_mfma_f32_32x32x16_bf16 v[64:79], v[120:123], v[124:127], v[64:79]
    ds_read_b64 v[108:109], v5 offset:2016
    ds_read_b64 v[110:111], v5 offset:2024
    ds_read_b128 v[116:119], v6 offset:5072
    s_waitcnt lgkmcnt(6)
    v_mfma_f32_32x32x16_bf16 v[80:95], v[132:135], v[140:143], v[80:95]
    v_mfma_f32_32x32x16_bf16 v[64:79], v[132:135], v[136:139], v[64:79]
    ds_read_b64 v[120:121], v5 offset:1920
    ds_read_b64 v[122:123], v5 offset:1928
    ds_read_b128 v[128:131], v6 offset:4960
    s_waitcnt lgkmcnt(6)
    v_mfma_f32_32x32x16_bf16 v[80:95], v[96:99], v[104:107], v[80:95]
    ds_read_b64 v[132:133], v5 offset:1952
    ds_read_b64 v[134:135], v5 offset:1960
    ds_read_b128 v[140:143], v6 offset:4992
    s_waitcnt lgkmcnt(6)
    v_mfma_f32_32x32x16_bf16 v[80:95], v[108:111], v[116:119], v[80:95]
    ds_read_b64 v[96:97], v5 offset:1856
    ds_read_b64 v[98:99], v5 offset:1864
    ds_read_b128 v[104:107], v6 offset:4880
    s_waitcnt lgkmcnt(6)
    v_mfma_f32_32x32x16_bf16 v[80:95], v[120:123], v[128:131], v[80:95]
    ds_read_b64 v[108:109], v5 offset:1888
    ds_read_b64 v[110:111], v5 offset:1896
    ds_read_b128 v[116:119], v6 offset:4912
    s_waitcnt lgkmcnt(6)
    v_mfma_f32_32x32x16_bf16 v[80:95], v[132:135], v[140:143], v[80:95]
    ds_read_b64 v[120:121], v5 offset:1792
    ds_read_b64 v[122:123], v5 offset:1800
    ds_read_b128 v[128:131], v6 offset:4800
    s_waitcnt lgkmcnt(6)
    v_mfma_f32_32x32x16_bf16 v[80:95], v[96:99], v[104:107], v[80:95]
    ds_read_b64 v[132:133], v5 offset:1824
    ds_read_b64 v[134:135], v5 offset:1832
    ds_read_b128 v[140:143], v6 offset:4832
    s_waitcnt lgkmcnt(6)
    v_mfma_f32_32x32x16_bf16 v[80:95], v[108:111], v[116:119], v[80:95]
    ds_read_b64 v[96:97], v5 offset:1728
    ds_read_b64 v[98:99], v5 offset:1736
    ds_read_b128 v[104:107], v6 offset:4720
    s_waitcnt lgkmcnt(6)
    v_mfma_f32_32x32x16_bf16 v[80:95], v[120:123], v[128:131], v[80:95]
    ds_read_b64 v[108:109], v5 offset:1760
    ds_read_b64 v[110:111], v5 offset:1768
    ds_read_b128 v[116:119], v6 offset:4752
    s_waitcnt lgkmcnt(6)
    v_mfma_f32_32x32x16_bf16 v[80:95], v[132:135], v[140:143], v[80:95]
    ds_read_b64 v[120:121], v5 offset:1664
    ds_read_b64 v[122:123], v5 offset:1672
    ds_read_b128 v[128:131], v6 offset:4640
    s_waitcnt lgkmcnt(6)
    v_mfma_f32_32x32x16_bf16 v[80:95], v[96:99], v[104:107], v[80:95]
    ds_read_b64 v[132:133], v5 offset:1696
    ds_read_b64 v[134:135], v5 offset:1704
    ds_read_b128 v[140:143], v6 offset:4672
    s_waitcnt lgkmcnt(6)
    v_mfma_f32_32x32x16_bf16 v[80:95], v[108:111], v[116:119], v[80:95]
    ds_read_b64 v[96:97], v5 offset:1600
    ds_read_b64 v[98:99], v5 offset:1608
    ds_read_b128 v[104:107], v6 offset:4560
    s_waitcnt lgkmcnt(6)
    v_mfma_f32_32x32x16_bf16 v[80:95], v[120:123], v[128:131], v[80:95]
    ds_read_b64 v[108:109], v5 offset:1632
    ds_read_b64 v[110:111], v5 offset:1640
    ds_read_b128 v[116:119], v6 offset:4592
    s_waitcnt lgkmcnt(6)
    v_mfma_f32_32x32x16_bf16 v[80:95], v[132:135], v[140:143], v[80:95]
    ds_read_b64 v[120:121], v5 offset:1536
    ds_read_b64 v[122:123], v5 offset:1544
    ds_read_b128 v[128:131], v6 offset:4480
    s_waitcnt lgkmcnt(6)
    v_mfma_f32_32x32x16_bf16 v[80:95], v[96:99], v[104:107], v[80:95]
    ds_read_b64 v[132:133], v5 offset:1568
    ds_read_b64 v[134:135], v5 offset:1576
    ds_read_b128 v[140:143], v6 offset:4512
    s_waitcnt lgkmcnt(6)
    v_mfma_f32_32x32x16_bf16 v[80:95], v[108:111], v[116:119], v[80:95]
    ds_read_b64 v[96:97], v5 offset:1472
    ds_read_b64 v[98:99], v5 offset:1480
    ds_read_b128 v[104:107], v6 offset:4400
    s_waitcnt lgkmcnt(6)
    v_mfma_f32_32x32x16_bf16 v[80:95], v[120:123], v[128:131], v[80:95]
    ds_read_b64 v[108:109], v5 offset:1504
    ds_read_b64 v[110:111], v5 offset:1512
    ds_read_b128 v[116:119], v6 offset:4432
    s_waitcnt lgkmcnt(6)
    v_mfma_f32_32x32x16_bf16 v[80:95], v[132:135], v[140:143], v[80:95]
    ds_read_b64 v[120:121], v5 offset:1408
    ds_read_b64 v[122:123], v5 offset:1416
    ds_read_b128 v[128:131], v6 offset:4320
    s_waitcnt lgkmcnt(6)
    v_mfma_f32_32x32x16_bf16 v[80:95], v[96:99], v[104:107], v[80:95]
    ds_read_b64 v[132:133], v5 offset:1440
    ds_read_b64 v[134:135], v5 offset:1448
    ds_read_b128 v[140:143], v6 offset:4352
    s_waitcnt lgkmcnt(6)
    v_mfma_f32_32x32x16_bf16 v[80:95], v[108:111], v[116:119], v[80:95]
    ds_read_b64 v[96:97], v5 offset:1344
    ds_read_b64 v[98:99], v5 offset:1352
    ds_read_b128 v[104:107], v6 offset:4240
    s_waitcnt lgkmcnt(6)
    v_mfma_f32_32x32x16_bf16 v[80:95], v[120:123], v[128:131], v[80:95]
    ds_read_b64 v[108:109], v5 offset:1376
    ds_read_b64 v[110:111], v5 offset:1384
    ds_read_b128 v[116:119], v6 offset:4272
    s_waitcnt lgkmcnt(6)
    v_mfma_f32_32x32x16_bf16 v[80:95], v[132:135], v[140:143], v[80:95]
    ds_read_b64 v[120:121], v5 offset:1280
    ds_read_b64 v[122:123], v5 offset:1288
    ds_read_b128 v[128:131], v6 offset:4160
    s_waitcnt lgkmcnt(6)
    v_mfma_f32_32x32x16_bf16 v[80:95], v[96:99], v[104:107], v[80:95]
    ds_read_b64 v[132:133], v5 offset:1312
    ds_read_b64 v[134:135], v5 offset:1320
    ds_read_b128 v[140:143], v6 offset:4192
    s_waitcnt lgkmcnt(6)
    v_mfma_f32_32x32x16_bf16 v[80:95], v[108:111], v[116:119], v[80:95]
    ds_read_b64 v[96:97], v5 offset:1216
    ds_read_b64 v[98:99], v5 offset:1224
    ds_read_b128 v[104:107], v6 offset:4080
    s_waitcnt lgkmcnt(6)
    v_mfma_f32_32x32x16_bf16 v[80:95], v[120:123], v[128:131], v[80:95]
    ds_read_b64 v[108:109], v5 offset:1248
    ds_read_b64 v[110:111], v5 offset:1256
    ds_read_b128 v[116:119], v6 offset:4112
    s_waitcnt lgkmcnt(6)
    v_mfma_f32_32x32x16_bf16 v[80:95], v[132:135], v[140:143], v[80:95]
    ds_read_b64 v[120:121], v5 offset:1152
    ds_read_b64 v[122:123], v5 offset:1160
    ds_read_b128 v[128:131], v6 offset:4000
    s_waitcnt lgkmcnt(6)
    v_mfma_f32_32x32x16_bf16 v[80:95], v[96:99], v[104:107], v[80:95]
    ds_read_b64 v[132:133], v5 offset:1184
    ds_read_b64 v[134:135], v5 offset:1192
    ds_read_b128 v[140:143], v6 offset:4032
    s_waitcnt lgkmcnt(6)
    v_mfma_f32_32x32x16_bf16 v[80:95], v[108:111], v[116:119], v[80:95]
    ds_read_b64 v[96:97], v5 offset:1088
    ds_read_b64 v[98:99], v5 offset:1096
    ds_read_b128 v[104:107], v6 offset:3920
    s_waitcnt lgkmcnt(6)
    v_mfma_f32_32x32x16_bf16 v[80:95], v[120:123], v[128:131], v[80:95]
    ds_read_b64 v[108:109], v5 offset:1120
    ds_read_b64 v[110:111], v5 offset:1128
    ds_read_b128 v[116:119], v6 offset:3952
    s_waitcnt lgkmcnt(6)
    v_mfma_f32_32x32x16_bf16 v[80:95], v[132:135], v[140:143], v[80:95]
    ds_read_b64 v[120:121], v5 offset:1024
    ds_read_b64 v[122:123], v5 offset:1032
    ds_read_b128 v[128:131], v6 offset:3840
    s_waitcnt lgkmcnt(6)
    v_mfma_f32_32x32x16_bf16 v[80:95], v[96:99], v[104:107], v[80:95]
    ds_read_b64 v[132:133], v5 offset:1056
    ds_read_b64 v[134:135], v5 offset:1064
    ds_read_b128 v[140:143], v6 offset:3872
    s_waitcnt lgkmcnt(6)
    v_mfma_f32_32x32x16_bf16 v[80:95], v[108:111], v[116:119], v[80:95]
    ds_read_b64 v[96:97], v5 offset:960
    ds_read_b64 v[98:99], v5 offset:968
    ds_read_b128 v[104:107], v6 offset:3760
    s_waitcnt lgkmcnt(6)
    v_mfma_f32_32x32x16_bf16 v[80:95], v[120:123], v[128:131], v[80:95]
    ds_read_b64 v[108:109], v5 offset:992
    ds_read_b64 v[110:111], v5 offset:1000
    ds_read_b128 v[116:119], v6 offset:3792
    s_waitcnt lgkmcnt(6)
    v_mfma_f32_32x32x16_bf16 v[80:95], v[132:135], v[140:143], v[80:95]
    ds_read_b64 v[120:121], v5 offset:896
    ds_read_b64 v[122:123], v5 offset:904
    ds_read_b128 v[128:131], v6 offset:3680
    s_waitcnt lgkmcnt(6)
    v_mfma_f32_32x32x16_bf16 v[80:95], v[96:99], v[104:107], v[80:95]
    ds_read_b64 v[132:133], v5 offset:928
    ds_read_b64 v[134:135], v5 offset:936
    ds_read_b128 v[140:143], v6 offset:3712
    s_waitcnt lgkmcnt(6)
    v_mfma_f32_32x32x16_bf16 v[80:95], v[108:111], v[116:119], v[80:95]
    ds_read_b64 v[96:97], v5 offset:832
    ds_read_b64 v[98:99], v5 offset:840
    ds_read_b128 v[104:107], v6 offset:3600
    s_waitcnt lgkmcnt(6)
    v_mfma_f32_32x32x16_bf16 v[80:95], v[120:123], v[128:131], v[80:95]
    ds_read_b64 v[108:109], v5 offset:864
    ds_read_b64 v[110:111], v5 offset:872
    ds_read_b128 v[116:119], v6 offset:3632
    s_waitcnt lgkmcnt(6)
    v_mfma_f32_32x32x16_bf16 v[80:95], v[132:135], v[140:143], v[80:95]
    ds_read_b64 v[120:121], v5 offset:768
    ds_read_b64 v[122:123], v5 offset:776
    ds_read_b128 v[128:131], v6 offset:3520
    s_waitcnt lgkmcnt(6)
    v_mfma_f32_32x32x16_bf16 v[80:95], v[96:99], v[104:107], v[80:95]
    ds_read_b64 v[132:133], v5 offset:800
    ds_read_b64 v[134:135], v5 offset:808
    ds_read_b128 v[140:143], v6 offset:3552
    s_waitcnt lgkmcnt(6)
    v_mfma_f32_32x32x16_bf16 v[80:95], v[108:111], v[116:119], v[80:95]
    ds_read_b64 v[96:97], v5 offset:704
    ds_read_b64 v[98:99], v5 offset:712
    ds_read_b128 v[104:107], v6 offset:3440
    s_waitcnt lgkmcnt(6)
    v_mfma_f32_32x32x16_bf16 v[80:95], v[120:123], v[128:131], v[80:95]
    ds_read_b64 v[108:109], v5 offset:736
    ds_read_b64 v[110:111], v5 offset:744
    ds_read_b128 v[116:119], v6 offset:3472
    s_waitcnt lgkmcnt(6)
    v_mfma_f32_32x32x16_bf16 v[80:95], v[132:135], v[140:143], v[80:95]
    ds_read_b64 v[120:121], v5 offset:640
    ds_read_b64 v[122:123], v5 offset:648
    ds_read_b128 v[128:131], v6 offset:3360
    s_waitcnt lgkmcnt(6)
    v_mfma_f32_32x32x16_bf16 v[80:95], v[96:99], v[104:107], v[80:95]
    ds_read_b64 v[132:133], v5 offset:672
    ds_read_b64 v[134:135], v5 offset:680
    ds_read_b128 v[140:143], v6 offset:3392
    s_waitcnt lgkmcnt(6)
    v_mfma_f32_32x32x16_bf16 v[80:95], v[108:111], v[116:119], v[80:95]
    ds_read_b64 v[96:97], v5 offset:576
    ds_read_b64 v[98:99], v5 offset:584
    ds_read_b128 v[104:107], v6 offset:3280
    s_waitcnt lgkmcnt(6)
    v_mfma_f32_32x32x16_bf16 v[80:95], v[120:123], v[128:131], v[80:95]
    ds_read_b64 v[108:109], v5 offset:608
    ds_read_b64 v[110:111], v5 offset:616
    ds_read_b128 v[116:119], v6 offset:3312
    s_waitcnt lgkmcnt(6)
    v_mfma_f32_32x32x16_bf16 v[80:95], v[132:135], v[140:143], v[80:95]
    ds_read_b64 v[120:121], v5 offset:512
    ds_read_b64 v[122:123], v5 offset:520
    ds_read_b128 v[128:131], v6 offset:3200
    s_waitcnt lgkmcnt(6)
    v_mfma_f32_32x32x16_bf16 v[80:95], v[96:99], v[104:107], v[80:95]
    ds_read_b64 v[132:133], v5 offset:544
    ds_read_b64 v[134:135], v5 offset:552
    ds_read_b128 v[140:143], v6 offset:3232
    s_waitcnt lgkmcnt(6)
    v_mfma_f32_32x32x16_bf16 v[80:95], v[108:111], v[116:119], v[80:95]
    ds_read_b64 v[96:97], v5 offset:448
    ds_read_b64 v[98:99], v5 offset:456
    ds_read_b128 v[104:107], v6 offset:3120
    s_waitcnt lgkmcnt(6)
    v_mfma_f32_32x32x16_bf16 v[80:95], v[120:123], v[128:131], v[80:95]
    ds_read_b64 v[108:109], v5 offset:480
    ds_read_b64 v[110:111], v5 offset:488
    ds_read_b128 v[116:119], v6 offset:3152
    s_waitcnt lgkmcnt(6)
    v_mfma_f32_32x32x16_bf16 v[80:95], v[132:135], v[140:143], v[80:95]
    ds_read_b64 v[120:121], v5 offset:384
    ds_read_b64 v[122:123], v5 offset:392
    ds_read_b128 v[128:131], v6 offset:3040
    s_waitcnt lgkmcnt(6)
    v_mfma_f32_32x32x16_bf16 v[80:95], v[96:99], v[104:107], v[80:95]
    ds_read_b64 v[132:133], v5 offset:416
    ds_read_b64 v[134:135], v5 offset:424
    ds_read_b128 v[140:143], v6 offset:3072
    s_waitcnt lgkmcnt(6)
    v_mfma_f32_32x32x16_bf16 v[80:95], v[108:111], v[116:119], v[80:95]
    ds_read_b64 v[96:97], v5 offset:320
    ds_read_b64 v[98:99], v5 offset:328
    ds_read_b128 v[104:107], v6 offset:2960
    s_waitcnt lgkmcnt(6)
    v_mfma_f32_32x32x16_bf16 v[80:95], v[120:123], v[128:131], v[80:95]
    ds_read_b64 v[108:109], v5 offset:352
    ds_read_b64 v[110:111], v5 offset:360
    ds_read_b128 v[116:119], v6 offset:2992
    s_waitcnt lgkmcnt(6)
    v_mfma_f32_32x32x16_bf16 v[80:95], v[132:135], v[140:143], v[80:95]
    ds_read_b64 v[120:121], v5 offset:256
    ds_read_b64 v[122:123], v5 offset:264
    ds_read_b128 v[128:131], v6 offset:2880
    s_waitcnt lgkmcnt(6)
    v_mfma_f32_32x32x16_bf16 v[80:95], v[96:99], v[104:107], v[80:95]
    ds_read_b64 v[132:133], v5 offset:288
    ds_read_b64 v[134:135], v5 offset:296
    ds_read_b128 v[140:143], v6 offset:2912
    s_waitcnt lgkmcnt(6)
    v_mfma_f32_32x32x16_bf16 v[80:95], v[108:111], v[116:119], v[80:95]
    ds_read_b64 v[96:97], v5 offset:192
    ds_read_b64 v[98:99], v5 offset:200
    ds_read_b128 v[104:107], v6 offset:2800
    s_waitcnt lgkmcnt(6)
    v_mfma_f32_32x32x16_bf16 v[80:95], v[120:123], v[128:131], v[80:95]
    ds_read_b64 v[108:109], v5 offset:224
    ds_read_b64 v[110:111], v5 offset:232
    ds_read_b128 v[116:119], v6 offset:2832
    s_waitcnt lgkmcnt(6)
    v_mfma_f32_32x32x16_bf16 v[80:95], v[132:135], v[140:143], v[80:95]
    ds_read_b64 v[120:121], v5 offset:128
    ds_read_b64 v[122:123], v5 offset:136
    ds_read_b128 v[128:131], v6 offset:2720
    s_waitcnt lgkmcnt(6)
    v_mfma_f32_32x32x16_bf16 v[80:95], v[96:99], v[104:107], v[80:95]
    ds_read_b64 v[132:133], v5 offset:160
    ds_read_b64 v[134:135], v5 offset:168
    ds_read_b128 v[140:143], v6 offset:2752
    s_waitcnt lgkmcnt(6)
    v_mfma_f32_32x32x16_bf16 v[80:95], v[108:111], v[116:119], v[80:95]
    ds_read_b64 v[96:97], v5 offset:64
    ds_read_b64 v[98:99], v5 offset:72
    ds_read_b128 v[104:107], v6 offset:2640
    s_waitcnt lgkmcnt(6)
    v_mfma_f32_32x32x16_bf16 v[80:95], v[120:123], v[128:131], v[80:95]
    ds_read_b64 v[108:109], v5 offset:96
    ds_read_b64 v[110:111], v5 offset:104
    ds_read_b128 v[116:119], v6 offset:2672
    s_waitcnt lgkmcnt(6)
    v_mfma_f32_32x32x16_bf16 v[80:95], v[132:135], v[140:143], v[80:95]
    ds_read_b64 v[120:121], v5 offset:0
    ds_read_b64 v[122:123], v5 offset:8
    ds_read_b128 v[128:131], v6 offset:2560
    s_waitcnt lgkmcnt(6)
    v_mfma_f32_32x32x16_bf16 v[80:95], v[96:99], v[104:107], v[80:95]
    ds_read_b64 v[132:133], v5 offset:32
    ds_read_b64 v[134:135], v5 offset:40
    ds_read_b128 v[140:143], v6 offset:2592
    s_waitcnt lgkmcnt(6)
    v_mfma_f32_32x32x16_bf16 v[80:95], v[108:111], v[116:119], v[80:95]
    s_waitcnt lgkmcnt(3)
    v_mfma_f32_32x32x16_bf16 v[80:95], v[120:123], v[128:131], v[80:95]
    s_waitcnt lgkmcnt(0)
    v_mfma_f32_32x32x16_bf16 v[80:95], v[132:135], v[140:143], v[80:95]
    s_nop 15
    s_barrier
    v_mul_u32_u24 v7, 264, v3
    v_lshl_add_u32 v7, v4, 5, v7
    s_lshl_b32 s3, s42, 1
    v_add_u32 v7, s3, v7
    v_cvt_pk_bf16_f32 v8, v64, v65
    ds_write_b16 v7, v8 offset:40960
    ds_write_b16_d16_hi v7, v8 offset:40968
    v_cvt_pk_bf16_f32 v8, v66, v67
    ds_write_b16 v7, v8 offset:40976
    ds_write_b16_d16_hi v7, v8 offset:40984
    v_cvt_pk_bf16_f32 v8, v68, v69
    ds_write_b16 v7, v8 offset:41024
    ds_write_b16_d16_hi v7, v8 offset:41032
    v_cvt_pk_bf16_f32 v8, v70, v71
    ds_write_b16 v7, v8 offset:41040
    ds_write_b16_d16_hi v7, v8 offset:41048
    v_cvt_pk_bf16_f32 v8, v72, v73
    ds_write_b16 v7, v8 offset:41088
    ds_write_b16_d16_hi v7, v8 offset:41096
    v_cvt_pk_bf16_f32 v8, v74, v75
    ds_write_b16 v7, v8 offset:41104
    ds_write_b16_d16_hi v7, v8 offset:41112
    v_cvt_pk_bf16_f32 v8, v76, v77
    ds_write_b16 v7, v8 offset:41152
    ds_write_b16_d16_hi v7, v8 offset:41160
    v_cvt_pk_bf16_f32 v8, v78, v79
    ds_write_b16 v7, v8 offset:41168
    ds_write_b16_d16_hi v7, v8 offset:41176
    v_cvt_pk_bf16_f32 v8, v80, v81
    ds_write_b16 v7, v8 offset:49408
    ds_write_b16_d16_hi v7, v8 offset:49416
    v_cvt_pk_bf16_f32 v8, v82, v83
    ds_write_b16 v7, v8 offset:49424
    ds_write_b16_d16_hi v7, v8 offset:49432
    v_cvt_pk_bf16_f32 v8, v84, v85
    ds_write_b16 v7, v8 offset:49472
    ds_write_b16_d16_hi v7, v8 offset:49480
    v_cvt_pk_bf16_f32 v8, v86, v87
    ds_write_b16 v7, v8 offset:49488
    ds_write_b16_d16_hi v7, v8 offset:49496
    v_cvt_pk_bf16_f32 v8, v88, v89
    ds_write_b16 v7, v8 offset:49536
    ds_write_b16_d16_hi v7, v8 offset:49544
    v_cvt_pk_bf16_f32 v8, v90, v91
    ds_write_b16 v7, v8 offset:49552
    ds_write_b16_d16_hi v7, v8 offset:49560
    v_cvt_pk_bf16_f32 v8, v92, v93
    ds_write_b16 v7, v8 offset:49600
    ds_write_b16_d16_hi v7, v8 offset:49608
    v_cvt_pk_bf16_f32 v8, v94, v95
    ds_write_b16 v7, v8 offset:49616
    ds_write_b16_d16_hi v7, v8 offset:49624
    s_waitcnt lgkmcnt(0)
    s_barrier
    v_lshrrev_b32 v3, 5, v0
    v_lshlrev_b32 v4, 3, v0
    v_lshl_add_u32 v4, v3, 3, v4
    v_mul_u32_u24 v5, 80, v3
    v_and_b32 v6, 31, v0
    v_lshl_add_u32 v5, v6, 1, v5
    v_mul_u32_u24 v6, 1152, v0
    s_lshl_b32 s3, s2, 3
    v_add_u32 v6, s3, v6
    ds_read_b64 v[10:11], v4 offset:40960
    ds_read_u16 v12, v5 offset:5120
    ds_read_u16 v13, v5 offset:15360
    ds_read_u16 v14, v5 offset:25600
    ds_read_u16 v15, v5 offset:35840
    s_waitcnt lgkmcnt(0)
    v_lshlrev_b32 v12, 16, v12
    v_mul_f32 v12, s72, v12
    v_lshlrev_b32 v13, 16, v13
    v_mul_f32 v13, s73, v13
    v_lshlrev_b32 v14, 16, v14
    v_mul_f32 v14, s74, v14
    v_lshlrev_b32 v15, 16, v15
    v_mul_f32 v15, s75, v15
    v_cvt_pk_bf16_f32 v16, v12, v13
    v_lshlrev_b32 v12, 16, v16
    v_and_b32 v13, s40, v16
    v_cvt_pk_bf16_f32 v16, v14, v15
    v_lshlrev_b32 v14, 16, v16
    v_and_b32 v15, s40, v16
    v_lshlrev_b32 v17, 16, v10
    v_and_b32 v18, s40, v10
    v_lshlrev_b32 v19, 16, v11
    v_and_b32 v20, s40, v11
    v_add_f32 v12, v12, v17
    v_add_f32 v13, v13, v18
    v_add_f32 v14, v14, v19
    v_add_f32 v15, v15, v20
    v_cvt_pk_bf16_f32 v22, v12, v13
    v_cvt_pk_bf16_f32 v23, v14, v15
    buffer_store_dwordx2 v[22:23], v6, s[32:35], 0 offen
    s_nop 1
    ds_read_b64 v[10:11], v4 offset:43072
    ds_read_u16 v12, v5 offset:5760
    ds_read_u16 v13, v5 offset:16000
    ds_read_u16 v14, v5 offset:26240
    ds_read_u16 v15, v5 offset:36480
    s_waitcnt lgkmcnt(0)
    v_lshlrev_b32 v12, 16, v12
    v_mul_f32 v12, s72, v12
    v_lshlrev_b32 v13, 16, v13
    v_mul_f32 v13, s73, v13
    v_lshlrev_b32 v14, 16, v14
    v_mul_f32 v14, s74, v14
    v_lshlrev_b32 v15, 16, v15
    v_mul_f32 v15, s75, v15
    v_cvt_pk_bf16_f32 v16, v12, v13
    v_lshlrev_b32 v12, 16, v16
    v_and_b32 v13, s40, v16
    v_cvt_pk_bf16_f32 v16, v14, v15
    v_lshlrev_b32 v14, 16, v16
    v_and_b32 v15, s40, v16
    v_lshlrev_b32 v17, 16, v10
    v_and_b32 v18, s40, v10
    v_lshlrev_b32 v19, 16, v11
    v_and_b32 v20, s40, v11
    v_add_f32 v12, v12, v17
    v_add_f32 v13, v13, v18
    v_add_f32 v14, v14, v19
    v_add_f32 v15, v15, v20
    v_cvt_pk_bf16_f32 v22, v12, v13
    v_cvt_pk_bf16_f32 v23, v14, v15
    v_add_u32 v6, 294912, v6
    buffer_store_dwordx2 v[22:23], v6, s[32:35], 0 offen
    s_nop 1
    ds_read_b64 v[10:11], v4 offset:45184
    ds_read_u16 v12, v5 offset:6400
    ds_read_u16 v13, v5 offset:16640
    ds_read_u16 v14, v5 offset:26880
    ds_read_u16 v15, v5 offset:37120
    s_waitcnt lgkmcnt(0)
    v_lshlrev_b32 v12, 16, v12
    v_mul_f32 v12, s72, v12
    v_lshlrev_b32 v13, 16, v13
    v_mul_f32 v13, s73, v13
    v_lshlrev_b32 v14, 16, v14
    v_mul_f32 v14, s74, v14
    v_lshlrev_b32 v15, 16, v15
    v_mul_f32 v15, s75, v15
    v_cvt_pk_bf16_f32 v16, v12, v13
    v_lshlrev_b32 v12, 16, v16
    v_and_b32 v13, s40, v16
    v_cvt_pk_bf16_f32 v16, v14, v15
    v_lshlrev_b32 v14, 16, v16
    v_and_b32 v15, s40, v16
    v_lshlrev_b32 v17, 16, v10
    v_and_b32 v18, s40, v10
    v_lshlrev_b32 v19, 16, v11
    v_and_b32 v20, s40, v11
    v_add_f32 v12, v12, v17
    v_add_f32 v13, v13, v18
    v_add_f32 v14, v14, v19
    v_add_f32 v15, v15, v20
    v_cvt_pk_bf16_f32 v22, v12, v13
    v_cvt_pk_bf16_f32 v23, v14, v15
    v_add_u32 v6, 294912, v6
    buffer_store_dwordx2 v[22:23], v6, s[32:35], 0 offen
    s_nop 1
    ds_read_b64 v[10:11], v4 offset:47296
    ds_read_u16 v12, v5 offset:7040
    ds_read_u16 v13, v5 offset:17280
    ds_read_u16 v14, v5 offset:27520
    ds_read_u16 v15, v5 offset:37760
    s_waitcnt lgkmcnt(0)
    v_lshlrev_b32 v12, 16, v12
    v_mul_f32 v12, s72, v12
    v_lshlrev_b32 v13, 16, v13
    v_mul_f32 v13, s73, v13
    v_lshlrev_b32 v14, 16, v14
    v_mul_f32 v14, s74, v14
    v_lshlrev_b32 v15, 16, v15
    v_mul_f32 v15, s75, v15
    v_cvt_pk_bf16_f32 v16, v12, v13
    v_lshlrev_b32 v12, 16, v16
    v_and_b32 v13, s40, v16
    v_cvt_pk_bf16_f32 v16, v14, v15
    v_lshlrev_b32 v14, 16, v16
    v_and_b32 v15, s40, v16
    v_lshlrev_b32 v17, 16, v10
    v_and_b32 v18, s40, v10
    v_lshlrev_b32 v19, 16, v11
    v_and_b32 v20, s40, v11
    v_add_f32 v12, v12, v17
    v_add_f32 v13, v13, v18
    v_add_f32 v14, v14, v19
    v_add_f32 v15, v15, v20
    v_cvt_pk_bf16_f32 v22, v12, v13
    v_cvt_pk_bf16_f32 v23, v14, v15
    v_add_u32 v6, 294912, v6
    buffer_store_dwordx2 v[22:23], v6, s[32:35], 0 offen
    s_nop 1
    ds_read_b64 v[10:11], v4 offset:49408
    ds_read_u16 v12, v5 offset:7680
    ds_read_u16 v13, v5 offset:17920
    ds_read_u16 v14, v5 offset:28160
    ds_read_u16 v15, v5 offset:38400
    s_waitcnt lgkmcnt(0)
    v_lshlrev_b32 v12, 16, v12
    v_mul_f32 v12, s72, v12
    v_lshlrev_b32 v13, 16, v13
    v_mul_f32 v13, s73, v13
    v_lshlrev_b32 v14, 16, v14
    v_mul_f32 v14, s74, v14
    v_lshlrev_b32 v15, 16, v15
    v_mul_f32 v15, s75, v15
    v_cvt_pk_bf16_f32 v16, v12, v13
    v_lshlrev_b32 v12, 16, v16
    v_and_b32 v13, s40, v16
    v_cvt_pk_bf16_f32 v16, v14, v15
    v_lshlrev_b32 v14, 16, v16
    v_and_b32 v15, s40, v16
    v_lshlrev_b32 v17, 16, v10
    v_and_b32 v18, s40, v10
    v_lshlrev_b32 v19, 16, v11
    v_and_b32 v20, s40, v11
    v_add_f32 v12, v12, v17
    v_add_f32 v13, v13, v18
    v_add_f32 v14, v14, v19
    v_add_f32 v15, v15, v20
    v_cvt_pk_bf16_f32 v22, v12, v13
    v_cvt_pk_bf16_f32 v23, v14, v15
    v_add_u32 v6, 294912, v6
    buffer_store_dwordx2 v[22:23], v6, s[32:35], 0 offen
    s_nop 1
    ds_read_b64 v[10:11], v4 offset:51520
    ds_read_u16 v12, v5 offset:8320
    ds_read_u16 v13, v5 offset:18560
    ds_read_u16 v14, v5 offset:28800
    ds_read_u16 v15, v5 offset:39040
    s_waitcnt lgkmcnt(0)
    v_lshlrev_b32 v12, 16, v12
    v_mul_f32 v12, s72, v12
    v_lshlrev_b32 v13, 16, v13
    v_mul_f32 v13, s73, v13
    v_lshlrev_b32 v14, 16, v14
    v_mul_f32 v14, s74, v14
    v_lshlrev_b32 v15, 16, v15
    v_mul_f32 v15, s75, v15
    v_cvt_pk_bf16_f32 v16, v12, v13
    v_lshlrev_b32 v12, 16, v16
    v_and_b32 v13, s40, v16
    v_cvt_pk_bf16_f32 v16, v14, v15
    v_lshlrev_b32 v14, 16, v16
    v_and_b32 v15, s40, v16
    v_lshlrev_b32 v17, 16, v10
    v_and_b32 v18, s40, v10
    v_lshlrev_b32 v19, 16, v11
    v_and_b32 v20, s40, v11
    v_add_f32 v12, v12, v17
    v_add_f32 v13, v13, v18
    v_add_f32 v14, v14, v19
    v_add_f32 v15, v15, v20
    v_cvt_pk_bf16_f32 v22, v12, v13
    v_cvt_pk_bf16_f32 v23, v14, v15
    v_add_u32 v6, 294912, v6
    buffer_store_dwordx2 v[22:23], v6, s[32:35], 0 offen
    s_nop 1
    ds_read_b64 v[10:11], v4 offset:53632
    ds_read_u16 v12, v5 offset:8960
    ds_read_u16 v13, v5 offset:19200
    ds_read_u16 v14, v5 offset:29440
    ds_read_u16 v15, v5 offset:39680
    s_waitcnt lgkmcnt(0)
    v_lshlrev_b32 v12, 16, v12
    v_mul_f32 v12, s72, v12
    v_lshlrev_b32 v13, 16, v13
    v_mul_f32 v13, s73, v13
    v_lshlrev_b32 v14, 16, v14
    v_mul_f32 v14, s74, v14
    v_lshlrev_b32 v15, 16, v15
    v_mul_f32 v15, s75, v15
    v_cvt_pk_bf16_f32 v16, v12, v13
    v_lshlrev_b32 v12, 16, v16
    v_and_b32 v13, s40, v16
    v_cvt_pk_bf16_f32 v16, v14, v15
    v_lshlrev_b32 v14, 16, v16
    v_and_b32 v15, s40, v16
    v_lshlrev_b32 v17, 16, v10
    v_and_b32 v18, s40, v10
    v_lshlrev_b32 v19, 16, v11
    v_and_b32 v20, s40, v11
    v_add_f32 v12, v12, v17
    v_add_f32 v13, v13, v18
    v_add_f32 v14, v14, v19
    v_add_f32 v15, v15, v20
    v_cvt_pk_bf16_f32 v22, v12, v13
    v_cvt_pk_bf16_f32 v23, v14, v15
    v_add_u32 v6, 294912, v6
    buffer_store_dwordx2 v[22:23], v6, s[32:35], 0 offen
    s_nop 1
    ds_read_b64 v[10:11], v4 offset:55744
    ds_read_u16 v12, v5 offset:9600
    ds_read_u16 v13, v5 offset:19840
    ds_read_u16 v14, v5 offset:30080
    ds_read_u16 v15, v5 offset:40320
    s_waitcnt lgkmcnt(0)
    v_lshlrev_b32 v12, 16, v12
    v_mul_f32 v12, s72, v12
    v_lshlrev_b32 v13, 16, v13
    v_mul_f32 v13, s73, v13
    v_lshlrev_b32 v14, 16, v14
    v_mul_f32 v14, s74, v14
    v_lshlrev_b32 v15, 16, v15
    v_mul_f32 v15, s75, v15
    v_cvt_pk_bf16_f32 v16, v12, v13
    v_lshlrev_b32 v12, 16, v16
    v_and_b32 v13, s40, v16
    v_cvt_pk_bf16_f32 v16, v14, v15
    v_lshlrev_b32 v14, 16, v16
    v_and_b32 v15, s40, v16
    v_lshlrev_b32 v17, 16, v10
    v_and_b32 v18, s40, v10
    v_lshlrev_b32 v19, 16, v11
    v_and_b32 v20, s40, v11
    v_add_f32 v12, v12, v17
    v_add_f32 v13, v13, v18
    v_add_f32 v14, v14, v19
    v_add_f32 v15, v15, v20
    v_cvt_pk_bf16_f32 v22, v12, v13
    v_cvt_pk_bf16_f32 v23, v14, v15
    v_add_u32 v6, 294912, v6
    buffer_store_dwordx2 v[22:23], v6, s[32:35], 0 offen
    s_nop 1
    s_waitcnt vmcnt(0)
conv_kernel_done:
    s_endpgm
prep_path:
    s_load_dwordx4 s[4:7], s[0:1], 56
    s_load_dwordx2 s[10:11], s[0:1], 72
    s_load_dwordx2 s[8:9], s[0:1], 96
    v_lshrrev_b32 v1, 6, v0
    v_and_b32 v2, 63, v0
    v_readfirstlane_b32 s42, v1
    v_and_b32 v3, 15, v2
    v_lshrrev_b32 v4, 4, v2
    v_lshlrev_b32 v5, 3, v3
    v_lshl_add_u32 v5, v4, 10, v5
    s_mul_i32 s53, s42, 5120
    s_sub_u32 s2, s2, 144
    s_lshl_b32 s2, s2, 2
    s_add_u32 s2, s2, s42
    s_and_b32 s42, s2, 7
    s_lshr_b32 s2, s2, 3
    v_add_u32 v5, s53, v5
    v_and_b32 v6, 1, v4
    v_lshl_add_u32 v14, v6, 7, v5
    v_xor_b32 v6, 1, v6
    v_lshl_add_u32 v15, v6, 7, v5
    v_lshlrev_b32 v16, 3, v2
    v_add_u32 v16, s53, v16
    v_lshlrev_b32 v19, 4, v2
    s_waitcnt lgkmcnt(0)
    s_cmp_ge_u32 s2, 288
    s_cbranch_scc1 prep_path_w2
    s_movk_i32 s60, 9216
    v_lshrrev_b32 v5, 5, v2
    v_lshlrev_b32 v5, 2, v5
    v_bfe_u32 v6, v2, 1, 2
    v_add_u32 v5, v5, v6
    v_mul_lo_u32 v5, v5, s60
    v_bfe_u32 v6, v2, 4, 1
    v_lshl_add_u32 v5, v6, 6, v5
    v_and_b32 v6, 1, v2
    v_lshl_add_u32 v5, v6, 4, v5
    v_bfe_u32 v6, v2, 3, 1
    v_lshl_add_u32 v17, v6, 5, v5
    v_xor_b32 v6, 1, v6
    v_lshl_add_u32 v18, v6, 5, v5
    v_lshrrev_b32 v5, 5, v2
    v_lshlrev_b32 v5, 2, v5
    v_bfe_u32 v6, v2, 3, 2
    v_lshl_add_u32 v5, v6, 3, v5
    v_bfe_u32 v6, v2, 1, 2
    v_add_u32 v5, v5, v6
    v_mul_lo_u32 v5, v5, s60
    v_and_b32 v6, 1, v2
    v_lshl_add_u32 v20, v6, 4, v5
    s_mul_hi_u32 s44, s2, 0x1c71c71d
    s_mul_i32 s3, s44, 9
    s_sub_u32 s45, s2, s3
    s_lshr_b32 s46, s42, 2
    s_bfe_u32 s47, s42, 0x10001
    s_and_b32 s48, s42, 1
    s_cmp_eq_u32 s47, 0
    s_cselect_b32 s12, s4, s6
    s_cselect_b32 s13, s5, s7
    s_mov_b32 s14, 0x510000
    s_mov_b32 s15, 0x00020000
    s_add_u32 s16, s8, 0x5000000
    s_addc_u32 s17, s9, 0
    s_mov_b32 s18, 0xa20000
    s_mov_b32 s19, 0x00020000
    s_lshl_b32 s50, s45, 6
    s_lshl_b32 s3, s46, 5
    s_add_u32 s50, s50, s3
    s_mul_i32 s50, s50, 9216
    s_mul_i32 s3, s44, 288
    s_add_u32 s50, s50, s3
    s_lshl_b32 s3, s48, 7
    s_add_u32 s51, s50, s3
    s_add_u32 s52, s50, 256
    s_mul_i32 s54, s44, 331776
    s_lshl_b32 s3, s47, 10
    s_add_u32 s54, s54, s3
    s_mul_i32 s62, s45, 20480
    s_add_u32 s62, s62, s54
    s_mul_i32 s3, s46, 10240
    s_add_u32 s62, s62, s3
    s_lshl_b32 s63, s45, 14
    s_add_u32 s63, s63, s54
    s_lshl_b32 s3, s46, 13
    s_add_u32 s63, s63, s3
    s_add_u32 s63, s63, 184320
    s_add_u32 s56, s63, 6144
    s_add_u32 s3, s62, 0
    s_add_u32 s64, s62, 8192
    s_cmp_eq_u32 s48, 0
    s_cselect_b32 s64, s3, s64
    s_add_u32 s3, s62, 2048
    s_add_u32 s65, s63, 0
    s_cmp_eq_u32 s48, 0
    s_cselect_b32 s65, s3, s65
    s_add_u32 s3, s62, 4096
    s_add_u32 s66, s63, 2048
    s_cmp_eq_u32 s48, 0
    s_cselect_b32 s66, s3, s66
    s_add_u32 s3, s62, 6144
    s_add_u32 s67, s63, 4096
    s_cmp_eq_u32 s48, 0
    s_cselect_b32 s67, s3, s67
    s_add_u32 m0, s53, 0
    s_add_u32 s57, s51, 0
    buffer_load_dwordx4 v17, s[12:15], s57 offen lds
    s_add_u32 m0, s53, 1024
    s_add_u32 s57, s51, 73728
    buffer_load_dwordx4 v18, s[12:15], s57 offen lds
    s_add_u32 m0, s53, 2048
    s_add_u32 s57, s51, 147456
    buffer_load_dwordx4 v17, s[12:15], s57 offen lds
    s_add_u32 m0, s53, 3072
    s_add_u32 s57, s51, 221184
    buffer_load_dwordx4 v18, s[12:15], s57 offen lds
    s_add_u32 m0, s53, 4096
    s_nop 0
    buffer_load_dwordx4 v20, s[12:15], s52 offen lds
    s_waitcnt vmcnt(0)
    ds_read_b64_tr_b16 v[24:25], v14 offset:0
    ds_read_b64_tr_b16 v[26:27], v14 offset:512
    ds_read_b64_tr_b16 v[28:29], v15 offset:0
    ds_read_b64_tr_b16 v[30:31], v15 offset:512
    ds_read_b64_tr_b16 v[32:33], v14 offset:256
    ds_read_b64_tr_b16 v[34:35], v14 offset:768
    ds_read_b64_tr_b16 v[36:37], v15 offset:256
    ds_read_b64_tr_b16 v[38:39], v15 offset:768
    ds_read_b64_tr_b16 v[40:41], v16 offset:4096
    ds_read_b64_tr_b16 v[42:43], v16 offset:4608
    s_waitcnt lgkmcnt(0)
    buffer_store_dwordx4 v[24:27], v19, s[16:19], s64 offen
    buffer_store_dwordx4 v[28:31], v19, s[16:19], s65 offen
    buffer_store_dwordx4 v[32:35], v19, s[16:19], s66 offen
    buffer_store_dwordx4 v[36:39], v19, s[16:19], s67 offen
    buffer_store_dwordx4 v[40:43], v19, s[16:19], s56 offen
    s_waitcnt vmcnt(0)
    s_endpgm
prep_path_w2:
    s_movk_i32 s60, 1152
    v_lshrrev_b32 v5, 5, v2
    v_lshlrev_b32 v5, 2, v5
    v_bfe_u32 v6, v2, 1, 2
    v_add_u32 v5, v5, v6
    v_mul_lo_u32 v5, v5, s60
    v_bfe_u32 v6, v2, 4, 1
    v_lshl_add_u32 v5, v6, 6, v5
    v_and_b32 v6, 1, v2
    v_lshl_add_u32 v5, v6, 4, v5
    v_bfe_u32 v6, v2, 3, 1
    v_lshl_add_u32 v17, v6, 5, v5
    v_xor_b32 v6, 1, v6
    v_lshl_add_u32 v18, v6, 5, v5
    v_lshrrev_b32 v5, 5, v2
    v_lshlrev_b32 v5, 2, v5
    v_bfe_u32 v6, v2, 3, 2
    v_lshl_add_u32 v5, v6, 3, v5
    v_bfe_u32 v6, v2, 1, 2
    v_add_u32 v5, v5, v6
    v_mul_lo_u32 v5, v5, s60
    v_and_b32 v6, 1, v2
    v_lshl_add_u32 v20, v6, 4, v5
    s_sub_u32 s43, s2, 288
    s_mul_hi_u32 s44, s43, 0x1c71c71d
    s_mul_i32 s3, s44, 9
    s_sub_u32 s45, s43, s3
    s_and_b32 s46, s44, 3
    s_lshr_b32 s44, s44, 2
    s_lshr_b32 s47, s42, 1
    s_and_b32 s48, s42, 1
    s_mov_b32 s12, s10
    s_mov_b32 s13, s11
    s_mov_b32 s14, 0x510000
    s_mov_b32 s15, 0x00020000
    s_add_u32 s16, s8, 0x6000000
    s_addc_u32 s17, s9, 0
    s_mov_b32 s18, 0x510000
    s_mov_b32 s19, 0x00020000
    s_mul_i32 s50, s46, 1152
    s_mul_i32 s3, s47, 288
    s_add_u32 s50, s50, s3
    s_lshl_b32 s3, s45, 5
    s_add_u32 s50, s50, s3
    s_mul_i32 s50, s50, 1152
    s_mul_i32 s3, s44, 288
    s_add_u32 s50, s50, s3
    s_lshl_b32 s3, s48, 7
    s_add_u32 s51, s50, s3
    s_add_u32 s52, s50, 256
    s_mul_i32 s54, s43, 36
    s_mul_i32 s3, s47, 9
    s_add_u32 s54, s54, s3
    s_lshl_b32 s55, s54, 10
    s_add_u32 s56, s55, 8192
    s_lshl_b32 s3, s48, 12
    s_add_u32 s55, s55, s3
    s_add_u32 m0, s53, 0
    s_add_u32 s57, s51, 0
    buffer_load_dwordx4 v17, s[12:15], s57 offen lds
    s_add_u32 m0, s53, 1024
    s_add_u32 s57, s51, 9216
    buffer_load_dwordx4 v18, s[12:15], s57 offen lds
    s_add_u32 m0, s53, 2048
    s_add_u32 s57, s51, 18432
    buffer_load_dwordx4 v17, s[12:15], s57 offen lds
    s_add_u32 m0, s53, 3072
    s_add_u32 s57, s51, 27648
    buffer_load_dwordx4 v18, s[12:15], s57 offen lds
    s_add_u32 m0, s53, 4096
    s_nop 0
    buffer_load_dwordx4 v20, s[12:15], s52 offen lds
    s_waitcnt vmcnt(0)
    ds_read_b64_tr_b16 v[24:25], v14 offset:0
    ds_read_b64_tr_b16 v[26:27], v14 offset:512
    ds_read_b64_tr_b16 v[28:29], v15 offset:0
    ds_read_b64_tr_b16 v[30:31], v15 offset:512
    ds_read_b64_tr_b16 v[32:33], v14 offset:256
    ds_read_b64_tr_b16 v[34:35], v14 offset:768
    ds_read_b64_tr_b16 v[36:37], v15 offset:256
    ds_read_b64_tr_b16 v[38:39], v15 offset:768
    ds_read_b64_tr_b16 v[40:41], v16 offset:4096
    ds_read_b64_tr_b16 v[42:43], v16 offset:4608
    s_waitcnt lgkmcnt(0)
    buffer_store_dwordx4 v[24:27], v19, s[16:19], s55 offen offset:0
    buffer_store_dwordx4 v[28:31], v19, s[16:19], s55 offen offset:1024
    buffer_store_dwordx4 v[32:35], v19, s[16:19], s55 offen offset:2048
    buffer_store_dwordx4 v[36:39], v19, s[16:19], s55 offen offset:3072
    buffer_store_dwordx4 v[40:43], v19, s[16:19], s56 offen
    s_waitcnt vmcnt(0)
    s_endpgm
.globl rowa_kernel
.p2align 8
.type rowa_kernel,@function
rowa_kernel:
    s_cmp_ge_u32 s2, 512
    s_cbranch_scc1 rowa_kernel_done
    s_load_dwordx2 s[4:5], s[0:1], 0
    s_load_dwordx2 s[8:9], s[0:1], 96
    s_mov_b32 s40, 0xffff0000
    v_lshrrev_b32 v1, 4, v0
    s_lshl_b32 s3, s2, 2
    v_add_u32 v1, s3, v1
    v_and_b32 v2, 15, v0
    s_movk_i32 s41, 1152
    v_mul_lo_u32 v3, v1, s41
    v_lshl_add_u32 v3, v2, 3, v3
    v_lshrrev_b32 v5, 4, v1
    v_and_b32 v6, 15, v1
    s_movk_i32 s41, 18432
    v_mul_lo_u32 v8, v5, s41
    v_lshl_add_u32 v8, v6, 4, v8
    v_lshrrev_b32 v7, 3, v2
    v_lshl_add_u32 v8, v7, 10, v8
    v_bfe_u32 v7, v2, 1, 2
    v_lshl_add_u32 v8, v7, 8, v8
    v_and_b32 v7, 1, v2
    v_lshl_add_u32 v8, v7, 3, v8
    s_waitcnt lgkmcnt(0)
    s_mov_b32 s12, s4
    s_mov_b32 s13, s5
    s_mov_b32 s14, 0x240000
    s_mov_b32 s15, 0x00020000
    s_mov_b32 s16, s8
    s_mov_b32 s17, s9
    s_mov_b32 s18, 0x240000
    s_mov_b32 s19, 0x00020000
    s_add_u32 s24, s8, 0x400000
    s_addc_u32 s25, s9, 0
    s_mov_b32 s26, 0x240000
    s_mov_b32 s27, 0x00020000
    s_add_u32 s28, s8, 0x800000
    s_addc_u32 s29, s9, 0
    s_mov_b32 s30, 0x240000
    s_mov_b32 s31, 0x00020000
    buffer_load_dwordx2 v[82:83], v3, s[12:15], 0 offen offset:0
    buffer_load_dwordx2 v[84:85], v3, s[12:15], 0 offen offset:128
    buffer_load_dwordx2 v[86:87], v3, s[12:15], 0 offen offset:256
    buffer_load_dwordx2 v[88:89], v3, s[12:15], 0 offen offset:384
    buffer_load_dwordx2 v[90:91], v3, s[12:15], 0 offen offset:512
    buffer_load_dwordx2 v[92:93], v3, s[12:15], 0 offen offset:640
    buffer_load_dwordx2 v[94:95], v3, s[12:15], 0 offen offset:768
    buffer_load_dwordx2 v[96:97], v3, s[12:15], 0 offen offset:896
    buffer_load_dwordx2 v[98:99], v3, s[12:15], 0 offen offset:1024
    buffer_load_dwordx2 v[100:101], v3, s[16:19], 0 offen offset:0
    buffer_load_dwordx2 v[102:103], v3, s[16:19], 0 offen offset:128
    buffer_load_dwordx2 v[104:105], v3, s[16:19], 0 offen offset:256
    buffer_load_dwordx2 v[106:107], v3, s[16:19], 0 offen offset:384
    buffer_load_dwordx2 v[108:109], v3, s[16:19], 0 offen offset:512
    buffer_load_dwordx2 v[110:111], v3, s[16:19], 0 offen offset:640
    buffer_load_dwordx2 v[112:113], v3, s[16:19], 0 offen offset:768
    buffer_load_dwordx2 v[114:115], v3, s[16:19], 0 offen offset:896
    buffer_load_dwordx2 v[116:117], v3, s[16:19], 0 offen offset:1024
    s_waitcnt vmcnt(0)
    v_lshlrev_b32 v10, 16, v82
    v_and_b32 v11, s40, v82
    v_lshlrev_b32 v12, 16, v83
    v_and_b32 v13, s40, v83
    v_lshlrev_b32 v14, 16, v84
    v_and_b32 v15, s40, v84
    v_lshlrev_b32 v16, 16, v85
    v_and_b32 v17, s40, v85
    v_lshlrev_b32 v18, 16, v86
    v_and_b32 v19, s40, v86
    v_lshlrev_b32 v20, 16, v87
    v_and_b32 v21, s40, v87
    v_lshlrev_b32 v22, 16, v88
    v_and_b32 v23, s40, v88
    v_lshlrev_b32 v24, 16, v89
    v_and_b32 v25, s40, v89
    v_lshlrev_b32 v26, 16, v90
    v_and_b32 v27, s40, v90
    v_lshlrev_b32 v28, 16, v91
    v_and_b32 v29, s40, v91
    v_lshlrev_b32 v30, 16, v92
    v_and_b32 v31, s40, v92
    v_lshlrev_b32 v32, 16, v93
    v_and_b32 v33, s40, v93
    v_lshlrev_b32 v34, 16, v94
    v_and_b32 v35, s40, v94
    v_lshlrev_b32 v36, 16, v95
    v_and_b32 v37, s40, v95
    v_lshlrev_b32 v38, 16, v96
    v_and_b32 v39, s40, v96
    v_lshlrev_b32 v40, 16, v97
    v_and_b32 v41, s40, v97
    v_lshlrev_b32 v42, 16, v98
    v_and_b32 v43, s40, v98
    v_lshlrev_b32 v44, 16, v99
    v_and_b32 v45, s40, v99
    v_lshlrev_b32 v46, 16, v100
    v_and_b32 v47, s40, v100
    v_lshlrev_b32 v48, 16, v101
    v_and_b32 v49, s40, v101
    v_lshlrev_b32 v50, 16, v102
    v_and_b32 v51, s40, v102
    v_lshlrev_b32 v52, 16, v103
    v_and_b32 v53, s40, v103
    v_lshlrev_b32 v54, 16, v104
    v_and_b32 v55, s40, v104
    v_lshlrev_b32 v56, 16, v105
    v_and_b32 v57, s40, v105
    v_lshlrev_b32 v58, 16, v106
    v_and_b32 v59, s40, v106
    v_lshlrev_b32 v60, 16, v107
    v_and_b32 v61, s40, v107
    v_lshlrev_b32 v62, 16, v108
    v_and_b32 v63, s40, v108
    v_lshlrev_b32 v64, 16, v109
    v_and_b32 v65, s40, v109
    v_lshlrev_b32 v66, 16, v110
    v_and_b32 v67, s40, v110
    v_lshlrev_b32 v68, 16, v111
    v_and_b32 v69, s40, v111
    v_lshlrev_b32 v70, 16, v112
    v_and_b32 v71, s40, v112
    v_lshlrev_b32 v72, 16, v113
    v_and_b32 v73, s40, v113
    v_lshlrev_b32 v74, 16, v114
    v_and_b32 v75, s40, v114
    v_lshlrev_b32 v76, 16, v115
    v_and_b32 v77, s40, v115
    v_lshlrev_b32 v78, 16, v116
    v_and_b32 v79, s40, v116
    v_lshlrev_b32 v80, 16, v117
    v_and_b32 v81, s40, v117
    v_add_f32 v5, v10, v11
    v_add_f32 v5, v5, v12
    v_add_f32 v5, v5, v13
    v_add_f32 v5, v5, v14
    v_add_f32 v5, v5, v15
    v_add_f32 v5, v5, v16
    v_add_f32 v5, v5, v17
    v_add_f32 v5, v5, v18
    v_add_f32 v5, v5, v19
    v_add_f32 v5, v5, v20
    v_add_f32 v5, v5, v21
    v_add_f32 v5, v5, v22
    v_add_f32 v5, v5, v23
    v_add_f32 v5, v5, v24
    v_add_f32 v5, v5, v25
    v_add_f32 v5, v5, v26
    v_add_f32 v5, v5, v27
    v_add_f32 v5, v5, v28
    v_add_f32 v5, v5, v29
    v_add_f32 v5, v5, v30
    v_add_f32 v5, v5, v31
    v_add_f32 v5, v5, v32
    v_add_f32 v5, v5, v33
    v_add_f32 v5, v5, v34
    v_add_f32 v5, v5, v35
    v_add_f32 v5, v5, v36
    v_add_f32 v5, v5, v37
    v_add_f32 v5, v5, v38
    v_add_f32 v5, v5, v39
    v_add_f32 v5, v5, v40
    v_add_f32 v5, v5, v41
    v_add_f32 v5, v5, v42
    v_add_f32 v5, v5, v43
    v_add_f32 v5, v5, v44
    v_add_f32 v5, v5, v45
    s_nop 1
    v_add_f32_dpp v5, v5, v5 row_ror:8 row_mask:0xf bank_mask:0xf
    s_nop 1
    v_add_f32_dpp v5, v5, v5 row_ror:4 row_mask:0xf bank_mask:0xf
    s_nop 1
    v_add_f32_dpp v5, v5, v5 row_ror:2 row_mask:0xf bank_mask:0xf
    s_nop 1
    v_add_f32_dpp v5, v5, v5 row_ror:1 row_mask:0xf bank_mask:0xf
    v_mul_f32 v5, 0x3ae38e39, v5
    v_mov_b32 v6, 0
    v_sub_f32 v7, v10, v5
    v_fmac_f32 v6, v7, v7
    v_sub_f32 v7, v11, v5
    v_fmac_f32 v6, v7, v7
    v_sub_f32 v7, v12, v5
    v_fmac_f32 v6, v7, v7
    v_sub_f32 v7, v13, v5
    v_fmac_f32 v6, v7, v7
    v_sub_f32 v7, v14, v5
    v_fmac_f32 v6, v7, v7
    v_sub_f32 v7, v15, v5
    v_fmac_f32 v6, v7, v7
    v_sub_f32 v7, v16, v5
    v_fmac_f32 v6, v7, v7
    v_sub_f32 v7, v17, v5
    v_fmac_f32 v6, v7, v7
    v_sub_f32 v7, v18, v5
    v_fmac_f32 v6, v7, v7
    v_sub_f32 v7, v19, v5
    v_fmac_f32 v6, v7, v7
    v_sub_f32 v7, v20, v5
    v_fmac_f32 v6, v7, v7
    v_sub_f32 v7, v21, v5
    v_fmac_f32 v6, v7, v7
    v_sub_f32 v7, v22, v5
    v_fmac_f32 v6, v7, v7
    v_sub_f32 v7, v23, v5
    v_fmac_f32 v6, v7, v7
    v_sub_f32 v7, v24, v5
    v_fmac_f32 v6, v7, v7
    v_sub_f32 v7, v25, v5
    v_fmac_f32 v6, v7, v7
    v_sub_f32 v7, v26, v5
    v_fmac_f32 v6, v7, v7
    v_sub_f32 v7, v27, v5
    v_fmac_f32 v6, v7, v7
    v_sub_f32 v7, v28, v5
    v_fmac_f32 v6, v7, v7
    v_sub_f32 v7, v29, v5
    v_fmac_f32 v6, v7, v7
    v_sub_f32 v7, v30, v5
    v_fmac_f32 v6, v7, v7
    v_sub_f32 v7, v31, v5
    v_fmac_f32 v6, v7, v7
    v_sub_f32 v7, v32, v5
    v_fmac_f32 v6, v7, v7
    v_sub_f32 v7, v33, v5
    v_fmac_f32 v6, v7, v7
    v_sub_f32 v7, v34, v5
    v_fmac_f32 v6, v7, v7
    v_sub_f32 v7, v35, v5
    v_fmac_f32 v6, v7, v7
    v_sub_f32 v7, v36, v5
    v_fmac_f32 v6, v7, v7
    v_sub_f32 v7, v37, v5
    v_fmac_f32 v6, v7, v7
    v_sub_f32 v7, v38, v5
    v_fmac_f32 v6, v7, v7
    v_sub_f32 v7, v39, v5
    v_fmac_f32 v6, v7, v7
    v_sub_f32 v7, v40, v5
    v_fmac_f32 v6, v7, v7
    v_sub_f32 v7, v41, v5
    v_fmac_f32 v6, v7, v7
    v_sub_f32 v7, v42, v5
    v_fmac_f32 v6, v7, v7
    v_sub_f32 v7, v43, v5
    v_fmac_f32 v6, v7, v7
    v_sub_f32 v7, v44, v5
    v_fmac_f32 v6, v7, v7
    v_sub_f32 v7, v45, v5
    v_fmac_f32 v6, v7, v7
    s_nop 1
    v_add_f32_dpp v6, v6, v6 row_ror:8 row_mask:0xf bank_mask:0xf
    s_nop 1
    v_add_f32_dpp v6, v6, v6 row_ror:4 row_mask:0xf bank_mask:0xf
    s_nop 1
    v_add_f32_dpp v6, v6, v6 row_ror:2 row_mask:0xf bank_mask:0xf
    s_nop 1
    v_add_f32_dpp v6, v6, v6 row_ror:1 row_mask:0xf bank_mask:0xf
    v_mul_f32 v6, 0x3ae38e39, v6
    v_cvt_pk_bf16_f32 v7, v5, v6
    v_lshlrev_b32 v5, 16, v7
    v_and_b32 v6, s40, v7
    v_add_f32 v6, 0x3727c5ac, v6
    v_cvt_pk_bf16_f32 v7, v6, v6
    v_lshlrev_b32 v6, 16, v7
    v_sqrt_f32 v6, v6
    s_nop 0
    v_cvt_pk_bf16_f32 v7, v6, v6
    v_lshlrev_b32 v6, 16, v7
    v_rcp_f32 v6, v6
    v_sub_f32 v120, v10, v5
    v_sub_f32 v121, v11, v5
    v_sub_f32 v122, v12, v5
    v_sub_f32 v123, v13, v5
    v_sub_f32 v124, v14, v5
    v_sub_f32 v125, v15, v5
    v_sub_f32 v126, v16, v5
    v_sub_f32 v127, v17, v5
    v_sub_f32 v128, v18, v5
    v_sub_f32 v129, v19, v5
    v_sub_f32 v130, v20, v5
    v_sub_f32 v131, v21, v5
    v_sub_f32 v132, v22, v5
    v_sub_f32 v133, v23, v5
    v_sub_f32 v134, v24, v5
    v_sub_f32 v135, v25, v5
    v_sub_f32 v136, v26, v5
    v_sub_f32 v137, v27, v5
    v_sub_f32 v138, v28, v5
    v_sub_f32 v139, v29, v5
    v_sub_f32 v140, v30, v5
    v_sub_f32 v141, v31, v5
    v_sub_f32 v142, v32, v5
    v_sub_f32 v143, v33, v5
    v_sub_f32 v144, v34, v5
    v_sub_f32 v145, v35, v5
    v_sub_f32 v146, v36, v5
    v_sub_f32 v147, v37, v5
    v_sub_f32 v148, v38, v5
    v_sub_f32 v149, v39, v5
    v_sub_f32 v150, v40, v5
    v_sub_f32 v151, v41, v5
    v_sub_f32 v152, v42, v5
    v_sub_f32 v153, v43, v5
    v_sub_f32 v154, v44, v5
    v_sub_f32 v155, v45, v5
    v_cvt_pk_bf16_f32 v7, v120, v121
    v_lshlrev_b32 v120, 16, v7
    v_and_b32 v121, s40, v7
    v_cvt_pk_bf16_f32 v7, v122, v123
    v_lshlrev_b32 v122, 16, v7
    v_and_b32 v123, s40, v7
    v_cvt_pk_bf16_f32 v7, v124, v125
    v_lshlrev_b32 v124, 16, v7
    v_and_b32 v125, s40, v7
    v_cvt_pk_bf16_f32 v7, v126, v127
    v_lshlrev_b32 v126, 16, v7
    v_and_b32 v127, s40, v7
    v_cvt_pk_bf16_f32 v7, v128, v129
    v_lshlrev_b32 v128, 16, v7
    v_and_b32 v129, s40, v7
    v_cvt_pk_bf16_f32 v7, v130, v131
    v_lshlrev_b32 v130, 16, v7
    v_and_b32 v131, s40, v7
    v_cvt_pk_bf16_f32 v7, v132, v133
    v_lshlrev_b32 v132, 16, v7
    v_and_b32 v133, s40, v7
    v_cvt_pk_bf16_f32 v7, v134, v135
    v_lshlrev_b32 v134, 16, v7
    v_and_b32 v135, s40, v7
    v_cvt_pk_bf16_f32 v7, v136, v137
    v_lshlrev_b32 v136, 16, v7
    v_and_b32 v137, s40, v7
    v_cvt_pk_bf16_f32 v7, v138, v139
    v_lshlrev_b32 v138, 16, v7
    v_and_b32 v139, s40, v7
    v_cvt_pk_bf16_f32 v7, v140, v141
    v_lshlrev_b32 v140, 16, v7
    v_and_b32 v141, s40, v7
    v_cvt_pk_bf16_f32 v7, v142, v143
    v_lshlrev_b32 v142, 16, v7
    v_and_b32 v143, s40, v7
    v_cvt_pk_bf16_f32 v7, v144, v145
    v_lshlrev_b32 v144, 16, v7
    v_and_b32 v145, s40, v7
    v_cvt_pk_bf16_f32 v7, v146, v147
    v_lshlrev_b32 v146, 16, v7
    v_and_b32 v147, s40, v7
    v_cvt_pk_bf16_f32 v7, v148, v149
    v_lshlrev_b32 v148, 16, v7
    v_and_b32 v149, s40, v7
    v_cvt_pk_bf16_f32 v7, v150, v151
    v_lshlrev_b32 v150, 16, v7
    v_and_b32 v151, s40, v7
    v_cvt_pk_bf16_f32 v7, v152, v153
    v_lshlrev_b32 v152, 16, v7
    v_and_b32 v153, s40, v7
    v_cvt_pk_bf16_f32 v7, v154, v155
    v_lshlrev_b32 v154, 16, v7
    v_and_b32 v155, s40, v7
    v_mul_f32 v120, v120, v6
    v_mul_f32 v121, v121, v6
    v_mul_f32 v122, v122, v6
    v_mul_f32 v123, v123, v6
    v_mul_f32 v124, v124, v6
    v_mul_f32 v125, v125, v6
    v_mul_f32 v126, v126, v6
    v_mul_f32 v127, v127, v6
    v_mul_f32 v128, v128, v6
    v_mul_f32 v129, v129, v6
    v_mul_f32 v130, v130, v6
    v_mul_f32 v131, v131, v6
    v_mul_f32 v132, v132, v6
    v_mul_f32 v133, v133, v6
    v_mul_f32 v134, v134, v6
    v_mul_f32 v135, v135, v6
    v_mul_f32 v136, v136, v6
    v_mul_f32 v137, v137, v6
    v_mul_f32 v138, v138, v6
    v_mul_f32 v139, v139, v6
    v_mul_f32 v140, v140, v6
    v_mul_f32 v141, v141, v6
    v_mul_f32 v142, v142, v6
    v_mul_f32 v143, v143, v6
    v_mul_f32 v144, v144, v6
    v_mul_f32 v145, v145, v6
    v_mul_f32 v146, v146, v6
    v_mul_f32 v147, v147, v6
    v_mul_f32 v148, v148, v6
    v_mul_f32 v149, v149, v6
    v_mul_f32 v150, v150, v6
    v_mul_f32 v151, v151, v6
    v_mul_f32 v152, v152, v6
    v_mul_f32 v153, v153, v6
    v_mul_f32 v154, v154, v6
    v_mul_f32 v155, v155, v6
    v_cvt_pk_bf16_f32 v7, v120, v121
    v_lshlrev_b32 v120, 16, v7
    v_and_b32 v121, s40, v7
    v_cvt_pk_bf16_f32 v7, v122, v123
    v_lshlrev_b32 v122, 16, v7
    v_and_b32 v123, s40, v7
    v_cvt_pk_bf16_f32 v7, v124, v125
    v_lshlrev_b32 v124, 16, v7
    v_and_b32 v125, s40, v7
    v_cvt_pk_bf16_f32 v7, v126, v127
    v_lshlrev_b32 v126, 16, v7
    v_and_b32 v127, s40, v7
    v_cvt_pk_bf16_f32 v7, v128, v129
    v_lshlrev_b32 v128, 16, v7
    v_and_b32 v129, s40, v7
    v_cvt_pk_bf16_f32 v7, v130, v131
    v_lshlrev_b32 v130, 16, v7
    v_and_b32 v131, s40, v7
    v_cvt_pk_bf16_f32 v7, v132, v133
    v_lshlrev_b32 v132, 16, v7
    v_and_b32 v133, s40, v7
    v_cvt_pk_bf16_f32 v7, v134, v135
    v_lshlrev_b32 v134, 16, v7
    v_and_b32 v135, s40, v7
    v_cvt_pk_bf16_f32 v7, v136, v137
    v_lshlrev_b32 v136, 16, v7
    v_and_b32 v137, s40, v7
    v_cvt_pk_bf16_f32 v7, v138, v139
    v_lshlrev_b32 v138, 16, v7
    v_and_b32 v139, s40, v7
    v_cvt_pk_bf16_f32 v7, v140, v141
    v_lshlrev_b32 v140, 16, v7
    v_and_b32 v141, s40, v7
    v_cvt_pk_bf16_f32 v7, v142, v143
    v_lshlrev_b32 v142, 16, v7
    v_and_b32 v143, s40, v7
    v_cvt_pk_bf16_f32 v7, v144, v145
    v_lshlrev_b32 v144, 16, v7
    v_and_b32 v145, s40, v7
    v_cvt_pk_bf16_f32 v7, v146, v147
    v_lshlrev_b32 v146, 16, v7
    v_and_b32 v147, s40, v7
    v_cvt_pk_bf16_f32 v7, v148, v149
    v_lshlrev_b32 v148, 16, v7
    v_and_b32 v149, s40, v7
    v_cvt_pk_bf16_f32 v7, v150, v151
    v_lshlrev_b32 v150, 16, v7
    v_and_b32 v151, s40, v7
    v_cvt_pk_bf16_f32 v7, v152, v153
    v_lshlrev_b32 v152, 16, v7
    v_and_b32 v153, s40, v7
    v_cvt_pk_bf16_f32 v7, v154, v155
    v_lshlrev_b32 v154, 16, v7
    v_and_b32 v155, s40, v7
    v_mul_f32 v120, v120, v46
    v_mul_f32 v121, v121, v47
    v_mul_f32 v122, v122, v48
    v_mul_f32 v123, v123, v49
    v_mul_f32 v124, v124, v50
    v_mul_f32 v125, v125, v51
    v_mul_f32 v126, v126, v52
    v_mul_f32 v127, v127, v53
    v_mul_f32 v128, v128, v54
    v_mul_f32 v129, v129, v55
    v_mul_f32 v130, v130, v56
    v_mul_f32 v131, v131, v57
    v_mul_f32 v132, v132, v58
    v_mul_f32 v133, v133, v59
    v_mul_f32 v134, v134, v60
    v_mul_f32 v135, v135, v61
    v_mul_f32 v136, v136, v62
    v_mul_f32 v137, v137, v63
    v_mul_f32 v138, v138, v64
    v_mul_f32 v139, v139, v65
    v_mul_f32 v140, v140, v66
    v_mul_f32 v141, v141, v67
    v_mul_f32 v142, v142, v68
    v_mul_f32 v143, v143, v69
    v_mul_f32 v144, v144, v70
    v_mul_f32 v145, v145, v71
    v_mul_f32 v146, v146, v72
    v_mul_f32 v147, v147, v73
    v_mul_f32 v148, v148, v74
    v_mul_f32 v149, v149, v75
    v_mul_f32 v150, v150, v76
    v_mul_f32 v151, v151, v77
    v_mul_f32 v152, v152, v78
    v_mul_f32 v153, v153, v79
    v_mul_f32 v154, v154, v80
    v_mul_f32 v155, v155, v81
    v_cvt_pk_bf16_f32 v7, v120, v121
    v_lshlrev_b32 v120, 16, v7
    v_and_b32 v121, s40, v7
    v_cvt_pk_bf16_f32 v7, v122, v123
    v_lshlrev_b32 v122, 16, v7
    v_and_b32 v123, s40, v7
    v_cvt_pk_bf16_f32 v7, v124, v125
    v_lshlrev_b32 v124, 16, v7
    v_and_b32 v125, s40, v7
    v_cvt_pk_bf16_f32 v7, v126, v127
    v_lshlrev_b32 v126, 16, v7
    v_and_b32 v127, s40, v7
    v_cvt_pk_bf16_f32 v7, v128, v129
    v_lshlrev_b32 v128, 16, v7
    v_and_b32 v129, s40, v7
    v_cvt_pk_bf16_f32 v7, v130, v131
    v_lshlrev_b32 v130, 16, v7
    v_and_b32 v131, s40, v7
    v_cvt_pk_bf16_f32 v7, v132, v133
    v_lshlrev_b32 v132, 16, v7
    v_and_b32 v133, s40, v7
    v_cvt_pk_bf16_f32 v7, v134, v135
    v_lshlrev_b32 v134, 16, v7
    v_and_b32 v135, s40, v7
    v_cvt_pk_bf16_f32 v7, v136, v137
    v_lshlrev_b32 v136, 16, v7
    v_and_b32 v137, s40, v7
    v_cvt_pk_bf16_f32 v7, v138, v139
    v_lshlrev_b32 v138, 16, v7
    v_and_b32 v139, s40, v7
    v_cvt_pk_bf16_f32 v7, v140, v141
    v_lshlrev_b32 v140, 16, v7
    v_and_b32 v141, s40, v7
    v_cvt_pk_bf16_f32 v7, v142, v143
    v_lshlrev_b32 v142, 16, v7
    v_and_b32 v143, s40, v7
    v_cvt_pk_bf16_f32 v7, v144, v145
    v_lshlrev_b32 v144, 16, v7
    v_and_b32 v145, s40, v7
    v_cvt_pk_bf16_f32 v7, v146, v147
    v_lshlrev_b32 v146, 16, v7
    v_and_b32 v147, s40, v7
    v_cvt_pk_bf16_f32 v7, v148, v149
    v_lshlrev_b32 v148, 16, v7
    v_and_b32 v149, s40, v7
    v_cvt_pk_bf16_f32 v7, v150, v151
    v_lshlrev_b32 v150, 16, v7
    v_and_b32 v151, s40, v7
    v_cvt_pk_bf16_f32 v7, v152, v153
    v_lshlrev_b32 v152, 16, v7
    v_and_b32 v153, s40, v7
    v_cvt_pk_bf16_f32 v7, v154, v155
    v_lshlrev_b32 v154, 16, v7
    v_and_b32 v155, s40, v7
    v_add_f32 v10, v10, v120
    v_add_f32 v11, v11, v121
    v_add_f32 v12, v12, v122
    v_add_f32 v13, v13, v123
    v_add_f32 v14, v14, v124
    v_add_f32 v15, v15, v125
    v_add_f32 v16, v16, v126
    v_add_f32 v17, v17, v127
    v_add_f32 v18, v18, v128
    v_add_f32 v19, v19, v129
    v_add_f32 v20, v20, v130
    v_add_f32 v21, v21, v131
    v_add_f32 v22, v22, v132
    v_add_f32 v23, v23, v133
    v_add_f32 v24, v24, v134
    v_add_f32 v25, v25, v135
    v_add_f32 v26, v26, v136
    v_add_f32 v27, v27, v137
    v_add_f32 v28, v28, v138
    v_add_f32 v29, v29, v139
    v_add_f32 v30, v30, v140
    v_add_f32 v31, v31, v141
    v_add_f32 v32, v32, v142
    v_add_f32 v33, v33, v143
    v_add_f32 v34, v34, v144
    v_add_f32 v35, v35, v145
    v_add_f32 v36, v36, v146
    v_add_f32 v37, v37, v147
    v_add_f32 v38, v38, v148
    v_add_f32 v39, v39, v149
    v_add_f32 v40, v40, v150
    v_add_f32 v41, v41, v151
    v_add_f32 v42, v42, v152
    v_add_f32 v43, v43, v153
    v_add_f32 v44, v44, v154
    v_add_f32 v45, v45, v155
    v_cvt_pk_bf16_f32 v82, v10, v11
    v_lshlrev_b32 v10, 16, v82
    v_and_b32 v11, s40, v82
    v_cvt_pk_bf16_f32 v83, v12, v13
    v_lshlrev_b32 v12, 16, v83
    v_and_b32 v13, s40, v83
    v_cvt_pk_bf16_f32 v84, v14, v15
    v_lshlrev_b32 v14, 16, v84
    v_and_b32 v15, s40, v84
    v_cvt_pk_bf16_f32 v85, v16, v17
    v_lshlrev_b32 v16, 16, v85
    v_and_b32 v17, s40, v85
    v_cvt_pk_bf16_f32 v86, v18, v19
    v_lshlrev_b32 v18, 16, v86
    v_and_b32 v19, s40, v86
    v_cvt_pk_bf16_f32 v87, v20, v21
    v_lshlrev_b32 v20, 16, v87
    v_and_b32 v21, s40, v87
    v_cvt_pk_bf16_f32 v88, v22, v23
    v_lshlrev_b32 v22, 16, v88
    v_and_b32 v23, s40, v88
    v_cvt_pk_bf16_f32 v89, v24, v25
    v_lshlrev_b32 v24, 16, v89
    v_and_b32 v25, s40, v89
    v_cvt_pk_bf16_f32 v90, v26, v27
    v_lshlrev_b32 v26, 16, v90
    v_and_b32 v27, s40, v90
    v_cvt_pk_bf16_f32 v91, v28, v29
    v_lshlrev_b32 v28, 16, v91
    v_and_b32 v29, s40, v91
    v_cvt_pk_bf16_f32 v92, v30, v31
    v_lshlrev_b32 v30, 16, v92
    v_and_b32 v31, s40, v92
    v_cvt_pk_bf16_f32 v93, v32, v33
    v_lshlrev_b32 v32, 16, v93
    v_and_b32 v33, s40, v93
    v_cvt_pk_bf16_f32 v94, v34, v35
    v_lshlrev_b32 v34, 16, v94
    v_and_b32 v35, s40, v94
    v_cvt_pk_bf16_f32 v95, v36, v37
    v_lshlrev_b32 v36, 16, v95
    v_and_b32 v37, s40, v95
    v_cvt_pk_bf16_f32 v96, v38, v39
    v_lshlrev_b32 v38, 16, v96
    v_and_b32 v39, s40, v96
    v_cvt_pk_bf16_f32 v97, v40, v41
    v_lshlrev_b32 v40, 16, v97
    v_and_b32 v41, s40, v97
    v_cvt_pk_bf16_f32 v98, v42, v43
    v_lshlrev_b32 v42, 16, v98
    v_and_b32 v43, s40, v98
    v_cvt_pk_bf16_f32 v99, v44, v45
    v_lshlrev_b32 v44, 16, v99
    v_and_b32 v45, s40, v99
    buffer_store_dwordx2 v[82:83], v3, s[24:27], 0 offen offset:0
    buffer_store_dwordx2 v[84:85], v3, s[24:27], 0 offen offset:128
    buffer_store_dwordx2 v[86:87], v3, s[24:27], 0 offen offset:256
    buffer_store_dwordx2 v[88:89], v3, s[24:27], 0 offen offset:384
    buffer_store_dwordx2 v[90:91], v3, s[24:27], 0 offen offset:512
    buffer_store_dwordx2 v[92:93], v3, s[24:27], 0 offen offset:640
    buffer_store_dwordx2 v[94:95], v3, s[24:27], 0 offen offset:768
    buffer_store_dwordx2 v[96:97], v3, s[24:27], 0 offen offset:896
    buffer_store_dwordx2 v[98:99], v3, s[24:27], 0 offen offset:1024
    v_add_f32 v5, v10, v11
    v_add_f32 v5, v5, v12
    v_add_f32 v5, v5, v13
    v_add_f32 v5, v5, v14
    v_add_f32 v5, v5, v15
    v_add_f32 v5, v5, v16
    v_add_f32 v5, v5, v17
    v_add_f32 v5, v5, v18
    v_add_f32 v5, v5, v19
    v_add_f32 v5, v5, v20
    v_add_f32 v5, v5, v21
    v_add_f32 v5, v5, v22
    v_add_f32 v5, v5, v23
    v_add_f32 v5, v5, v24
    v_add_f32 v5, v5, v25
    v_add_f32 v5, v5, v26
    v_add_f32 v5, v5, v27
    v_add_f32 v5, v5, v28
    v_add_f32 v5, v5, v29
    v_add_f32 v5, v5, v30
    v_add_f32 v5, v5, v31
    v_add_f32 v5, v5, v32
    v_add_f32 v5, v5, v33
    v_add_f32 v5, v5, v34
    v_add_f32 v5, v5, v35
    v_add_f32 v5, v5, v36
    v_add_f32 v5, v5, v37
    v_add_f32 v5, v5, v38
    v_add_f32 v5, v5, v39
    v_add_f32 v5, v5, v40
    v_add_f32 v5, v5, v41
    v_add_f32 v5, v5, v42
    v_add_f32 v5, v5, v43
    v_add_f32 v5, v5, v44
    v_add_f32 v5, v5, v45
    s_nop 1
    v_add_f32_dpp v5, v5, v5 row_ror:8 row_mask:0xf bank_mask:0xf
    s_nop 1
    v_add_f32_dpp v5, v5, v5 row_ror:4 row_mask:0xf bank_mask:0xf
    s_nop 1
    v_add_f32_dpp v5, v5, v5 row_ror:2 row_mask:0xf bank_mask:0xf
    s_nop 1
    v_add_f32_dpp v5, v5, v5 row_ror:1 row_mask:0xf bank_mask:0xf
    v_mul_f32 v5, 0x3ae38e39, v5
    v_mov_b32 v6, 0
    v_sub_f32 v7, v10, v5
    v_fmac_f32 v6, v7, v7
    v_sub_f32 v7, v11, v5
    v_fmac_f32 v6, v7, v7
    v_sub_f32 v7, v12, v5
    v_fmac_f32 v6, v7, v7
    v_sub_f32 v7, v13, v5
    v_fmac_f32 v6, v7, v7
    v_sub_f32 v7, v14, v5
    v_fmac_f32 v6, v7, v7
    v_sub_f32 v7, v15, v5
    v_fmac_f32 v6, v7, v7
    v_sub_f32 v7, v16, v5
    v_fmac_f32 v6, v7, v7
    v_sub_f32 v7, v17, v5
    v_fmac_f32 v6, v7, v7
    v_sub_f32 v7, v18, v5
    v_fmac_f32 v6, v7, v7
    v_sub_f32 v7, v19, v5
    v_fmac_f32 v6, v7, v7
    v_sub_f32 v7, v20, v5
    v_fmac_f32 v6, v7, v7
    v_sub_f32 v7, v21, v5
    v_fmac_f32 v6, v7, v7
    v_sub_f32 v7, v22, v5
    v_fmac_f32 v6, v7, v7
    v_sub_f32 v7, v23, v5
    v_fmac_f32 v6, v7, v7
    v_sub_f32 v7, v24, v5
    v_fmac_f32 v6, v7, v7
    v_sub_f32 v7, v25, v5
    v_fmac_f32 v6, v7, v7
    v_sub_f32 v7, v26, v5
    v_fmac_f32 v6, v7, v7
    v_sub_f32 v7, v27, v5
    v_fmac_f32 v6, v7, v7
    v_sub_f32 v7, v28, v5
    v_fmac_f32 v6, v7, v7
    v_sub_f32 v7, v29, v5
    v_fmac_f32 v6, v7, v7
    v_sub_f32 v7, v30, v5
    v_fmac_f32 v6, v7, v7
    v_sub_f32 v7, v31, v5
    v_fmac_f32 v6, v7, v7
    v_sub_f32 v7, v32, v5
    v_fmac_f32 v6, v7, v7
    v_sub_f32 v7, v33, v5
    v_fmac_f32 v6, v7, v7
    v_sub_f32 v7, v34, v5
    v_fmac_f32 v6, v7, v7
    v_sub_f32 v7, v35, v5
    v_fmac_f32 v6, v7, v7
    v_sub_f32 v7, v36, v5
    v_fmac_f32 v6, v7, v7
    v_sub_f32 v7, v37, v5
    v_fmac_f32 v6, v7, v7
    v_sub_f32 v7, v38, v5
    v_fmac_f32 v6, v7, v7
    v_sub_f32 v7, v39, v5
    v_fmac_f32 v6, v7, v7
    v_sub_f32 v7, v40, v5
    v_fmac_f32 v6, v7, v7
    v_sub_f32 v7, v41, v5
    v_fmac_f32 v6, v7, v7
    v_sub_f32 v7, v42, v5
    v_fmac_f32 v6, v7, v7
    v_sub_f32 v7, v43, v5
    v_fmac_f32 v6, v7, v7
    v_sub_f32 v7, v44, v5
    v_fmac_f32 v6, v7, v7
    v_sub_f32 v7, v45, v5
    v_fmac_f32 v6, v7, v7
    s_nop 1
    v_add_f32_dpp v6, v6, v6 row_ror:8 row_mask:0xf bank_mask:0xf
    s_nop 1
    v_add_f32_dpp v6, v6, v6 row_ror:4 row_mask:0xf bank_mask:0xf
    s_nop 1
    v_add_f32_dpp v6, v6, v6 row_ror:2 row_mask:0xf bank_mask:0xf
    s_nop 1
    v_add_f32_dpp v6, v6, v6 row_ror:1 row_mask:0xf bank_mask:0xf
    v_mul_f32 v6, 0x3ae38e39, v6
    v_cvt_pk_bf16_f32 v7, v5, v6
    v_lshlrev_b32 v5, 16, v7
    v_and_b32 v6, s40, v7
    v_add_f32 v6, 0x3727c5ac, v6
    v_cvt_pk_bf16_f32 v7, v6, v6
    v_lshlrev_b32 v6, 16, v7
    v_sqrt_f32 v6, v6
    s_nop 0
    v_cvt_pk_bf16_f32 v7, v6, v6
    v_lshlrev_b32 v6, 16, v7
    v_rcp_f32 v6, v6
    v_sub_f32 v120, v10, v5
    v_sub_f32 v121, v11, v5
    v_sub_f32 v122, v12, v5
    v_sub_f32 v123, v13, v5
    v_sub_f32 v124, v14, v5
    v_sub_f32 v125, v15, v5
    v_sub_f32 v126, v16, v5
    v_sub_f32 v127, v17, v5
    v_sub_f32 v128, v18, v5
    v_sub_f32 v129, v19, v5
    v_sub_f32 v130, v20, v5
    v_sub_f32 v131, v21, v5
    v_sub_f32 v132, v22, v5
    v_sub_f32 v133, v23, v5
    v_sub_f32 v134, v24, v5
    v_sub_f32 v135, v25, v5
    v_sub_f32 v136, v26, v5
    v_sub_f32 v137, v27, v5
    v_sub_f32 v138, v28, v5
    v_sub_f32 v139, v29, v5
    v_sub_f32 v140, v30, v5
    v_sub_f32 v141, v31, v5
    v_sub_f32 v142, v32, v5
    v_sub_f32 v143, v33, v5
    v_sub_f32 v144, v34, v5
    v_sub_f32 v145, v35, v5
    v_sub_f32 v146, v36, v5
    v_sub_f32 v147, v37, v5
    v_sub_f32 v148, v38, v5
    v_sub_f32 v149, v39, v5
    v_sub_f32 v150, v40, v5
    v_sub_f32 v151, v41, v5
    v_sub_f32 v152, v42, v5
    v_sub_f32 v153, v43, v5
    v_sub_f32 v154, v44, v5
    v_sub_f32 v155, v45, v5
    v_cvt_pk_bf16_f32 v7, v120, v121
    v_lshlrev_b32 v120, 16, v7
    v_and_b32 v121, s40, v7
    v_cvt_pk_bf16_f32 v7, v122, v123
    v_lshlrev_b32 v122, 16, v7
    v_and_b32 v123, s40, v7
    v_cvt_pk_bf16_f32 v7, v124, v125
    v_lshlrev_b32 v124, 16, v7
    v_and_b32 v125, s40, v7
    v_cvt_pk_bf16_f32 v7, v126, v127
    v_lshlrev_b32 v126, 16, v7
    v_and_b32 v127, s40, v7
    v_cvt_pk_bf16_f32 v7, v128, v129
    v_lshlrev_b32 v128, 16, v7
    v_and_b32 v129, s40, v7
    v_cvt_pk_bf16_f32 v7, v130, v131
    v_lshlrev_b32 v130, 16, v7
    v_and_b32 v131, s40, v7
    v_cvt_pk_bf16_f32 v7, v132, v133
    v_lshlrev_b32 v132, 16, v7
    v_and_b32 v133, s40, v7
    v_cvt_pk_bf16_f32 v7, v134, v135
    v_lshlrev_b32 v134, 16, v7
    v_and_b32 v135, s40, v7
    v_cvt_pk_bf16_f32 v7, v136, v137
    v_lshlrev_b32 v136, 16, v7
    v_and_b32 v137, s40, v7
    v_cvt_pk_bf16_f32 v7, v138, v139
    v_lshlrev_b32 v138, 16, v7
    v_and_b32 v139, s40, v7
    v_cvt_pk_bf16_f32 v7, v140, v141
    v_lshlrev_b32 v140, 16, v7
    v_and_b32 v141, s40, v7
    v_cvt_pk_bf16_f32 v7, v142, v143
    v_lshlrev_b32 v142, 16, v7
    v_and_b32 v143, s40, v7
    v_cvt_pk_bf16_f32 v7, v144, v145
    v_lshlrev_b32 v144, 16, v7
    v_and_b32 v145, s40, v7
    v_cvt_pk_bf16_f32 v7, v146, v147
    v_lshlrev_b32 v146, 16, v7
    v_and_b32 v147, s40, v7
    v_cvt_pk_bf16_f32 v7, v148, v149
    v_lshlrev_b32 v148, 16, v7
    v_and_b32 v149, s40, v7
    v_cvt_pk_bf16_f32 v7, v150, v151
    v_lshlrev_b32 v150, 16, v7
    v_and_b32 v151, s40, v7
    v_cvt_pk_bf16_f32 v7, v152, v153
    v_lshlrev_b32 v152, 16, v7
    v_and_b32 v153, s40, v7
    v_cvt_pk_bf16_f32 v7, v154, v155
    v_lshlrev_b32 v154, 16, v7
    v_and_b32 v155, s40, v7
    v_mul_f32 v120, v120, v6
    v_mul_f32 v121, v121, v6
    v_mul_f32 v122, v122, v6
    v_mul_f32 v123, v123, v6
    v_mul_f32 v124, v124, v6
    v_mul_f32 v125, v125, v6
    v_mul_f32 v126, v126, v6
    v_mul_f32 v127, v127, v6
    v_mul_f32 v128, v128, v6
    v_mul_f32 v129, v129, v6
    v_mul_f32 v130, v130, v6
    v_mul_f32 v131, v131, v6
    v_mul_f32 v132, v132, v6
    v_mul_f32 v133, v133, v6
    v_mul_f32 v134, v134, v6
    v_mul_f32 v135, v135, v6
    v_mul_f32 v136, v136, v6
    v_mul_f32 v137, v137, v6
    v_mul_f32 v138, v138, v6
    v_mul_f32 v139, v139, v6
    v_mul_f32 v140, v140, v6
    v_mul_f32 v141, v141, v6
    v_mul_f32 v142, v142, v6
    v_mul_f32 v143, v143, v6
    v_mul_f32 v144, v144, v6
    v_mul_f32 v145, v145, v6
    v_mul_f32 v146, v146, v6
    v_mul_f32 v147, v147, v6
    v_mul_f32 v148, v148, v6
    v_mul_f32 v149, v149, v6
    v_mul_f32 v150, v150, v6
    v_mul_f32 v151, v151, v6
    v_mul_f32 v152, v152, v6
    v_mul_f32 v153, v153, v6
    v_mul_f32 v154, v154, v6
    v_mul_f32 v155, v155, v6
    v_cvt_pk_bf16_f32 v7, v120, v121
    v_lshlrev_b32 v120, 16, v7
    v_and_b32 v121, s40, v7
    v_cvt_pk_bf16_f32 v7, v122, v123
    v_lshlrev_b32 v122, 16, v7
    v_and_b32 v123, s40, v7
    v_cvt_pk_bf16_f32 v7, v124, v125
    v_lshlrev_b32 v124, 16, v7
    v_and_b32 v125, s40, v7
    v_cvt_pk_bf16_f32 v7, v126, v127
    v_lshlrev_b32 v126, 16, v7
    v_and_b32 v127, s40, v7
    v_cvt_pk_bf16_f32 v7, v128, v129
    v_lshlrev_b32 v128, 16, v7
    v_and_b32 v129, s40, v7
    v_cvt_pk_bf16_f32 v7, v130, v131
    v_lshlrev_b32 v130, 16, v7
    v_and_b32 v131, s40, v7
    v_cvt_pk_bf16_f32 v7, v132, v133
    v_lshlrev_b32 v132, 16, v7
    v_and_b32 v133, s40, v7
    v_cvt_pk_bf16_f32 v7, v134, v135
    v_lshlrev_b32 v134, 16, v7
    v_and_b32 v135, s40, v7
    v_cvt_pk_bf16_f32 v7, v136, v137
    v_lshlrev_b32 v136, 16, v7
    v_and_b32 v137, s40, v7
    v_cvt_pk_bf16_f32 v7, v138, v139
    v_lshlrev_b32 v138, 16, v7
    v_and_b32 v139, s40, v7
    v_cvt_pk_bf16_f32 v7, v140, v141
    v_lshlrev_b32 v140, 16, v7
    v_and_b32 v141, s40, v7
    v_cvt_pk_bf16_f32 v7, v142, v143
    v_lshlrev_b32 v142, 16, v7
    v_and_b32 v143, s40, v7
    v_cvt_pk_bf16_f32 v7, v144, v145
    v_lshlrev_b32 v144, 16, v7
    v_and_b32 v145, s40, v7
    v_cvt_pk_bf16_f32 v7, v146, v147
    v_lshlrev_b32 v146, 16, v7
    v_and_b32 v147, s40, v7
    v_cvt_pk_bf16_f32 v7, v148, v149
    v_lshlrev_b32 v148, 16, v7
    v_and_b32 v149, s40, v7
    v_cvt_pk_bf16_f32 v7, v150, v151
    v_lshlrev_b32 v150, 16, v7
    v_and_b32 v151, s40, v7
    v_cvt_pk_bf16_f32 v7, v152, v153
    v_lshlrev_b32 v152, 16, v7
    v_and_b32 v153, s40, v7
    v_cvt_pk_bf16_f32 v7, v154, v155
    v_lshlrev_b32 v154, 16, v7
    v_and_b32 v155, s40, v7
    v_cvt_pk_bf16_f32 v100, v120, v121
    v_cvt_pk_bf16_f32 v101, v122, v123
    v_cvt_pk_bf16_f32 v102, v124, v125
    v_cvt_pk_bf16_f32 v103, v126, v127
    v_cvt_pk_bf16_f32 v104, v128, v129
    v_cvt_pk_bf16_f32 v105, v130, v131
    v_cvt_pk_bf16_f32 v106, v132, v133
    v_cvt_pk_bf16_f32 v107, v134, v135
    v_cvt_pk_bf16_f32 v108, v136, v137
    v_cvt_pk_bf16_f32 v109, v138, v139
    v_cvt_pk_bf16_f32 v110, v140, v141
    v_cvt_pk_bf16_f32 v111, v142, v143
    v_cvt_pk_bf16_f32 v112, v144, v145
    v_cvt_pk_bf16_f32 v113, v146, v147
    v_cvt_pk_bf16_f32 v114, v148, v149
    v_cvt_pk_bf16_f32 v115, v150, v151
    v_cvt_pk_bf16_f32 v116, v152, v153
    v_cvt_pk_bf16_f32 v117, v154, v155
    s_movk_i32 s42, 0
    buffer_store_dwordx2 v[100:101], v8, s[28:31], s42 offen offset:0
    buffer_store_dwordx2 v[102:103], v8, s[28:31], s42 offen offset:2048
    s_movk_i32 s42, 4096
    buffer_store_dwordx2 v[104:105], v8, s[28:31], s42 offen offset:0
    buffer_store_dwordx2 v[106:107], v8, s[28:31], s42 offen offset:2048
    s_movk_i32 s42, 8192
    buffer_store_dwordx2 v[108:109], v8, s[28:31], s42 offen offset:0
    buffer_store_dwordx2 v[110:111], v8, s[28:31], s42 offen offset:2048
    s_movk_i32 s42, 12288
    buffer_store_dwordx2 v[112:113], v8, s[28:31], s42 offen offset:0
    buffer_store_dwordx2 v[114:115], v8, s[28:31], s42 offen offset:2048
    s_movk_i32 s42, 16384
    buffer_store_dwordx2 v[116:117], v8, s[28:31], s42 offen offset:0
    s_waitcnt vmcnt(0)
rowa_kernel_done:
    s_endpgm
.globl rowb_kernel
.p2align 8
.type rowb_kernel,@function
rowb_kernel:
    s_cmp_ge_u32 s2, 128
    s_cbranch_scc1 rowb_kernel_done
    s_load_dwordx2 s[4:5], s[0:1], 0
    s_load_dwordx2 s[6:7], s[0:1], 80
    s_load_dwordx2 s[8:9], s[0:1], 96
    s_mov_b32 s40, 0xffff0000
    v_lshrrev_b32 v1, 6, v0
    v_and_b32 v2, 63, v0
    v_readfirstlane_b32 s42, v1
    v_and_b32 v5, 15, v2
    v_lshrrev_b32 v6, 4, v2
    s_lshl_b32 s3, s2, 4
    v_add_u32 v3, s3, v5
    s_movk_i32 s41, 1152
    v_mul_lo_u32 v3, v3, s41
    v_lshl_add_u32 v3, v6, 3, v3
    s_mul_i32 s3, s42, 288
    v_add_u32 v3, s3, v3
    s_mul_i32 s3, s2, 36
    s_mul_i32 s43, s42, 9
    s_add_u32 s3, s3, s43
    s_lshl_b32 s3, s3, 10
    v_lshlrev_b32 v4, 4, v2
    v_add_u32 v4, s3, v4
    v_lshlrev_b32 v8, 4, v5
    v_lshrrev_b32 v7, 1, v6
    v_lshl_add_u32 v8, v7, 8, v8
    v_and_b32 v7, 1, v6
    v_lshl_add_u32 v8, v7, 3, v8
    s_mul_i32 s3, s2, 18432
    s_lshl_b32 s43, s43, 9
    s_add_u32 s3, s3, s43
    v_add_u32 v8, s3, v8
    v_lshlrev_b32 v9, 4, v5
    v_add_u32 v9, v9, v6
    s_lshl_b32 s3, s42, 2
    v_add_u32 v9, s3, v9
    v_lshlrev_b32 v9, 2, v9
    v_lshlrev_b32 v1, 6, v5
    s_waitcnt lgkmcnt(0)
    s_add_u32 s12, s8, 0x400000
    s_addc_u32 s13, s9, 0
    s_mov_b32 s14, 0x240000
    s_mov_b32 s15, 0x00020000
    s_mov_b32 s16, s8
    s_mov_b32 s17, s9
    s_mov_b32 s18, 0x240000
    s_mov_b32 s19, 0x00020000
    s_add_u32 s20, s8, 0x3000000
    s_addc_u32 s21, s9, 0
    s_mov_b32 s22, 0x1200000
    s_mov_b32 s23, 0x00020000
    s_add_u32 s24, s8, 0xc00000
    s_addc_u32 s25, s9, 0
    s_mov_b32 s26, 0x240000
    s_mov_b32 s27, 0x00020000
    s_add_u32 s28, s8, 0x800000
    s_addc_u32 s29, s9, 0
    s_mov_b32 s30, 0x240000
    s_mov_b32 s31, 0x00020000
    s_mov_b32 s44, 0x0
    buffer_load_dwordx4 v[120:123], v4, s[20:23], s44 offen offset:0
    buffer_load_dwordx4 v[124:127], v4, s[20:23], s44 offen offset:1024
    buffer_load_dwordx4 v[128:131], v4, s[20:23], s44 offen offset:2048
    buffer_load_dwordx4 v[132:135], v4, s[20:23], s44 offen offset:3072
    s_mov_b32 s44, 0x1000
    buffer_load_dwordx4 v[136:139], v4, s[20:23], s44 offen offset:0
    buffer_load_dwordx4 v[140:143], v4, s[20:23], s44 offen offset:1024
    buffer_load_dwordx4 v[144:147], v4, s[20:23], s44 offen offset:2048
    buffer_load_dwordx4 v[148:151], v4, s[20:23], s44 offen offset:3072
    s_mov_b32 s44, 0x2000
    buffer_load_dwordx4 v[152:155], v4, s[20:23], s44 offen offset:0
    s_mov_b32 s44, 0x480000
    buffer_load_dwordx4 v[156:159], v4, s[20:23], s44 offen offset:0
    buffer_load_dwordx4 v[160:163], v4, s[20:23], s44 offen offset:1024
    buffer_load_dwordx4 v[164:167], v4, s[20:23], s44 offen offset:2048
    buffer_load_dwordx4 v[168:171], v4, s[20:23], s44 offen offset:3072
    s_mov_b32 s44, 0x481000
    buffer_load_dwordx4 v[172:175], v4, s[20:23], s44 offen offset:0
    buffer_load_dwordx4 v[176:179], v4, s[20:23], s44 offen offset:1024
    buffer_load_dwordx4 v[180:183], v4, s[20:23], s44 offen offset:2048
    buffer_load_dwordx4 v[184:187], v4, s[20:23], s44 offen offset:3072
    s_mov_b32 s44, 0x482000
    buffer_load_dwordx4 v[188:191], v4, s[20:23], s44 offen offset:0
    s_mov_b32 s44, 0x900000
    buffer_load_dwordx4 v[192:195], v4, s[20:23], s44 offen offset:0
    buffer_load_dwordx4 v[196:199], v4, s[20:23], s44 offen offset:1024
    buffer_load_dwordx4 v[200:203], v4, s[20:23], s44 offen offset:2048
    buffer_load_dwordx4 v[204:207], v4, s[20:23], s44 offen offset:3072
    s_mov_b32 s44, 0x901000
    buffer_load_dwordx4 v[208:211], v4, s[20:23], s44 offen offset:0
    buffer_load_dwordx4 v[212:215], v4, s[20:23], s44 offen offset:1024
    buffer_load_dwordx4 v[216:219], v4, s[20:23], s44 offen offset:2048
    buffer_load_dwordx4 v[220:223], v4, s[20:23], s44 offen offset:3072
    s_mov_b32 s44, 0x902000
    buffer_load_dwordx4 v[224:227], v4, s[20:23], s44 offen offset:0
    buffer_load_dwordx2 v[82:83], v3, s[12:15], 0 offen offset:0
    buffer_load_dwordx2 v[84:85], v3, s[12:15], 0 offen offset:32
    buffer_load_dwordx2 v[86:87], v3, s[12:15], 0 offen offset:64
    buffer_load_dwordx2 v[88:89], v3, s[12:15], 0 offen offset:96
    buffer_load_dwordx2 v[90:91], v3, s[12:15], 0 offen offset:128
    buffer_load_dwordx2 v[92:93], v3, s[12:15], 0 offen offset:160
    buffer_load_dwordx2 v[94:95], v3, s[12:15], 0 offen offset:192
    buffer_load_dwordx2 v[96:97], v3, s[12:15], 0 offen offset:224
    buffer_load_dwordx2 v[98:99], v3, s[12:15], 0 offen offset:256
    buffer_load_dwordx2 v[100:101], v3, s[16:19], 0 offen offset:0
    buffer_load_dwordx2 v[102:103], v3, s[16:19], 0 offen offset:32
    buffer_load_dwordx2 v[104:105], v3, s[16:19], 0 offen offset:64
    buffer_load_dwordx2 v[106:107], v3, s[16:19], 0 offen offset:96
    buffer_load_dwordx2 v[108:109], v3, s[16:19], 0 offen offset:128
    buffer_load_dwordx2 v[110:111], v3, s[16:19], 0 offen offset:160
    buffer_load_dwordx2 v[112:113], v3, s[16:19], 0 offen offset:192
    buffer_load_dwordx2 v[114:115], v3, s[16:19], 0 offen offset:224
    buffer_load_dwordx2 v[116:117], v3, s[16:19], 0 offen offset:256
    s_waitcnt vmcnt(0)
    v_lshlrev_b32 v10, 16, v82
    v_and_b32 v11, s40, v82
    v_lshlrev_b32 v12, 16, v83
    v_and_b32 v13, s40, v83
    v_lshlrev_b32 v14, 16, v84
    v_and_b32 v15, s40, v84
    v_lshlrev_b32 v16, 16, v85
    v_and_b32 v17, s40, v85
    v_lshlrev_b32 v18, 16, v86
    v_and_b32 v19, s40, v86
    v_lshlrev_b32 v20, 16, v87
    v_and_b32 v21, s40, v87
    v_lshlrev_b32 v22, 16, v88
    v_and_b32 v23, s40, v88
    v_lshlrev_b32 v24, 16, v89
    v_and_b32 v25, s40, v89
    v_lshlrev_b32 v26, 16, v90
    v_and_b32 v27, s40, v90
    v_lshlrev_b32 v28, 16, v91
    v_and_b32 v29, s40, v91
    v_lshlrev_b32 v30, 16, v92
    v_and_b32 v31, s40, v92
    v_lshlrev_b32 v32, 16, v93
    v_and_b32 v33, s40, v93
    v_lshlrev_b32 v34, 16, v94
    v_and_b32 v35, s40, v94
    v_lshlrev_b32 v36, 16, v95
    v_and_b32 v37, s40, v95
    v_lshlrev_b32 v38, 16, v96
    v_and_b32 v39, s40, v96
    v_lshlrev_b32 v40, 16, v97
    v_and_b32 v41, s40, v97
    v_lshlrev_b32 v42, 16, v98
    v_and_b32 v43, s40, v98
    v_lshlrev_b32 v44, 16, v99
    v_and_b32 v45, s40, v99
    v_lshlrev_b32 v46, 16, v100
    v_and_b32 v47, s40, v100
    v_lshlrev_b32 v48, 16, v101
    v_and_b32 v49, s40, v101
    v_lshlrev_b32 v50, 16, v102
    v_and_b32 v51, s40, v102
    v_lshlrev_b32 v52, 16, v103
    v_and_b32 v53, s40, v103
    v_lshlrev_b32 v54, 16, v104
    v_and_b32 v55, s40, v104
    v_lshlrev_b32 v56, 16, v105
    v_and_b32 v57, s40, v105
    v_lshlrev_b32 v58, 16, v106
    v_and_b32 v59, s40, v106
    v_lshlrev_b32 v60, 16, v107
    v_and_b32 v61, s40, v107
    v_lshlrev_b32 v62, 16, v108
    v_and_b32 v63, s40, v108
    v_lshlrev_b32 v64, 16, v109
    v_and_b32 v65, s40, v109
    v_lshlrev_b32 v66, 16, v110
    v_and_b32 v67, s40, v110
    v_lshlrev_b32 v68, 16, v111
    v_and_b32 v69, s40, v111
    v_lshlrev_b32 v70, 16, v112
    v_and_b32 v71, s40, v112
    v_lshlrev_b32 v72, 16, v113
    v_and_b32 v73, s40, v113
    v_lshlrev_b32 v74, 16, v114
    v_and_b32 v75, s40, v114
    v_lshlrev_b32 v76, 16, v115
    v_and_b32 v77, s40, v115
    v_lshlrev_b32 v78, 16, v116
    v_and_b32 v79, s40, v116
    v_lshlrev_b32 v80, 16, v117
    v_and_b32 v81, s40, v117
    v_add_f32 v120, v120, v156
    v_add_f32 v121, v121, v157
    v_add_f32 v122, v122, v158
    v_add_f32 v123, v123, v159
    v_add_f32 v124, v124, v160
    v_add_f32 v125, v125, v161
    v_add_f32 v126, v126, v162
    v_add_f32 v127, v127, v163
    v_add_f32 v128, v128, v164
    v_add_f32 v129, v129, v165
    v_add_f32 v130, v130, v166
    v_add_f32 v131, v131, v167
    v_add_f32 v132, v132, v168
    v_add_f32 v133, v133, v169
    v_add_f32 v134, v134, v170
    v_add_f32 v135, v135, v171
    v_add_f32 v136, v136, v172
    v_add_f32 v137, v137, v173
    v_add_f32 v138, v138, v174
    v_add_f32 v139, v139, v175
    v_add_f32 v140, v140, v176
    v_add_f32 v141, v141, v177
    v_add_f32 v142, v142, v178
    v_add_f32 v143, v143, v179
    v_add_f32 v144, v144, v180
    v_add_f32 v145, v145, v181
    v_add_f32 v146, v146, v182
    v_add_f32 v147, v147, v183
    v_add_f32 v148, v148, v184
    v_add_f32 v149, v149, v185
    v_add_f32 v150, v150, v186
    v_add_f32 v151, v151, v187
    v_add_f32 v152, v152, v188
    v_add_f32 v153, v153, v189
    v_add_f32 v154, v154, v190
    v_add_f32 v155, v155, v191
    s_mov_b32 s44, 0xd80000
    buffer_load_dwordx4 v[156:159], v4, s[20:23], s44 offen offset:0
    buffer_load_dwordx4 v[160:163], v4, s[20:23], s44 offen offset:1024
    buffer_load_dwordx4 v[164:167], v4, s[20:23], s44 offen offset:2048
    buffer_load_dwordx4 v[168:171], v4, s[20:23], s44 offen offset:3072
    s_mov_b32 s44, 0xd81000
    buffer_load_dwordx4 v[172:175], v4, s[20:23], s44 offen offset:0
    buffer_load_dwordx4 v[176:179], v4, s[20:23], s44 offen offset:1024
    buffer_load_dwordx4 v[180:183], v4, s[20:23], s44 offen offset:2048
    buffer_load_dwordx4 v[184:187], v4, s[20:23], s44 offen offset:3072
    s_mov_b32 s44, 0xd82000
    buffer_load_dwordx4 v[188:191], v4, s[20:23], s44 offen offset:0
    v_add_f32 v120, v120, v192
    v_add_f32 v121, v121, v193
    v_add_f32 v122, v122, v194
    v_add_f32 v123, v123, v195
    v_add_f32 v124, v124, v196
    v_add_f32 v125, v125, v197
    v_add_f32 v126, v126, v198
    v_add_f32 v127, v127, v199
    v_add_f32 v128, v128, v200
    v_add_f32 v129, v129, v201
    v_add_f32 v130, v130, v202
    v_add_f32 v131, v131, v203
    v_add_f32 v132, v132, v204
    v_add_f32 v133, v133, v205
    v_add_f32 v134, v134, v206
    v_add_f32 v135, v135, v207
    v_add_f32 v136, v136, v208
    v_add_f32 v137, v137, v209
    v_add_f32 v138, v138, v210
    v_add_f32 v139, v139, v211
    v_add_f32 v140, v140, v212
    v_add_f32 v141, v141, v213
    v_add_f32 v142, v142, v214
    v_add_f32 v143, v143, v215
    v_add_f32 v144, v144, v216
    v_add_f32 v145, v145, v217
    v_add_f32 v146, v146, v218
    v_add_f32 v147, v147, v219
    v_add_f32 v148, v148, v220
    v_add_f32 v149, v149, v221
    v_add_f32 v150, v150, v222
    v_add_f32 v151, v151, v223
    v_add_f32 v152, v152, v224
    v_add_f32 v153, v153, v225
    v_add_f32 v154, v154, v226
    v_add_f32 v155, v155, v227
    s_waitcnt vmcnt(0)
    v_add_f32 v120, v120, v156
    v_add_f32 v121, v121, v157
    v_add_f32 v122, v122, v158
    v_add_f32 v123, v123, v159
    v_add_f32 v124, v124, v160
    v_add_f32 v125, v125, v161
    v_add_f32 v126, v126, v162
    v_add_f32 v127, v127, v163
    v_add_f32 v128, v128, v164
    v_add_f32 v129, v129, v165
    v_add_f32 v130, v130, v166
    v_add_f32 v131, v131, v167
    v_add_f32 v132, v132, v168
    v_add_f32 v133, v133, v169
    v_add_f32 v134, v134, v170
    v_add_f32 v135, v135, v171
    v_add_f32 v136, v136, v172
    v_add_f32 v137, v137, v173
    v_add_f32 v138, v138, v174
    v_add_f32 v139, v139, v175
    v_add_f32 v140, v140, v176
    v_add_f32 v141, v141, v177
    v_add_f32 v142, v142, v178
    v_add_f32 v143, v143, v179
    v_add_f32 v144, v144, v180
    v_add_f32 v145, v145, v181
    v_add_f32 v146, v146, v182
    v_add_f32 v147, v147, v183
    v_add_f32 v148, v148, v184
    v_add_f32 v149, v149, v185
    v_add_f32 v150, v150, v186
    v_add_f32 v151, v151, v187
    v_add_f32 v152, v152, v188
    v_add_f32 v153, v153, v189
    v_add_f32 v154, v154, v190
    v_add_f32 v155, v155, v191
    v_cvt_pk_bf16_f32 v5, v120, v121
    v_lshlrev_b32 v120, 16, v5
    v_and_b32 v121, s40, v5
    v_cvt_pk_bf16_f32 v5, v122, v123
    v_lshlrev_b32 v122, 16, v5
    v_and_b32 v123, s40, v5
    v_cvt_pk_bf16_f32 v5, v124, v125
    v_lshlrev_b32 v124, 16, v5
    v_and_b32 v125, s40, v5
    v_cvt_pk_bf16_f32 v5, v126, v127
    v_lshlrev_b32 v126, 16, v5
    v_and_b32 v127, s40, v5
    v_cvt_pk_bf16_f32 v5, v128, v129
    v_lshlrev_b32 v128, 16, v5
    v_and_b32 v129, s40, v5
    v_cvt_pk_bf16_f32 v5, v130, v131
    v_lshlrev_b32 v130, 16, v5
    v_and_b32 v131, s40, v5
    v_cvt_pk_bf16_f32 v5, v132, v133
    v_lshlrev_b32 v132, 16, v5
    v_and_b32 v133, s40, v5
    v_cvt_pk_bf16_f32 v5, v134, v135
    v_lshlrev_b32 v134, 16, v5
    v_and_b32 v135, s40, v5
    v_cvt_pk_bf16_f32 v5, v136, v137
    v_lshlrev_b32 v136, 16, v5
    v_and_b32 v137, s40, v5
    v_cvt_pk_bf16_f32 v5, v138, v139
    v_lshlrev_b32 v138, 16, v5
    v_and_b32 v139, s40, v5
    v_cvt_pk_bf16_f32 v5, v140, v141
    v_lshlrev_b32 v140, 16, v5
    v_and_b32 v141, s40, v5
    v_cvt_pk_bf16_f32 v5, v142, v143
    v_lshlrev_b32 v142, 16, v5
    v_and_b32 v143, s40, v5
    v_cvt_pk_bf16_f32 v5, v144, v145
    v_lshlrev_b32 v144, 16, v5
    v_and_b32 v145, s40, v5
    v_cvt_pk_bf16_f32 v5, v146, v147
    v_lshlrev_b32 v146, 16, v5
    v_and_b32 v147, s40, v5
    v_cvt_pk_bf16_f32 v5, v148, v149
    v_lshlrev_b32 v148, 16, v5
    v_and_b32 v149, s40, v5
    v_cvt_pk_bf16_f32 v5, v150, v151
    v_lshlrev_b32 v150, 16, v5
    v_and_b32 v151, s40, v5
    v_cvt_pk_bf16_f32 v5, v152, v153
    v_lshlrev_b32 v152, 16, v5
    v_and_b32 v153, s40, v5
    v_cvt_pk_bf16_f32 v5, v154, v155
    v_lshlrev_b32 v154, 16, v5
    v_and_b32 v155, s40, v5
    v_add_f32 v10, v10, v120
    v_add_f32 v11, v11, v121
    v_add_f32 v12, v12, v122
    v_add_f32 v13, v13, v123
    v_add_f32 v14, v14, v124
    v_add_f32 v15, v15, v125
    v_add_f32 v16, v16, v126
    v_add_f32 v17, v17, v127
    v_add_f32 v18, v18, v128
    v_add_f32 v19, v19, v129
    v_add_f32 v20, v20, v130
    v_add_f32 v21, v21, v131
    v_add_f32 v22, v22, v132
    v_add_f32 v23, v23, v133
    v_add_f32 v24, v24, v134
    v_add_f32 v25, v25, v135
    v_add_f32 v26, v26, v136
    v_add_f32 v27, v27, v137
    v_add_f32 v28, v28, v138
    v_add_f32 v29, v29, v139
    v_add_f32 v30, v30, v140
    v_add_f32 v31, v31, v141
    v_add_f32 v32, v32, v142
    v_add_f32 v33, v33, v143
    v_add_f32 v34, v34, v144
    v_add_f32 v35, v35, v145
    v_add_f32 v36, v36, v146
    v_add_f32 v37, v37, v147
    v_add_f32 v38, v38, v148
    v_add_f32 v39, v39, v149
    v_add_f32 v40, v40, v150
    v_add_f32 v41, v41, v151
    v_add_f32 v42, v42, v152
    v_add_f32 v43, v43, v153
    v_add_f32 v44, v44, v154
    v_add_f32 v45, v45, v155
    v_cvt_pk_bf16_f32 v5, v10, v11
    v_lshlrev_b32 v10, 16, v5
    v_and_b32 v11, s40, v5
    v_cvt_pk_bf16_f32 v5, v12, v13
    v_lshlrev_b32 v12, 16, v5
    v_and_b32 v13, s40, v5
    v_cvt_pk_bf16_f32 v5, v14, v15
    v_lshlrev_b32 v14, 16, v5
    v_and_b32 v15, s40, v5
    v_cvt_pk_bf16_f32 v5, v16, v17
    v_lshlrev_b32 v16, 16, v5
    v_and_b32 v17, s40, v5
    v_cvt_pk_bf16_f32 v5, v18, v19
    v_lshlrev_b32 v18, 16, v5
    v_and_b32 v19, s40, v5
    v_cvt_pk_bf16_f32 v5, v20, v21
    v_lshlrev_b32 v20, 16, v5
    v_and_b32 v21, s40, v5
    v_cvt_pk_bf16_f32 v5, v22, v23
    v_lshlrev_b32 v22, 16, v5
    v_and_b32 v23, s40, v5
    v_cvt_pk_bf16_f32 v5, v24, v25
    v_lshlrev_b32 v24, 16, v5
    v_and_b32 v25, s40, v5
    v_cvt_pk_bf16_f32 v5, v26, v27
    v_lshlrev_b32 v26, 16, v5
    v_and_b32 v27, s40, v5
    v_cvt_pk_bf16_f32 v5, v28, v29
    v_lshlrev_b32 v28, 16, v5
    v_and_b32 v29, s40, v5
    v_cvt_pk_bf16_f32 v5, v30, v31
    v_lshlrev_b32 v30, 16, v5
    v_and_b32 v31, s40, v5
    v_cvt_pk_bf16_f32 v5, v32, v33
    v_lshlrev_b32 v32, 16, v5
    v_and_b32 v33, s40, v5
    v_cvt_pk_bf16_f32 v5, v34, v35
    v_lshlrev_b32 v34, 16, v5
    v_and_b32 v35, s40, v5
    v_cvt_pk_bf16_f32 v5, v36, v37
    v_lshlrev_b32 v36, 16, v5
    v_and_b32 v37, s40, v5
    v_cvt_pk_bf16_f32 v5, v38, v39
    v_lshlrev_b32 v38, 16, v5
    v_and_b32 v39, s40, v5
    v_cvt_pk_bf16_f32 v5, v40, v41
    v_lshlrev_b32 v40, 16, v5
    v_and_b32 v41, s40, v5
    v_cvt_pk_bf16_f32 v5, v42, v43
    v_lshlrev_b32 v42, 16, v5
    v_and_b32 v43, s40, v5
    v_cvt_pk_bf16_f32 v5, v44, v45
    v_lshlrev_b32 v44, 16, v5
    v_and_b32 v45, s40, v5
    v_add_f32 v5, v10, v11
    v_add_f32 v5, v5, v12
    v_add_f32 v5, v5, v13
    v_add_f32 v5, v5, v14
    v_add_f32 v5, v5, v15
    v_add_f32 v5, v5, v16
    v_add_f32 v5, v5, v17
    v_add_f32 v5, v5, v18
    v_add_f32 v5, v5, v19
    v_add_f32 v5, v5, v20
    v_add_f32 v5, v5, v21
    v_add_f32 v5, v5, v22
    v_add_f32 v5, v5, v23
    v_add_f32 v5, v5, v24
    v_add_f32 v5, v5, v25
    v_add_f32 v5, v5, v26
    v_add_f32 v5, v5, v27
    v_add_f32 v5, v5, v28
    v_add_f32 v5, v5, v29
    v_add_f32 v5, v5, v30
    v_add_f32 v5, v5, v31
    v_add_f32 v5, v5, v32
    v_add_f32 v5, v5, v33
    v_add_f32 v5, v5, v34
    v_add_f32 v5, v5, v35
    v_add_f32 v5, v5, v36
    v_add_f32 v5, v5, v37
    v_add_f32 v5, v5, v38
    v_add_f32 v5, v5, v39
    v_add_f32 v5, v5, v40
    v_add_f32 v5, v5, v41
    v_add_f32 v5, v5, v42
    v_add_f32 v5, v5, v43
    v_add_f32 v5, v5, v44
    v_add_f32 v5, v5, v45
    ds_write_b32 v9, v5 offset:0
    s_waitcnt lgkmcnt(0)
    s_barrier
    ds_read_b128 v[160:163], v1 offset:0
    ds_read_b128 v[164:167], v1 offset:16
    ds_read_b128 v[168:171], v1 offset:32
    ds_read_b128 v[172:175], v1 offset:48
    s_waitcnt lgkmcnt(0)
    v_add_f32 v5, v160, v161
    v_add_f32 v5, v5, v162
    v_add_f32 v5, v5, v163
    v_add_f32 v5, v5, v164
    v_add_f32 v5, v5, v165
    v_add_f32 v5, v5, v166
    v_add_f32 v5, v5, v167
    v_add_f32 v5, v5, v168
    v_add_f32 v5, v5, v169
    v_add_f32 v5, v5, v170
    v_add_f32 v5, v5, v171
    v_add_f32 v5, v5, v172
    v_add_f32 v5, v5, v173
    v_add_f32 v5, v5, v174
    v_add_f32 v5, v5, v175
    v_mul_f32 v5, 0x3ae38e39, v5
    v_mov_b32 v6, 0
    v_sub_f32 v7, v10, v5
    v_fmac_f32 v6, v7, v7
    v_sub_f32 v7, v11, v5
    v_fmac_f32 v6, v7, v7
    v_sub_f32 v7, v12, v5
    v_fmac_f32 v6, v7, v7
    v_sub_f32 v7, v13, v5
    v_fmac_f32 v6, v7, v7
    v_sub_f32 v7, v14, v5
    v_fmac_f32 v6, v7, v7
    v_sub_f32 v7, v15, v5
    v_fmac_f32 v6, v7, v7
    v_sub_f32 v7, v16, v5
    v_fmac_f32 v6, v7, v7
    v_sub_f32 v7, v17, v5
    v_fmac_f32 v6, v7, v7
    v_sub_f32 v7, v18, v5
    v_fmac_f32 v6, v7, v7
    v_sub_f32 v7, v19, v5
    v_fmac_f32 v6, v7, v7
    v_sub_f32 v7, v20, v5
    v_fmac_f32 v6, v7, v7
    v_sub_f32 v7, v21, v5
    v_fmac_f32 v6, v7, v7
    v_sub_f32 v7, v22, v5
    v_fmac_f32 v6, v7, v7
    v_sub_f32 v7, v23, v5
    v_fmac_f32 v6, v7, v7
    v_sub_f32 v7, v24, v5
    v_fmac_f32 v6, v7, v7
    v_sub_f32 v7, v25, v5
    v_fmac_f32 v6, v7, v7
    v_sub_f32 v7, v26, v5
    v_fmac_f32 v6, v7, v7
    v_sub_f32 v7, v27, v5
    v_fmac_f32 v6, v7, v7
    v_sub_f32 v7, v28, v5
    v_fmac_f32 v6, v7, v7
    v_sub_f32 v7, v29, v5
    v_fmac_f32 v6, v7, v7
    v_sub_f32 v7, v30, v5
    v_fmac_f32 v6, v7, v7
    v_sub_f32 v7, v31, v5
    v_fmac_f32 v6, v7, v7
    v_sub_f32 v7, v32, v5
    v_fmac_f32 v6, v7, v7
    v_sub_f32 v7, v33, v5
    v_fmac_f32 v6, v7, v7
    v_sub_f32 v7, v34, v5
    v_fmac_f32 v6, v7, v7
    v_sub_f32 v7, v35, v5
    v_fmac_f32 v6, v7, v7
    v_sub_f32 v7, v36, v5
    v_fmac_f32 v6, v7, v7
    v_sub_f32 v7, v37, v5
    v_fmac_f32 v6, v7, v7
    v_sub_f32 v7, v38, v5
    v_fmac_f32 v6, v7, v7
    v_sub_f32 v7, v39, v5
    v_fmac_f32 v6, v7, v7
    v_sub_f32 v7, v40, v5
    v_fmac_f32 v6, v7, v7
    v_sub_f32 v7, v41, v5
    v_fmac_f32 v6, v7, v7
    v_sub_f32 v7, v42, v5
    v_fmac_f32 v6, v7, v7
    v_sub_f32 v7, v43, v5
    v_fmac_f32 v6, v7, v7
    v_sub_f32 v7, v44, v5
    v_fmac_f32 v6, v7, v7
    v_sub_f32 v7, v45, v5
    v_fmac_f32 v6, v7, v7
    ds_write_b32 v9, v6 offset:1024
    s_waitcnt lgkmcnt(0)
    s_barrier
    ds_read_b128 v[160:163], v1 offset:1024
    ds_read_b128 v[164:167], v1 offset:1040
    ds_read_b128 v[168:171], v1 offset:1056
    ds_read_b128 v[172:175], v1 offset:1072
    s_waitcnt lgkmcnt(0)
    v_add_f32 v6, v160, v161
    v_add_f32 v6, v6, v162
    v_add_f32 v6, v6, v163
    v_add_f32 v6, v6, v164
    v_add_f32 v6, v6, v165
    v_add_f32 v6, v6, v166
    v_add_f32 v6, v6, v167
    v_add_f32 v6, v6, v168
    v_add_f32 v6, v6, v169
    v_add_f32 v6, v6, v170
    v_add_f32 v6, v6, v171
    v_add_f32 v6, v6, v172
    v_add_f32 v6, v6, v173
    v_add_f32 v6, v6, v174
    v_add_f32 v6, v6, v175
    v_mul_f32 v6, 0x3ae38e39, v6
    v_cvt_pk_bf16_f32 v7, v5, v6
    v_lshlrev_b32 v5, 16, v7
    v_and_b32 v6, s40, v7
    v_add_f32 v6, 0x3727c5ac, v6
    v_cvt_pk_bf16_f32 v7, v6, v6
    v_lshlrev_b32 v6, 16, v7
    v_sqrt_f32 v6, v6
    s_nop 0
    v_cvt_pk_bf16_f32 v7, v6, v6
    v_lshlrev_b32 v6, 16, v7
    v_rcp_f32 v6, v6
    v_sub_f32 v120, v10, v5
    v_sub_f32 v121, v11, v5
    v_sub_f32 v122, v12, v5
    v_sub_f32 v123, v13, v5
    v_sub_f32 v124, v14, v5
    v_sub_f32 v125, v15, v5
    v_sub_f32 v126, v16, v5
    v_sub_f32 v127, v17, v5
    v_sub_f32 v128, v18, v5
    v_sub_f32 v129, v19, v5
    v_sub_f32 v130, v20, v5
    v_sub_f32 v131, v21, v5
    v_sub_f32 v132, v22, v5
    v_sub_f32 v133, v23, v5
    v_sub_f32 v134, v24, v5
    v_sub_f32 v135, v25, v5
    v_sub_f32 v136, v26, v5
    v_sub_f32 v137, v27, v5
    v_sub_f32 v138, v28, v5
    v_sub_f32 v139, v29, v5
    v_sub_f32 v140, v30, v5
    v_sub_f32 v141, v31, v5
    v_sub_f32 v142, v32, v5
    v_sub_f32 v143, v33, v5
    v_sub_f32 v144, v34, v5
    v_sub_f32 v145, v35, v5
    v_sub_f32 v146, v36, v5
    v_sub_f32 v147, v37, v5
    v_sub_f32 v148, v38, v5
    v_sub_f32 v149, v39, v5
    v_sub_f32 v150, v40, v5
    v_sub_f32 v151, v41, v5
    v_sub_f32 v152, v42, v5
    v_sub_f32 v153, v43, v5
    v_sub_f32 v154, v44, v5
    v_sub_f32 v155, v45, v5
    v_cvt_pk_bf16_f32 v7, v120, v121
    v_lshlrev_b32 v120, 16, v7
    v_and_b32 v121, s40, v7
    v_cvt_pk_bf16_f32 v7, v122, v123
    v_lshlrev_b32 v122, 16, v7
    v_and_b32 v123, s40, v7
    v_cvt_pk_bf16_f32 v7, v124, v125
    v_lshlrev_b32 v124, 16, v7
    v_and_b32 v125, s40, v7
    v_cvt_pk_bf16_f32 v7, v126, v127
    v_lshlrev_b32 v126, 16, v7
    v_and_b32 v127, s40, v7
    v_cvt_pk_bf16_f32 v7, v128, v129
    v_lshlrev_b32 v128, 16, v7
    v_and_b32 v129, s40, v7
    v_cvt_pk_bf16_f32 v7, v130, v131
    v_lshlrev_b32 v130, 16, v7
    v_and_b32 v131, s40, v7
    v_cvt_pk_bf16_f32 v7, v132, v133
    v_lshlrev_b32 v132, 16, v7
    v_and_b32 v133, s40, v7
    v_cvt_pk_bf16_f32 v7, v134, v135
    v_lshlrev_b32 v134, 16, v7
    v_and_b32 v135, s40, v7
    v_cvt_pk_bf16_f32 v7, v136, v137
    v_lshlrev_b32 v136, 16, v7
    v_and_b32 v137, s40, v7
    v_cvt_pk_bf16_f32 v7, v138, v139
    v_lshlrev_b32 v138, 16, v7
    v_and_b32 v139, s40, v7
    v_cvt_pk_bf16_f32 v7, v140, v141
    v_lshlrev_b32 v140, 16, v7
    v_and_b32 v141, s40, v7
    v_cvt_pk_bf16_f32 v7, v142, v143
    v_lshlrev_b32 v142, 16, v7
    v_and_b32 v143, s40, v7
    v_cvt_pk_bf16_f32 v7, v144, v145
    v_lshlrev_b32 v144, 16, v7
    v_and_b32 v145, s40, v7
    v_cvt_pk_bf16_f32 v7, v146, v147
    v_lshlrev_b32 v146, 16, v7
    v_and_b32 v147, s40, v7
    v_cvt_pk_bf16_f32 v7, v148, v149
    v_lshlrev_b32 v148, 16, v7
    v_and_b32 v149, s40, v7
    v_cvt_pk_bf16_f32 v7, v150, v151
    v_lshlrev_b32 v150, 16, v7
    v_and_b32 v151, s40, v7
    v_cvt_pk_bf16_f32 v7, v152, v153
    v_lshlrev_b32 v152, 16, v7
    v_and_b32 v153, s40, v7
    v_cvt_pk_bf16_f32 v7, v154, v155
    v_lshlrev_b32 v154, 16, v7
    v_and_b32 v155, s40, v7
    v_mul_f32 v120, v120, v6
    v_mul_f32 v121, v121, v6
    v_mul_f32 v122, v122, v6
    v_mul_f32 v123, v123, v6
    v_mul_f32 v124, v124, v6
    v_mul_f32 v125, v125, v6
    v_mul_f32 v126, v126, v6
    v_mul_f32 v127, v127, v6
    v_mul_f32 v128, v128, v6
    v_mul_f32 v129, v129, v6
    v_mul_f32 v130, v130, v6
    v_mul_f32 v131, v131, v6
    v_mul_f32 v132, v132, v6
    v_mul_f32 v133, v133, v6
    v_mul_f32 v134, v134, v6
    v_mul_f32 v135, v135, v6
    v_mul_f32 v136, v136, v6
    v_mul_f32 v137, v137, v6
    v_mul_f32 v138, v138, v6
    v_mul_f32 v139, v139, v6
    v_mul_f32 v140, v140, v6
    v_mul_f32 v141, v141, v6
    v_mul_f32 v142, v142, v6
    v_mul_f32 v143, v143, v6
    v_mul_f32 v144, v144, v6
    v_mul_f32 v145, v145, v6
    v_mul_f32 v146, v146, v6
    v_mul_f32 v147, v147, v6
    v_mul_f32 v148, v148, v6
    v_mul_f32 v149, v149, v6
    v_mul_f32 v150, v150, v6
    v_mul_f32 v151, v151, v6
    v_mul_f32 v152, v152, v6
    v_mul_f32 v153, v153, v6
    v_mul_f32 v154, v154, v6
    v_mul_f32 v155, v155, v6
    v_cvt_pk_bf16_f32 v7, v120, v121
    v_lshlrev_b32 v120, 16, v7
    v_and_b32 v121, s40, v7
    v_cvt_pk_bf16_f32 v7, v122, v123
    v_lshlrev_b32 v122, 16, v7
    v_and_b32 v123, s40, v7
    v_cvt_pk_bf16_f32 v7, v124, v125
    v_lshlrev_b32 v124, 16, v7
    v_and_b32 v125, s40, v7
    v_cvt_pk_bf16_f32 v7, v126, v127
    v_lshlrev_b32 v126, 16, v7
    v_and_b32 v127, s40, v7
    v_cvt_pk_bf16_f32 v7, v128, v129
    v_lshlrev_b32 v128, 16, v7
    v_and_b32 v129, s40, v7
    v_cvt_pk_bf16_f32 v7, v130, v131
    v_lshlrev_b32 v130, 16, v7
    v_and_b32 v131, s40, v7
    v_cvt_pk_bf16_f32 v7, v132, v133
    v_lshlrev_b32 v132, 16, v7
    v_and_b32 v133, s40, v7
    v_cvt_pk_bf16_f32 v7, v134, v135
    v_lshlrev_b32 v134, 16, v7
    v_and_b32 v135, s40, v7
    v_cvt_pk_bf16_f32 v7, v136, v137
    v_lshlrev_b32 v136, 16, v7
    v_and_b32 v137, s40, v7
    v_cvt_pk_bf16_f32 v7, v138, v139
    v_lshlrev_b32 v138, 16, v7
    v_and_b32 v139, s40, v7
    v_cvt_pk_bf16_f32 v7, v140, v141
    v_lshlrev_b32 v140, 16, v7
    v_and_b32 v141, s40, v7
    v_cvt_pk_bf16_f32 v7, v142, v143
    v_lshlrev_b32 v142, 16, v7
    v_and_b32 v143, s40, v7
    v_cvt_pk_bf16_f32 v7, v144, v145
    v_lshlrev_b32 v144, 16, v7
    v_and_b32 v145, s40, v7
    v_cvt_pk_bf16_f32 v7, v146, v147
    v_lshlrev_b32 v146, 16, v7
    v_and_b32 v147, s40, v7
    v_cvt_pk_bf16_f32 v7, v148, v149
    v_lshlrev_b32 v148, 16, v7
    v_and_b32 v149, s40, v7
    v_cvt_pk_bf16_f32 v7, v150, v151
    v_lshlrev_b32 v150, 16, v7
    v_and_b32 v151, s40, v7
    v_cvt_pk_bf16_f32 v7, v152, v153
    v_lshlrev_b32 v152, 16, v7
    v_and_b32 v153, s40, v7
    v_cvt_pk_bf16_f32 v7, v154, v155
    v_lshlrev_b32 v154, 16, v7
    v_and_b32 v155, s40, v7
    v_mul_f32 v120, v120, v46
    v_mul_f32 v121, v121, v47
    v_mul_f32 v122, v122, v48
    v_mul_f32 v123, v123, v49
    v_mul_f32 v124, v124, v50
    v_mul_f32 v125, v125, v51
    v_mul_f32 v126, v126, v52
    v_mul_f32 v127, v127, v53
    v_mul_f32 v128, v128, v54
    v_mul_f32 v129, v129, v55
    v_mul_f32 v130, v130, v56
    v_mul_f32 v131, v131, v57
    v_mul_f32 v132, v132, v58
    v_mul_f32 v133, v133, v59
    v_mul_f32 v134, v134, v60
    v_mul_f32 v135, v135, v61
    v_mul_f32 v136, v136, v62
    v_mul_f32 v137, v137, v63
    v_mul_f32 v138, v138, v64
    v_mul_f32 v139, v139, v65
    v_mul_f32 v140, v140, v66
    v_mul_f32 v141, v141, v67
    v_mul_f32 v142, v142, v68
    v_mul_f32 v143, v143, v69
    v_mul_f32 v144, v144, v70
    v_mul_f32 v145, v145, v71
    v_mul_f32 v146, v146, v72
    v_mul_f32 v147, v147, v73
    v_mul_f32 v148, v148, v74
    v_mul_f32 v149, v149, v75
    v_mul_f32 v150, v150, v76
    v_mul_f32 v151, v151, v77
    v_mul_f32 v152, v152, v78
    v_mul_f32 v153, v153, v79
    v_mul_f32 v154, v154, v80
    v_mul_f32 v155, v155, v81
    v_cvt_pk_bf16_f32 v7, v120, v121
    v_lshlrev_b32 v120, 16, v7
    v_and_b32 v121, s40, v7
    v_cvt_pk_bf16_f32 v7, v122, v123
    v_lshlrev_b32 v122, 16, v7
    v_and_b32 v123, s40, v7
    v_cvt_pk_bf16_f32 v7, v124, v125
    v_lshlrev_b32 v124, 16, v7
    v_and_b32 v125, s40, v7
    v_cvt_pk_bf16_f32 v7, v126, v127
    v_lshlrev_b32 v126, 16, v7
    v_and_b32 v127, s40, v7
    v_cvt_pk_bf16_f32 v7, v128, v129
    v_lshlrev_b32 v128, 16, v7
    v_and_b32 v129, s40, v7
    v_cvt_pk_bf16_f32 v7, v130, v131
    v_lshlrev_b32 v130, 16, v7
    v_and_b32 v131, s40, v7
    v_cvt_pk_bf16_f32 v7, v132, v133
    v_lshlrev_b32 v132, 16, v7
    v_and_b32 v133, s40, v7
    v_cvt_pk_bf16_f32 v7, v134, v135
    v_lshlrev_b32 v134, 16, v7
    v_and_b32 v135, s40, v7
    v_cvt_pk_bf16_f32 v7, v136, v137
    v_lshlrev_b32 v136, 16, v7
    v_and_b32 v137, s40, v7
    v_cvt_pk_bf16_f32 v7, v138, v139
    v_lshlrev_b32 v138, 16, v7
    v_and_b32 v139, s40, v7
    v_cvt_pk_bf16_f32 v7, v140, v141
    v_lshlrev_b32 v140, 16, v7
    v_and_b32 v141, s40, v7
    v_cvt_pk_bf16_f32 v7, v142, v143
    v_lshlrev_b32 v142, 16, v7
    v_and_b32 v143, s40, v7
    v_cvt_pk_bf16_f32 v7, v144, v145
    v_lshlrev_b32 v144, 16, v7
    v_and_b32 v145, s40, v7
    v_cvt_pk_bf16_f32 v7, v146, v147
    v_lshlrev_b32 v146, 16, v7
    v_and_b32 v147, s40, v7
    v_cvt_pk_bf16_f32 v7, v148, v149
    v_lshlrev_b32 v148, 16, v7
    v_and_b32 v149, s40, v7
    v_cvt_pk_bf16_f32 v7, v150, v151
    v_lshlrev_b32 v150, 16, v7
    v_and_b32 v151, s40, v7
    v_cvt_pk_bf16_f32 v7, v152, v153
    v_lshlrev_b32 v152, 16, v7
    v_and_b32 v153, s40, v7
    v_cvt_pk_bf16_f32 v7, v154, v155
    v_lshlrev_b32 v154, 16, v7
    v_and_b32 v155, s40, v7
    v_add_f32 v10, v10, v120
    v_add_f32 v11, v11, v121
    v_add_f32 v12, v12, v122
    v_add_f32 v13, v13, v123
    v_add_f32 v14, v14, v124
    v_add_f32 v15, v15, v125
    v_add_f32 v16, v16, v126
    v_add_f32 v17, v17, v127
    v_add_f32 v18, v18, v128
    v_add_f32 v19, v19, v129
    v_add_f32 v20, v20, v130
    v_add_f32 v21, v21, v131
    v_add_f32 v22, v22, v132
    v_add_f32 v23, v23, v133
    v_add_f32 v24, v24, v134
    v_add_f32 v25, v25, v135
    v_add_f32 v26, v26, v136
    v_add_f32 v27, v27, v137
    v_add_f32 v28, v28, v138
    v_add_f32 v29, v29, v139
    v_add_f32 v30, v30, v140
    v_add_f32 v31, v31, v141
    v_add_f32 v32, v32, v142
    v_add_f32 v33, v33, v143
    v_add_f32 v34, v34, v144
    v_add_f32 v35, v35, v145
    v_add_f32 v36, v36, v146
    v_add_f32 v37, v37, v147
    v_add_f32 v38, v38, v148
    v_add_f32 v39, v39, v149
    v_add_f32 v40, v40, v150
    v_add_f32 v41, v41, v151
    v_add_f32 v42, v42, v152
    v_add_f32 v43, v43, v153
    v_add_f32 v44, v44, v154
    v_add_f32 v45, v45, v155
    v_cvt_pk_bf16_f32 v82, v10, v11
    v_lshlrev_b32 v10, 16, v82
    v_and_b32 v11, s40, v82
    v_cvt_pk_bf16_f32 v83, v12, v13
    v_lshlrev_b32 v12, 16, v83
    v_and_b32 v13, s40, v83
    v_cvt_pk_bf16_f32 v84, v14, v15
    v_lshlrev_b32 v14, 16, v84
    v_and_b32 v15, s40, v84
    v_cvt_pk_bf16_f32 v85, v16, v17
    v_lshlrev_b32 v16, 16, v85
    v_and_b32 v17, s40, v85
    v_cvt_pk_bf16_f32 v86, v18, v19
    v_lshlrev_b32 v18, 16, v86
    v_and_b32 v19, s40, v86
    v_cvt_pk_bf16_f32 v87, v20, v21
    v_lshlrev_b32 v20, 16, v87
    v_and_b32 v21, s40, v87
    v_cvt_pk_bf16_f32 v88, v22, v23
    v_lshlrev_b32 v22, 16, v88
    v_and_b32 v23, s40, v88
    v_cvt_pk_bf16_f32 v89, v24, v25
    v_lshlrev_b32 v24, 16, v89
    v_and_b32 v25, s40, v89
    v_cvt_pk_bf16_f32 v90, v26, v27
    v_lshlrev_b32 v26, 16, v90
    v_and_b32 v27, s40, v90
    v_cvt_pk_bf16_f32 v91, v28, v29
    v_lshlrev_b32 v28, 16, v91
    v_and_b32 v29, s40, v91
    v_cvt_pk_bf16_f32 v92, v30, v31
    v_lshlrev_b32 v30, 16, v92
    v_and_b32 v31, s40, v92
    v_cvt_pk_bf16_f32 v93, v32, v33
    v_lshlrev_b32 v32, 16, v93
    v_and_b32 v33, s40, v93
    v_cvt_pk_bf16_f32 v94, v34, v35
    v_lshlrev_b32 v34, 16, v94
    v_and_b32 v35, s40, v94
    v_cvt_pk_bf16_f32 v95, v36, v37
    v_lshlrev_b32 v36, 16, v95
    v_and_b32 v37, s40, v95
    v_cvt_pk_bf16_f32 v96, v38, v39
    v_lshlrev_b32 v38, 16, v96
    v_and_b32 v39, s40, v96
    v_cvt_pk_bf16_f32 v97, v40, v41
    v_lshlrev_b32 v40, 16, v97
    v_and_b32 v41, s40, v97
    v_cvt_pk_bf16_f32 v98, v42, v43
    v_lshlrev_b32 v42, 16, v98
    v_and_b32 v43, s40, v98
    v_cvt_pk_bf16_f32 v99, v44, v45
    v_lshlrev_b32 v44, 16, v99
    v_and_b32 v45, s40, v99
    buffer_store_dwordx2 v[82:83], v3, s[24:27], 0 offen offset:0
    buffer_store_dwordx2 v[84:85], v3, s[24:27], 0 offen offset:32
    buffer_store_dwordx2 v[86:87], v3, s[24:27], 0 offen offset:64
    buffer_store_dwordx2 v[88:89], v3, s[24:27], 0 offen offset:96
    buffer_store_dwordx2 v[90:91], v3, s[24:27], 0 offen offset:128
    buffer_store_dwordx2 v[92:93], v3, s[24:27], 0 offen offset:160
    buffer_store_dwordx2 v[94:95], v3, s[24:27], 0 offen offset:192
    buffer_store_dwordx2 v[96:97], v3, s[24:27], 0 offen offset:224
    buffer_store_dwordx2 v[98:99], v3, s[24:27], 0 offen offset:256
    v_add_f32 v5, v10, v11
    v_add_f32 v5, v5, v12
    v_add_f32 v5, v5, v13
    v_add_f32 v5, v5, v14
    v_add_f32 v5, v5, v15
    v_add_f32 v5, v5, v16
    v_add_f32 v5, v5, v17
    v_add_f32 v5, v5, v18
    v_add_f32 v5, v5, v19
    v_add_f32 v5, v5, v20
    v_add_f32 v5, v5, v21
    v_add_f32 v5, v5, v22
    v_add_f32 v5, v5, v23
    v_add_f32 v5, v5, v24
    v_add_f32 v5, v5, v25
    v_add_f32 v5, v5, v26
    v_add_f32 v5, v5, v27
    v_add_f32 v5, v5, v28
    v_add_f32 v5, v5, v29
    v_add_f32 v5, v5, v30
    v_add_f32 v5, v5, v31
    v_add_f32 v5, v5, v32
    v_add_f32 v5, v5, v33
    v_add_f32 v5, v5, v34
    v_add_f32 v5, v5, v35
    v_add_f32 v5, v5, v36
    v_add_f32 v5, v5, v37
    v_add_f32 v5, v5, v38
    v_add_f32 v5, v5, v39
    v_add_f32 v5, v5, v40
    v_add_f32 v5, v5, v41
    v_add_f32 v5, v5, v42
    v_add_f32 v5, v5, v43
    v_add_f32 v5, v5, v44
    v_add_f32 v5, v5, v45
    ds_write_b32 v9, v5 offset:2048
    s_waitcnt lgkmcnt(0)
    s_barrier
    ds_read_b128 v[160:163], v1 offset:2048
    ds_read_b128 v[164:167], v1 offset:2064
    ds_read_b128 v[168:171], v1 offset:2080
    ds_read_b128 v[172:175], v1 offset:2096
    s_waitcnt lgkmcnt(0)
    v_add_f32 v5, v160, v161
    v_add_f32 v5, v5, v162
    v_add_f32 v5, v5, v163
    v_add_f32 v5, v5, v164
    v_add_f32 v5, v5, v165
    v_add_f32 v5, v5, v166
    v_add_f32 v5, v5, v167
    v_add_f32 v5, v5, v168
    v_add_f32 v5, v5, v169
    v_add_f32 v5, v5, v170
    v_add_f32 v5, v5, v171
    v_add_f32 v5, v5, v172
    v_add_f32 v5, v5, v173
    v_add_f32 v5, v5, v174
    v_add_f32 v5, v5, v175
    v_mul_f32 v5, 0x3ae38e39, v5
    v_mov_b32 v6, 0
    v_sub_f32 v7, v10, v5
    v_fmac_f32 v6, v7, v7
    v_sub_f32 v7, v11, v5
    v_fmac_f32 v6, v7, v7
    v_sub_f32 v7, v12, v5
    v_fmac_f32 v6, v7, v7
    v_sub_f32 v7, v13, v5
    v_fmac_f32 v6, v7, v7
    v_sub_f32 v7, v14, v5
    v_fmac_f32 v6, v7, v7
    v_sub_f32 v7, v15, v5
    v_fmac_f32 v6, v7, v7
    v_sub_f32 v7, v16, v5
    v_fmac_f32 v6, v7, v7
    v_sub_f32 v7, v17, v5
    v_fmac_f32 v6, v7, v7
    v_sub_f32 v7, v18, v5
    v_fmac_f32 v6, v7, v7
    v_sub_f32 v7, v19, v5
    v_fmac_f32 v6, v7, v7
    v_sub_f32 v7, v20, v5
    v_fmac_f32 v6, v7, v7
    v_sub_f32 v7, v21, v5
    v_fmac_f32 v6, v7, v7
    v_sub_f32 v7, v22, v5
    v_fmac_f32 v6, v7, v7
    v_sub_f32 v7, v23, v5
    v_fmac_f32 v6, v7, v7
    v_sub_f32 v7, v24, v5
    v_fmac_f32 v6, v7, v7
    v_sub_f32 v7, v25, v5
    v_fmac_f32 v6, v7, v7
    v_sub_f32 v7, v26, v5
    v_fmac_f32 v6, v7, v7
    v_sub_f32 v7, v27, v5
    v_fmac_f32 v6, v7, v7
    v_sub_f32 v7, v28, v5
    v_fmac_f32 v6, v7, v7
    v_sub_f32 v7, v29, v5
    v_fmac_f32 v6, v7, v7
    v_sub_f32 v7, v30, v5
    v_fmac_f32 v6, v7, v7
    v_sub_f32 v7, v31, v5
    v_fmac_f32 v6, v7, v7
    v_sub_f32 v7, v32, v5
    v_fmac_f32 v6, v7, v7
    v_sub_f32 v7, v33, v5
    v_fmac_f32 v6, v7, v7
    v_sub_f32 v7, v34, v5
    v_fmac_f32 v6, v7, v7
    v_sub_f32 v7, v35, v5
    v_fmac_f32 v6, v7, v7
    v_sub_f32 v7, v36, v5
    v_fmac_f32 v6, v7, v7
    v_sub_f32 v7, v37, v5
    v_fmac_f32 v6, v7, v7
    v_sub_f32 v7, v38, v5
    v_fmac_f32 v6, v7, v7
    v_sub_f32 v7, v39, v5
    v_fmac_f32 v6, v7, v7
    v_sub_f32 v7, v40, v5
    v_fmac_f32 v6, v7, v7
    v_sub_f32 v7, v41, v5
    v_fmac_f32 v6, v7, v7
    v_sub_f32 v7, v42, v5
    v_fmac_f32 v6, v7, v7
    v_sub_f32 v7, v43, v5
    v_fmac_f32 v6, v7, v7
    v_sub_f32 v7, v44, v5
    v_fmac_f32 v6, v7, v7
    v_sub_f32 v7, v45, v5
    v_fmac_f32 v6, v7, v7
    ds_write_b32 v9, v6 offset:3072
    s_waitcnt lgkmcnt(0)
    s_barrier
    ds_read_b128 v[160:163], v1 offset:3072
    ds_read_b128 v[164:167], v1 offset:3088
    ds_read_b128 v[168:171], v1 offset:3104
    ds_read_b128 v[172:175], v1 offset:3120
    s_waitcnt lgkmcnt(0)
    v_add_f32 v6, v160, v161
    v_add_f32 v6, v6, v162
    v_add_f32 v6, v6, v163
    v_add_f32 v6, v6, v164
    v_add_f32 v6, v6, v165
    v_add_f32 v6, v6, v166
    v_add_f32 v6, v6, v167
    v_add_f32 v6, v6, v168
    v_add_f32 v6, v6, v169
    v_add_f32 v6, v6, v170
    v_add_f32 v6, v6, v171
    v_add_f32 v6, v6, v172
    v_add_f32 v6, v6, v173
    v_add_f32 v6, v6, v174
    v_add_f32 v6, v6, v175
    v_mul_f32 v6, 0x3ae38e39, v6
    v_cvt_pk_bf16_f32 v7, v5, v6
    v_lshlrev_b32 v5, 16, v7
    v_and_b32 v6, s40, v7
    v_add_f32 v6, 0x3727c5ac, v6
    v_cvt_pk_bf16_f32 v7, v6, v6
    v_lshlrev_b32 v6, 16, v7
    v_sqrt_f32 v6, v6
    s_nop 0
    v_cvt_pk_bf16_f32 v7, v6, v6
    v_lshlrev_b32 v6, 16, v7
    v_rcp_f32 v6, v6
    v_sub_f32 v120, v10, v5
    v_sub_f32 v121, v11, v5
    v_sub_f32 v122, v12, v5
    v_sub_f32 v123, v13, v5
    v_sub_f32 v124, v14, v5
    v_sub_f32 v125, v15, v5
    v_sub_f32 v126, v16, v5
    v_sub_f32 v127, v17, v5
    v_sub_f32 v128, v18, v5
    v_sub_f32 v129, v19, v5
    v_sub_f32 v130, v20, v5
    v_sub_f32 v131, v21, v5
    v_sub_f32 v132, v22, v5
    v_sub_f32 v133, v23, v5
    v_sub_f32 v134, v24, v5
    v_sub_f32 v135, v25, v5
    v_sub_f32 v136, v26, v5
    v_sub_f32 v137, v27, v5
    v_sub_f32 v138, v28, v5
    v_sub_f32 v139, v29, v5
    v_sub_f32 v140, v30, v5
    v_sub_f32 v141, v31, v5
    v_sub_f32 v142, v32, v5
    v_sub_f32 v143, v33, v5
    v_sub_f32 v144, v34, v5
    v_sub_f32 v145, v35, v5
    v_sub_f32 v146, v36, v5
    v_sub_f32 v147, v37, v5
    v_sub_f32 v148, v38, v5
    v_sub_f32 v149, v39, v5
    v_sub_f32 v150, v40, v5
    v_sub_f32 v151, v41, v5
    v_sub_f32 v152, v42, v5
    v_sub_f32 v153, v43, v5
    v_sub_f32 v154, v44, v5
    v_sub_f32 v155, v45, v5
    v_cvt_pk_bf16_f32 v7, v120, v121
    v_lshlrev_b32 v120, 16, v7
    v_and_b32 v121, s40, v7
    v_cvt_pk_bf16_f32 v7, v122, v123
    v_lshlrev_b32 v122, 16, v7
    v_and_b32 v123, s40, v7
    v_cvt_pk_bf16_f32 v7, v124, v125
    v_lshlrev_b32 v124, 16, v7
    v_and_b32 v125, s40, v7
    v_cvt_pk_bf16_f32 v7, v126, v127
    v_lshlrev_b32 v126, 16, v7
    v_and_b32 v127, s40, v7
    v_cvt_pk_bf16_f32 v7, v128, v129
    v_lshlrev_b32 v128, 16, v7
    v_and_b32 v129, s40, v7
    v_cvt_pk_bf16_f32 v7, v130, v131
    v_lshlrev_b32 v130, 16, v7
    v_and_b32 v131, s40, v7
    v_cvt_pk_bf16_f32 v7, v132, v133
    v_lshlrev_b32 v132, 16, v7
    v_and_b32 v133, s40, v7
    v_cvt_pk_bf16_f32 v7, v134, v135
    v_lshlrev_b32 v134, 16, v7
    v_and_b32 v135, s40, v7
    v_cvt_pk_bf16_f32 v7, v136, v137
    v_lshlrev_b32 v136, 16, v7
    v_and_b32 v137, s40, v7
    v_cvt_pk_bf16_f32 v7, v138, v139
    v_lshlrev_b32 v138, 16, v7
    v_and_b32 v139, s40, v7
    v_cvt_pk_bf16_f32 v7, v140, v141
    v_lshlrev_b32 v140, 16, v7
    v_and_b32 v141, s40, v7
    v_cvt_pk_bf16_f32 v7, v142, v143
    v_lshlrev_b32 v142, 16, v7
    v_and_b32 v143, s40, v7
    v_cvt_pk_bf16_f32 v7, v144, v145
    v_lshlrev_b32 v144, 16, v7
    v_and_b32 v145, s40, v7
    v_cvt_pk_bf16_f32 v7, v146, v147
    v_lshlrev_b32 v146, 16, v7
    v_and_b32 v147, s40, v7
    v_cvt_pk_bf16_f32 v7, v148, v149
    v_lshlrev_b32 v148, 16, v7
    v_and_b32 v149, s40, v7
    v_cvt_pk_bf16_f32 v7, v150, v151
    v_lshlrev_b32 v150, 16, v7
    v_and_b32 v151, s40, v7
    v_cvt_pk_bf16_f32 v7, v152, v153
    v_lshlrev_b32 v152, 16, v7
    v_and_b32 v153, s40, v7
    v_cvt_pk_bf16_f32 v7, v154, v155
    v_lshlrev_b32 v154, 16, v7
    v_and_b32 v155, s40, v7
    v_mul_f32 v120, v120, v6
    v_mul_f32 v121, v121, v6
    v_mul_f32 v122, v122, v6
    v_mul_f32 v123, v123, v6
    v_mul_f32 v124, v124, v6
    v_mul_f32 v125, v125, v6
    v_mul_f32 v126, v126, v6
    v_mul_f32 v127, v127, v6
    v_mul_f32 v128, v128, v6
    v_mul_f32 v129, v129, v6
    v_mul_f32 v130, v130, v6
    v_mul_f32 v131, v131, v6
    v_mul_f32 v132, v132, v6
    v_mul_f32 v133, v133, v6
    v_mul_f32 v134, v134, v6
    v_mul_f32 v135, v135, v6
    v_mul_f32 v136, v136, v6
    v_mul_f32 v137, v137, v6
    v_mul_f32 v138, v138, v6
    v_mul_f32 v139, v139, v6
    v_mul_f32 v140, v140, v6
    v_mul_f32 v141, v141, v6
    v_mul_f32 v142, v142, v6
    v_mul_f32 v143, v143, v6
    v_mul_f32 v144, v144, v6
    v_mul_f32 v145, v145, v6
    v_mul_f32 v146, v146, v6
    v_mul_f32 v147, v147, v6
    v_mul_f32 v148, v148, v6
    v_mul_f32 v149, v149, v6
    v_mul_f32 v150, v150, v6
    v_mul_f32 v151, v151, v6
    v_mul_f32 v152, v152, v6
    v_mul_f32 v153, v153, v6
    v_mul_f32 v154, v154, v6
    v_mul_f32 v155, v155, v6
    v_cvt_pk_bf16_f32 v7, v120, v121
    v_lshlrev_b32 v120, 16, v7
    v_and_b32 v121, s40, v7
    v_cvt_pk_bf16_f32 v7, v122, v123
    v_lshlrev_b32 v122, 16, v7
    v_and_b32 v123, s40, v7
    v_cvt_pk_bf16_f32 v7, v124, v125
    v_lshlrev_b32 v124, 16, v7
    v_and_b32 v125, s40, v7
    v_cvt_pk_bf16_f32 v7, v126, v127
    v_lshlrev_b32 v126, 16, v7
    v_and_b32 v127, s40, v7
    v_cvt_pk_bf16_f32 v7, v128, v129
    v_lshlrev_b32 v128, 16, v7
    v_and_b32 v129, s40, v7
    v_cvt_pk_bf16_f32 v7, v130, v131
    v_lshlrev_b32 v130, 16, v7
    v_and_b32 v131, s40, v7
    v_cvt_pk_bf16_f32 v7, v132, v133
    v_lshlrev_b32 v132, 16, v7
    v_and_b32 v133, s40, v7
    v_cvt_pk_bf16_f32 v7, v134, v135
    v_lshlrev_b32 v134, 16, v7
    v_and_b32 v135, s40, v7
    v_cvt_pk_bf16_f32 v7, v136, v137
    v_lshlrev_b32 v136, 16, v7
    v_and_b32 v137, s40, v7
    v_cvt_pk_bf16_f32 v7, v138, v139
    v_lshlrev_b32 v138, 16, v7
    v_and_b32 v139, s40, v7
    v_cvt_pk_bf16_f32 v7, v140, v141
    v_lshlrev_b32 v140, 16, v7
    v_and_b32 v141, s40, v7
    v_cvt_pk_bf16_f32 v7, v142, v143
    v_lshlrev_b32 v142, 16, v7
    v_and_b32 v143, s40, v7
    v_cvt_pk_bf16_f32 v7, v144, v145
    v_lshlrev_b32 v144, 16, v7
    v_and_b32 v145, s40, v7
    v_cvt_pk_bf16_f32 v7, v146, v147
    v_lshlrev_b32 v146, 16, v7
    v_and_b32 v147, s40, v7
    v_cvt_pk_bf16_f32 v7, v148, v149
    v_lshlrev_b32 v148, 16, v7
    v_and_b32 v149, s40, v7
    v_cvt_pk_bf16_f32 v7, v150, v151
    v_lshlrev_b32 v150, 16, v7
    v_and_b32 v151, s40, v7
    v_cvt_pk_bf16_f32 v7, v152, v153
    v_lshlrev_b32 v152, 16, v7
    v_and_b32 v153, s40, v7
    v_cvt_pk_bf16_f32 v7, v154, v155
    v_lshlrev_b32 v154, 16, v7
    v_and_b32 v155, s40, v7
    v_cvt_pk_bf16_f32 v100, v120, v121
    v_cvt_pk_bf16_f32 v101, v122, v123
    v_cvt_pk_bf16_f32 v102, v124, v125
    v_cvt_pk_bf16_f32 v103, v126, v127
    v_cvt_pk_bf16_f32 v104, v128, v129
    v_cvt_pk_bf16_f32 v105, v130, v131
    v_cvt_pk_bf16_f32 v106, v132, v133
    v_cvt_pk_bf16_f32 v107, v134, v135
    v_cvt_pk_bf16_f32 v108, v136, v137
    v_cvt_pk_bf16_f32 v109, v138, v139
    v_cvt_pk_bf16_f32 v110, v140, v141
    v_cvt_pk_bf16_f32 v111, v142, v143
    v_cvt_pk_bf16_f32 v112, v144, v145
    v_cvt_pk_bf16_f32 v113, v146, v147
    v_cvt_pk_bf16_f32 v114, v148, v149
    v_cvt_pk_bf16_f32 v115, v150, v151
    v_cvt_pk_bf16_f32 v116, v152, v153
    v_cvt_pk_bf16_f32 v117, v154, v155
    buffer_store_dwordx2 v[100:101], v8, s[28:31], 0 offen offset:0
    buffer_store_dwordx2 v[102:103], v8, s[28:31], 0 offen offset:512
    buffer_store_dwordx2 v[104:105], v8, s[28:31], 0 offen offset:1024
    buffer_store_dwordx2 v[106:107], v8, s[28:31], 0 offen offset:1536
    buffer_store_dwordx2 v[108:109], v8, s[28:31], 0 offen offset:2048
    buffer_store_dwordx2 v[110:111], v8, s[28:31], 0 offen offset:2560
    buffer_store_dwordx2 v[112:113], v8, s[28:31], 0 offen offset:3072
    buffer_store_dwordx2 v[114:115], v8, s[28:31], 0 offen offset:3584
    s_movk_i32 s44, 4096
    buffer_store_dwordx2 v[116:117], v8, s[28:31], s44 offen offset:0
    s_waitcnt vmcnt(0)
rowb_kernel_done:
    s_endpgm
.globl rowc_kernel
.p2align 8
.type rowc_kernel,@function
rowc_kernel:
    s_cmp_ge_u32 s2, 128
    s_cbranch_scc1 rowc_kernel_done
    s_load_dwordx2 s[4:5], s[0:1], 0
    s_load_dwordx2 s[6:7], s[0:1], 80
    s_load_dwordx2 s[8:9], s[0:1], 96
    s_mov_b32 s40, 0xffff0000
    v_lshrrev_b32 v1, 6, v0
    v_and_b32 v2, 63, v0
    v_readfirstlane_b32 s42, v1
    v_and_b32 v5, 15, v2
    v_lshrrev_b32 v6, 4, v2
    s_lshl_b32 s3, s2, 4
    v_add_u32 v3, s3, v5
    s_movk_i32 s41, 1152
    v_mul_lo_u32 v3, v3, s41
    v_lshl_add_u32 v3, v6, 3, v3
    s_mul_i32 s3, s42, 288
    v_add_u32 v3, s3, v3
    s_mul_i32 s3, s2, 36
    s_mul_i32 s43, s42, 9
    s_add_u32 s3, s3, s43
    s_lshl_b32 s3, s3, 10
    v_lshlrev_b32 v4, 4, v2
    v_add_u32 v4, s3, v4
    v_lshlrev_b32 v8, 4, v5
    v_lshrrev_b32 v7, 1, v6
    v_lshl_add_u32 v8, v7, 8, v8
    v_and_b32 v7, 1, v6
    v_lshl_add_u32 v8, v7, 3, v8
    s_mul_i32 s3, s2, 18432
    s_lshl_b32 s43, s43, 9
    s_add_u32 s3, s3, s43
    v_add_u32 v8, s3, v8
    v_lshlrev_b32 v9, 4, v5
    v_add_u32 v9, v9, v6
    s_lshl_b32 s3, s42, 2
    v_add_u32 v9, s3, v9
    v_lshlrev_b32 v9, 2, v9
    v_lshlrev_b32 v1, 6, v5
    s_waitcnt lgkmcnt(0)
    s_add_u32 s12, s8, 0xc00000
    s_addc_u32 s13, s9, 0
    s_mov_b32 s14, 0x240000
    s_mov_b32 s15, 0x00020000
    s_mov_b32 s16, s8
    s_mov_b32 s17, s9
    s_mov_b32 s18, 0x240000
    s_mov_b32 s19, 0x00020000
    s_add_u32 s20, s8, 0x3000000
    s_addc_u32 s21, s9, 0
    s_mov_b32 s22, 0x1200000
    s_mov_b32 s23, 0x00020000
    s_mov_b32 s24, s6
    s_mov_b32 s25, s7
    s_mov_b32 s26, 0x240000
    s_mov_b32 s27, 0x00020000
    s_add_u32 s28, s8, 0x800000
    s_addc_u32 s29, s9, 0
    s_mov_b32 s30, 0x240000
    s_mov_b32 s31, 0x00020000
    s_mov_b32 s44, 0x0
    buffer_load_dwordx4 v[120:123], v4, s[20:23], s44 offen offset:0
    buffer_load_dwordx4 v[124:127], v4, s[20:23], s44 offen offset:1024
    buffer_load_dwordx4 v[128:131], v4, s[20:23], s44 offen offset:2048
    buffer_load_dwordx4 v[132:135], v4, s[20:23], s44 offen offset:3072
    s_mov_b32 s44, 0x1000
    buffer_load_dwordx4 v[136:139], v4, s[20:23], s44 offen offset:0
    buffer_load_dwordx4 v[140:143], v4, s[20:23], s44 offen offset:1024
    buffer_load_dwordx4 v[144:147], v4, s[20:23], s44 offen offset:2048
    buffer_load_dwordx4 v[148:151], v4, s[20:23], s44 offen offset:3072
    s_mov_b32 s44, 0x2000
    buffer_load_dwordx4 v[152:155], v4, s[20:23], s44 offen offset:0
    s_mov_b32 s44, 0x480000
    buffer_load_dwordx4 v[156:159], v4, s[20:23], s44 offen offset:0
    buffer_load_dwordx4 v[160:163], v4, s[20:23], s44 offen offset:1024
    buffer_load_dwordx4 v[164:167], v4, s[20:23], s44 offen offset:2048
    buffer_load_dwordx4 v[168:171], v4, s[20:23], s44 offen offset:3072
    s_mov_b32 s44, 0x481000
    buffer_load_dwordx4 v[172:175], v4, s[20:23], s44 offen offset:0
    buffer_load_dwordx4 v[176:179], v4, s[20:23], s44 offen offset:1024
    buffer_load_dwordx4 v[180:183], v4, s[20:23], s44 offen offset:2048
    buffer_load_dwordx4 v[184:187], v4, s[20:23], s44 offen offset:3072
    s_mov_b32 s44, 0x482000
    buffer_load_dwordx4 v[188:191], v4, s[20:23], s44 offen offset:0
    s_mov_b32 s44, 0x900000
    buffer_load_dwordx4 v[192:195], v4, s[20:23], s44 offen offset:0
    buffer_load_dwordx4 v[196:199], v4, s[20:23], s44 offen offset:1024
    buffer_load_dwordx4 v[200:203], v4, s[20:23], s44 offen offset:2048
    buffer_load_dwordx4 v[204:207], v4, s[20:23], s44 offen offset:3072
    s_mov_b32 s44, 0x901000
    buffer_load_dwordx4 v[208:211], v4, s[20:23], s44 offen offset:0
    buffer_load_dwordx4 v[212:215], v4, s[20:23], s44 offen offset:1024
    buffer_load_dwordx4 v[216:219], v4, s[20:23], s44 offen offset:2048
    buffer_load_dwordx4 v[220:223], v4, s[20:23], s44 offen offset:3072
    s_mov_b32 s44, 0x902000
    buffer_load_dwordx4 v[224:227], v4, s[20:23], s44 offen offset:0
    buffer_load_dwordx2 v[82:83], v3, s[12:15], 0 offen offset:0
    buffer_load_dwordx2 v[84:85], v3, s[12:15], 0 offen offset:32
    buffer_load_dwordx2 v[86:87], v3, s[12:15], 0 offen offset:64
    buffer_load_dwordx2 v[88:89], v3, s[12:15], 0 offen offset:96
    buffer_load_dwordx2 v[90:91], v3, s[12:15], 0 offen offset:128
    buffer_load_dwordx2 v[92:93], v3, s[12:15], 0 offen offset:160
    buffer_load_dwordx2 v[94:95], v3, s[12:15], 0 offen offset:192
    buffer_load_dwordx2 v[96:97], v3, s[12:15], 0 offen offset:224
    buffer_load_dwordx2 v[98:99], v3, s[12:15], 0 offen offset:256
    s_waitcnt vmcnt(0)
    v_lshlrev_b32 v10, 16, v82
    v_and_b32 v11, s40, v82
    v_lshlrev_b32 v12, 16, v83
    v_and_b32 v13, s40, v83
    v_lshlrev_b32 v14, 16, v84
    v_and_b32 v15, s40, v84
    v_lshlrev_b32 v16, 16, v85
    v_and_b32 v17, s40, v85
    v_lshlrev_b32 v18, 16, v86
    v_and_b32 v19, s40, v86
    v_lshlrev_b32 v20, 16, v87
    v_and_b32 v21, s40, v87
    v_lshlrev_b32 v22, 16, v88
    v_and_b32 v23, s40, v88
    v_lshlrev_b32 v24, 16, v89
    v_and_b32 v25, s40, v89
    v_lshlrev_b32 v26, 16, v90
    v_and_b32 v27, s40, v90
    v_lshlrev_b32 v28, 16, v91
    v_and_b32 v29, s40, v91
    v_lshlrev_b32 v30, 16, v92
    v_and_b32 v31, s40, v92
    v_lshlrev_b32 v32, 16, v93
    v_and_b32 v33, s40, v93
    v_lshlrev_b32 v34, 16, v94
    v_and_b32 v35, s40, v94
    v_lshlrev_b32 v36, 16, v95
    v_and_b32 v37, s40, v95
    v_lshlrev_b32 v38, 16, v96
    v_and_b32 v39, s40, v96
    v_lshlrev_b32 v40, 16, v97
    v_and_b32 v41, s40, v97
    v_lshlrev_b32 v42, 16, v98
    v_and_b32 v43, s40, v98
    v_lshlrev_b32 v44, 16, v99
    v_and_b32 v45, s40, v99
    v_add_f32 v120, v120, v156
    v_add_f32 v121, v121, v157
    v_add_f32 v122, v122, v158
    v_add_f32 v123, v123, v159
    v_add_f32 v124, v124, v160
    v_add_f32 v125, v125, v161
    v_add_f32 v126, v126, v162
    v_add_f32 v127, v127, v163
    v_add_f32 v128, v128, v164
    v_add_f32 v129, v129, v165
    v_add_f32 v130, v130, v166
    v_add_f32 v131, v131, v167
    v_add_f32 v132, v132, v168
    v_add_f32 v133, v133, v169
    v_add_f32 v134, v134, v170
    v_add_f32 v135, v135, v171
    v_add_f32 v136, v136, v172
    v_add_f32 v137, v137, v173
    v_add_f32 v138, v138, v174
    v_add_f32 v139, v139, v175
    v_add_f32 v140, v140, v176
    v_add_f32 v141, v141, v177
    v_add_f32 v142, v142, v178
    v_add_f32 v143, v143, v179
    v_add_f32 v144, v144, v180
    v_add_f32 v145, v145, v181
    v_add_f32 v146, v146, v182
    v_add_f32 v147, v147, v183
    v_add_f32 v148, v148, v184
    v_add_f32 v149, v149, v185
    v_add_f32 v150, v150, v186
    v_add_f32 v151, v151, v187
    v_add_f32 v152, v152, v188
    v_add_f32 v153, v153, v189
    v_add_f32 v154, v154, v190
    v_add_f32 v155, v155, v191
    s_mov_b32 s44, 0xd80000
    buffer_load_dwordx4 v[156:159], v4, s[20:23], s44 offen offset:0
    buffer_load_dwordx4 v[160:163], v4, s[20:23], s44 offen offset:1024
    buffer_load_dwordx4 v[164:167], v4, s[20:23], s44 offen offset:2048
    buffer_load_dwordx4 v[168:171], v4, s[20:23], s44 offen offset:3072
    s_mov_b32 s44, 0xd81000
    buffer_load_dwordx4 v[172:175], v4, s[20:23], s44 offen offset:0
    buffer_load_dwordx4 v[176:179], v4, s[20:23], s44 offen offset:1024
    buffer_load_dwordx4 v[180:183], v4, s[20:23], s44 offen offset:2048
    buffer_load_dwordx4 v[184:187], v4, s[20:23], s44 offen offset:3072
    s_mov_b32 s44, 0xd82000
    buffer_load_dwordx4 v[188:191], v4, s[20:23], s44 offen offset:0
    v_add_f32 v120, v120, v192
    v_add_f32 v121, v121, v193
    v_add_f32 v122, v122, v194
    v_add_f32 v123, v123, v195
    v_add_f32 v124, v124, v196
    v_add_f32 v125, v125, v197
    v_add_f32 v126, v126, v198
    v_add_f32 v127, v127, v199
    v_add_f32 v128, v128, v200
    v_add_f32 v129, v129, v201
    v_add_f32 v130, v130, v202
    v_add_f32 v131, v131, v203
    v_add_f32 v132, v132, v204
    v_add_f32 v133, v133, v205
    v_add_f32 v134, v134, v206
    v_add_f32 v135, v135, v207
    v_add_f32 v136, v136, v208
    v_add_f32 v137, v137, v209
    v_add_f32 v138, v138, v210
    v_add_f32 v139, v139, v211
    v_add_f32 v140, v140, v212
    v_add_f32 v141, v141, v213
    v_add_f32 v142, v142, v214
    v_add_f32 v143, v143, v215
    v_add_f32 v144, v144, v216
    v_add_f32 v145, v145, v217
    v_add_f32 v146, v146, v218
    v_add_f32 v147, v147, v219
    v_add_f32 v148, v148, v220
    v_add_f32 v149, v149, v221
    v_add_f32 v150, v150, v222
    v_add_f32 v151, v151, v223
    v_add_f32 v152, v152, v224
    v_add_f32 v153, v153, v225
    v_add_f32 v154, v154, v226
    v_add_f32 v155, v155, v227
    s_waitcnt vmcnt(0)
    v_add_f32 v120, v120, v156
    v_add_f32 v121, v121, v157
    v_add_f32 v122, v122, v158
    v_add_f32 v123, v123, v159
    v_add_f32 v124, v124, v160
    v_add_f32 v125, v125, v161
    v_add_f32 v126, v126, v162
    v_add_f32 v127, v127, v163
    v_add_f32 v128, v128, v164
    v_add_f32 v129, v129, v165
    v_add_f32 v130, v130, v166
    v_add_f32 v131, v131, v167
    v_add_f32 v132, v132, v168
    v_add_f32 v133, v133, v169
    v_add_f32 v134, v134, v170
    v_add_f32 v135, v135, v171
    v_add_f32 v136, v136, v172
    v_add_f32 v137, v137, v173
    v_add_f32 v138, v138, v174
    v_add_f32 v139, v139, v175
    v_add_f32 v140, v140, v176
    v_add_f32 v141, v141, v177
    v_add_f32 v142, v142, v178
    v_add_f32 v143, v143, v179
    v_add_f32 v144, v144, v180
    v_add_f32 v145, v145, v181
    v_add_f32 v146, v146, v182
    v_add_f32 v147, v147, v183
    v_add_f32 v148, v148, v184
    v_add_f32 v149, v149, v185
    v_add_f32 v150, v150, v186
    v_add_f32 v151, v151, v187
    v_add_f32 v152, v152, v188
    v_add_f32 v153, v153, v189
    v_add_f32 v154, v154, v190
    v_add_f32 v155, v155, v191
    v_cvt_pk_bf16_f32 v5, v120, v121
    v_lshlrev_b32 v120, 16, v5
    v_and_b32 v121, s40, v5
    v_cvt_pk_bf16_f32 v5, v122, v123
    v_lshlrev_b32 v122, 16, v5
    v_and_b32 v123, s40, v5
    v_cvt_pk_bf16_f32 v5, v124, v125
    v_lshlrev_b32 v124, 16, v5
    v_and_b32 v125, s40, v5
    v_cvt_pk_bf16_f32 v5, v126, v127
    v_lshlrev_b32 v126, 16, v5
    v_and_b32 v127, s40, v5
    v_cvt_pk_bf16_f32 v5, v128, v129
    v_lshlrev_b32 v128, 16, v5
    v_and_b32 v129, s40, v5
    v_cvt_pk_bf16_f32 v5, v130, v131
    v_lshlrev_b32 v130, 16, v5
    v_and_b32 v131, s40, v5
    v_cvt_pk_bf16_f32 v5, v132, v133
    v_lshlrev_b32 v132, 16, v5
    v_and_b32 v133, s40, v5
    v_cvt_pk_bf16_f32 v5, v134, v135
    v_lshlrev_b32 v134, 16, v5
    v_and_b32 v135, s40, v5
    v_cvt_pk_bf16_f32 v5, v136, v137
    v_lshlrev_b32 v136, 16, v5
    v_and_b32 v137, s40, v5
    v_cvt_pk_bf16_f32 v5, v138, v139
    v_lshlrev_b32 v138, 16, v5
    v_and_b32 v139, s40, v5
    v_cvt_pk_bf16_f32 v5, v140, v141
    v_lshlrev_b32 v140, 16, v5
    v_and_b32 v141, s40, v5
    v_cvt_pk_bf16_f32 v5, v142, v143
    v_lshlrev_b32 v142, 16, v5
    v_and_b32 v143, s40, v5
    v_cvt_pk_bf16_f32 v5, v144, v145
    v_lshlrev_b32 v144, 16, v5
    v_and_b32 v145, s40, v5
    v_cvt_pk_bf16_f32 v5, v146, v147
    v_lshlrev_b32 v146, 16, v5
    v_and_b32 v147, s40, v5
    v_cvt_pk_bf16_f32 v5, v148, v149
    v_lshlrev_b32 v148, 16, v5
    v_and_b32 v149, s40, v5
    v_cvt_pk_bf16_f32 v5, v150, v151
    v_lshlrev_b32 v150, 16, v5
    v_and_b32 v151, s40, v5
    v_cvt_pk_bf16_f32 v5, v152, v153
    v_lshlrev_b32 v152, 16, v5
    v_and_b32 v153, s40, v5
    v_cvt_pk_bf16_f32 v5, v154, v155
    v_lshlrev_b32 v154, 16, v5
    v_and_b32 v155, s40, v5
    v_add_f32 v10, v10, v120
    v_add_f32 v11, v11, v121
    v_add_f32 v12, v12, v122
    v_add_f32 v13, v13, v123
    v_add_f32 v14, v14, v124
    v_add_f32 v15, v15, v125
    v_add_f32 v16, v16, v126
    v_add_f32 v17, v17, v127
    v_add_f32 v18, v18, v128
    v_add_f32 v19, v19, v129
    v_add_f32 v20, v20, v130
    v_add_f32 v21, v21, v131
    v_add_f32 v22, v22, v132
    v_add_f32 v23, v23, v133
    v_add_f32 v24, v24, v134
    v_add_f32 v25, v25, v135
    v_add_f32 v26, v26, v136
    v_add_f32 v27, v27, v137
    v_add_f32 v28, v28, v138
    v_add_f32 v29, v29, v139
    v_add_f32 v30, v30, v140
    v_add_f32 v31, v31, v141
    v_add_f32 v32, v32, v142
    v_add_f32 v33, v33, v143
    v_add_f32 v34, v34, v144
    v_add_f32 v35, v35, v145
    v_add_f32 v36, v36, v146
    v_add_f32 v37, v37, v147
    v_add_f32 v38, v38, v148
    v_add_f32 v39, v39, v149
    v_add_f32 v40, v40, v150
    v_add_f32 v41, v41, v151
    v_add_f32 v42, v42, v152
    v_add_f32 v43, v43, v153
    v_add_f32 v44, v44, v154
    v_add_f32 v45, v45, v155
    v_cvt_pk_bf16_f32 v82, v10, v11
    v_cvt_pk_bf16_f32 v83, v12, v13
    v_cvt_pk_bf16_f32 v84, v14, v15
    v_cvt_pk_bf16_f32 v85, v16, v17
    v_cvt_pk_bf16_f32 v86, v18, v19
    v_cvt_pk_bf16_f32 v87, v20, v21
    v_cvt_pk_bf16_f32 v88, v22, v23
    v_cvt_pk_bf16_f32 v89, v24, v25
    v_cvt_pk_bf16_f32 v90, v26, v27
    v_cvt_pk_bf16_f32 v91, v28, v29
    v_cvt_pk_bf16_f32 v92, v30, v31
    v_cvt_pk_bf16_f32 v93, v32, v33
    v_cvt_pk_bf16_f32 v94, v34, v35
    v_cvt_pk_bf16_f32 v95, v36, v37
    v_cvt_pk_bf16_f32 v96, v38, v39
    v_cvt_pk_bf16_f32 v97, v40, v41
    v_cvt_pk_bf16_f32 v98, v42, v43
    v_cvt_pk_bf16_f32 v99, v44, v45
    buffer_store_dwordx2 v[82:83], v3, s[24:27], 0 offen offset:0
    buffer_store_dwordx2 v[84:85], v3, s[24:27], 0 offen offset:32
    buffer_store_dwordx2 v[86:87], v3, s[24:27], 0 offen offset:64
    buffer_store_dwordx2 v[88:89], v3, s[24:27], 0 offen offset:96
    buffer_store_dwordx2 v[90:91], v3, s[24:27], 0 offen offset:128
    buffer_store_dwordx2 v[92:93], v3, s[24:27], 0 offen offset:160
    buffer_store_dwordx2 v[94:95], v3, s[24:27], 0 offen offset:192
    buffer_store_dwordx2 v[96:97], v3, s[24:27], 0 offen offset:224
    buffer_store_dwordx2 v[98:99], v3, s[24:27], 0 offen offset:256
    s_waitcnt vmcnt(0)
rowc_kernel_done:
    s_endpgm
.globl gemm1_kernel
.p2align 8
.type gemm1_kernel,@function
gemm1_kernel:
    s_cmp_ge_u32 s2, 256
    s_cbranch_scc1 gemm1_kernel_done
    s_load_dwordx2 s[8:9], s[0:1], 96
    s_and_b32 s3, s2, 7
    s_lshr_b32 s44, s2, 3
    s_and_b32 s45, s44, 7
    s_lshr_b32 s44, s44, 3
    s_lshl_b32 s3, s3, 2
    s_add_u32 s46, s3, s44
    v_lshrrev_b32 v1, 6, v0
    v_and_b32 v2, 63, v0
    v_readfirstlane_b32 s42, v1
    v_lshlrev_b32 v10, 4, v2
    v_and_b32 v3, 15, v2
    v_lshrrev_b32 v4, 4, v2
    s_waitcnt lgkmcnt(0)
    s_add_u32 s12, s8, 0x5000000
    s_addc_u32 s13, s9, 0
    s_mov_b32 s14, 0xa20000
    s_mov_b32 s15, 0x00020000
    s_add_u32 s20, s8, 0x800000
    s_addc_u32 s21, s9, 0
    s_mov_b32 s22, 0x240000
    s_mov_b32 s23, 0x00020000
    s_add_u32 s24, s8, 0x1000000
    s_addc_u32 s25, s9, 0
    s_mov_b32 s26, 0x1200000
    s_mov_b32 s27, 0x00020000
    s_mul_i32 s50, s46, 331776
    s_lshl_b32 s48, s45, 4
    s_lshl_b32 s3, s42, 1
    s_add_u32 s48, s48, s3
    s_mul_i32 s58, s48, 18432
    v_lshlrev_b32 v12, 4, v3
    v_lshrrev_b32 v5, 1, v4
    v_lshl_add_u32 v12, v5, 8, v12
    v_and_b32 v5, 1, v4
    v_lshl_add_u32 v12, v5, 3, v12
    s_mul_i32 s3, s48, 147456
    s_mul_i32 s47, s46, 4608
    s_add_u32 s3, s3, s47
    v_add_u32 v12, s3, v12
    v_add_u32 v13, 147456, v12
    v_mov_b32 v14, v10
    s_lshl_b32 s53, s42, 12
    s_and_b32 s54, s42, 3
    s_lshl_b32 s54, s54, 10
    s_add_u32 s54, s54, 32768
    v_mov_b32 v112, 0
    v_mov_b32 v113, 0
    v_mov_b32 v114, 0
    v_mov_b32 v115, 0
    v_mov_b32 v116, 0
    v_mov_b32 v117, 0
    v_mov_b32 v118, 0
    v_mov_b32 v119, 0
    v_mov_b32 v120, 0
    v_mov_b32 v121, 0
    v_mov_b32 v122, 0
    v_mov_b32 v123, 0
    v_mov_b32 v124, 0
    v_mov_b32 v125, 0
    v_mov_b32 v126, 0
    v_mov_b32 v127, 0
    v_mov_b32 v128, 0
    v_mov_b32 v129, 0
    v_mov_b32 v130, 0
    v_mov_b32 v131, 0
    v_mov_b32 v132, 0
    v_mov_b32 v133, 0
    v_mov_b32 v134, 0
    v_mov_b32 v135, 0
    v_mov_b32 v136, 0
    v_mov_b32 v137, 0
    v_mov_b32 v138, 0
    v_mov_b32 v139, 0
    v_mov_b32 v140, 0
    v_mov_b32 v141, 0
    v_mov_b32 v142, 0
    v_mov_b32 v143, 0
    v_mov_b32 v144, 0
    v_mov_b32 v145, 0
    v_mov_b32 v146, 0
    v_mov_b32 v147, 0
    v_mov_b32 v148, 0
    v_mov_b32 v149, 0
    v_mov_b32 v150, 0
    v_mov_b32 v151, 0
    v_mov_b32 v152, 0
    v_mov_b32 v153, 0
    v_mov_b32 v154, 0
    v_mov_b32 v155, 0
    v_mov_b32 v156, 0
    v_mov_b32 v157, 0
    v_mov_b32 v158, 0
    v_mov_b32 v159, 0
    v_mov_b32 v160, 0
    v_mov_b32 v161, 0
    v_mov_b32 v162, 0
    v_mov_b32 v163, 0
    v_mov_b32 v164, 0
    v_mov_b32 v165, 0
    v_mov_b32 v166, 0
    v_mov_b32 v167, 0
    v_mov_b32 v168, 0
    v_mov_b32 v169, 0
    v_mov_b32 v170, 0
    v_mov_b32 v171, 0
    v_mov_b32 v172, 0
    v_mov_b32 v173, 0
    v_mov_b32 v174, 0
    v_mov_b32 v175, 0
    v_mov_b32 v176, 0
    v_mov_b32 v177, 0
    v_mov_b32 v178, 0
    v_mov_b32 v179, 0
    v_mov_b32 v180, 0
    v_mov_b32 v181, 0
    v_mov_b32 v182, 0
    v_mov_b32 v183, 0
    v_mov_b32 v184, 0
    v_mov_b32 v185, 0
    v_mov_b32 v186, 0
    v_mov_b32 v187, 0
    v_mov_b32 v188, 0
    v_mov_b32 v189, 0
    v_mov_b32 v190, 0
    v_mov_b32 v191, 0
    v_mov_b32 v192, 0
    v_mov_b32 v193, 0
    v_mov_b32 v194, 0
    v_mov_b32 v195, 0
    v_mov_b32 v196, 0
    v_mov_b32 v197, 0
    v_mov_b32 v198, 0
    v_mov_b32 v199, 0
    v_mov_b32 v200, 0
    v_mov_b32 v201, 0
    v_mov_b32 v202, 0
    v_mov_b32 v203, 0
    v_mov_b32 v204, 0
    v_mov_b32 v205, 0
    v_mov_b32 v206, 0
    v_mov_b32 v207, 0
    v_mov_b32 v208, 0
    v_mov_b32 v209, 0
    v_mov_b32 v210, 0
    v_mov_b32 v211, 0
    v_mov_b32 v212, 0
    v_mov_b32 v213, 0
    v_mov_b32 v214, 0
    v_mov_b32 v215, 0
    v_mov_b32 v216, 0
    v_mov_b32 v217, 0
    v_mov_b32 v218, 0
    v_mov_b32 v219, 0
    v_mov_b32 v220, 0
    v_mov_b32 v221, 0
    v_mov_b32 v222, 0
    v_mov_b32 v223, 0
    v_mov_b32 v224, 0
    v_mov_b32 v225, 0
    v_mov_b32 v226, 0
    v_mov_b32 v227, 0
    v_mov_b32 v228, 0
    v_mov_b32 v229, 0
    v_mov_b32 v230, 0
    v_mov_b32 v231, 0
    v_mov_b32 v232, 0
    v_mov_b32 v233, 0
    v_mov_b32 v234, 0
    v_mov_b32 v235, 0
    v_mov_b32 v236, 0
    v_mov_b32 v237, 0
    v_mov_b32 v238, 0
    v_mov_b32 v239, 0
    v_mov_b32 v240, 0
    v_mov_b32 v241, 0
    v_mov_b32 v242, 0
    v_mov_b32 v243, 0
    v_mov_b32 v244, 0
    v_mov_b32 v245, 0
    v_mov_b32 v246, 0
    v_mov_b32 v247, 0
    v_mov_b32 v248, 0
    v_mov_b32 v249, 0
    v_mov_b32 v250, 0
    v_mov_b32 v251, 0
    v_mov_b32 v252, 0
    v_mov_b32 v253, 0
    v_mov_b32 v254, 0
    v_mov_b32 v255, 0
    v_mov_b32 v28, 0xbfb8aa3b
    v_mov_b32 v29, 0xbfb8aa3b
    v_mov_b32 v22, 1.0
    v_mov_b32 v23, 1.0
    s_movk_i32 s61, 4096
    s_lshl_b32 s53, s42, 10
    s_and_b32 s54, s42, 3
    s_lshl_b32 s54, s54, 10
    s_add_u32 s54, s54, 16384
    s_add_u32 s55, s58, 0
    buffer_load_dwordx4 v[64:67], v10, s[20:23], s55 offen offset:0
    buffer_load_dwordx4 v[72:75], v10, s[20:23], s55 offen offset:1024
    s_add_u32 s55, s58, 18432
    buffer_load_dwordx4 v[68:71], v10, s[20:23], s55 offen offset:0
    buffer_load_dwordx4 v[76:79], v10, s[20:23], s55 offen offset:1024
    s_add_u32 m0, s53, 0
    s_add_u32 s56, s50, 0
    s_add_u32 s57, s56, s53
    buffer_load_dwordx4 v10, s[12:15], s57 offen lds
    s_add_u32 m0, s53, 8192
    s_add_u32 s57, s57, 8192
    buffer_load_dwordx4 v10, s[12:15], s57 offen lds
    s_add_u32 m0, s54, 0
    s_add_u32 s57, s56, s54
    buffer_load_dwordx4 v10, s[12:15], s57 offen lds
    s_add_u32 s55, s58, 2048
    buffer_load_dwordx4 v[80:83], v10, s[20:23], s55 offen offset:0
    buffer_load_dwordx4 v[88:91], v10, s[20:23], s55 offen offset:1024
    s_add_u32 s55, s58, 20480
    buffer_load_dwordx4 v[84:87], v10, s[20:23], s55 offen offset:0
    buffer_load_dwordx4 v[92:95], v10, s[20:23], s55 offen offset:1024
    s_add_u32 m0, s53, 20480
    s_add_u32 s56, s50, 20480
    s_add_u32 s57, s56, s53
    buffer_load_dwordx4 v10, s[12:15], s57 offen lds
    s_add_u32 m0, s53, 28672
    s_add_u32 s57, s57, 8192
    buffer_load_dwordx4 v10, s[12:15], s57 offen lds
    s_add_u32 m0, s54, 20480
    s_add_u32 s57, s56, s54
    buffer_load_dwordx4 v10, s[12:15], s57 offen lds
    s_add_u32 m0, s53, 40960
    s_add_u32 s56, s50, 40960
    s_add_u32 s57, s56, s53
    buffer_load_dwordx4 v10, s[12:15], s57 offen lds
    s_add_u32 m0, s53, 49152
    s_add_u32 s57, s57, 8192
    buffer_load_dwordx4 v10, s[12:15], s57 offen lds
    s_add_u32 m0, s54, 40960
    s_add_u32 s57, s56, s54
    buffer_load_dwordx4 v10, s[12:15], s57 offen lds
    s_waitcnt vmcnt(10)
    s_barrier
    v_add_u32 v20, 0, v14
    ds_read_b128 v[40:43], v20 offset:0
    ds_read_b128 v[44:47], v20 offset:1024
    ds_read_b128 v[48:51], v20 offset:2048
    ds_read_b128 v[52:55], v20 offset:3072
    ds_read_b128 v[56:59], v20 offset:4096
    s_waitcnt lgkmcnt(3)
    v_mfma_f32_16x16x32_bf16 v[112:115], v[40:43], v[64:67], v[112:115]
    v_mfma_f32_16x16x32_bf16 v[116:119], v[40:43], v[68:71], v[116:119]
    ds_read_b128 v[60:63], v20 offset:5120
    v_mfma_f32_16x16x32_bf16 v[184:187], v[44:47], v[64:67], v[184:187]
    v_mfma_f32_16x16x32_bf16 v[188:191], v[44:47], v[68:71], v[188:191]
    ds_read_b128 v[40:43], v20 offset:6144
    s_waitcnt lgkmcnt(3)
    v_mfma_f32_16x16x32_bf16 v[120:123], v[48:51], v[64:67], v[120:123]
    v_mfma_f32_16x16x32_bf16 v[124:127], v[48:51], v[68:71], v[124:127]
    ds_read_b128 v[44:47], v20 offset:7168
    v_mfma_f32_16x16x32_bf16 v[192:195], v[52:55], v[64:67], v[192:195]
    v_mfma_f32_16x16x32_bf16 v[196:199], v[52:55], v[68:71], v[196:199]
    ds_read_b128 v[48:51], v20 offset:8192
    s_waitcnt lgkmcnt(3)
    v_mfma_f32_16x16x32_bf16 v[128:131], v[56:59], v[64:67], v[128:131]
    v_mfma_f32_16x16x32_bf16 v[132:135], v[56:59], v[68:71], v[132:135]
    ds_read_b128 v[52:55], v20 offset:9216
    v_mfma_f32_16x16x32_bf16 v[200:203], v[60:63], v[64:67], v[200:203]
    v_mfma_f32_16x16x32_bf16 v[204:207], v[60:63], v[68:71], v[204:207]
    ds_read_b128 v[56:59], v20 offset:10240
    s_waitcnt lgkmcnt(3)
    v_mfma_f32_16x16x32_bf16 v[136:139], v[40:43], v[64:67], v[136:139]
    v_mfma_f32_16x16x32_bf16 v[140:143], v[40:43], v[68:71], v[140:143]
    ds_read_b128 v[60:63], v20 offset:11264
    v_mfma_f32_16x16x32_bf16 v[208:211], v[44:47], v[64:67], v[208:211]
    v_mfma_f32_16x16x32_bf16 v[212:215], v[44:47], v[68:71], v[212:215]
    ds_read_b128 v[40:43], v20 offset:12288
    s_waitcnt lgkmcnt(3)
    v_mfma_f32_16x16x32_bf16 v[144:147], v[48:51], v[64:67], v[144:147]
    v_mfma_f32_16x16x32_bf16 v[148:151], v[48:51], v[68:71], v[148:151]
    s_waitcnt vmcnt(3)
    s_barrier
    v_add_u32 v21, 20480, v14
    ds_read_b128 v[44:47], v20 offset:13312
    v_mfma_f32_16x16x32_bf16 v[216:219], v[52:55], v[64:67], v[216:219]
    s_add_u32 s55, s58, 4096
    v_mfma_f32_16x16x32_bf16 v[220:223], v[52:55], v[68:71], v[220:223]
    buffer_load_dwordx4 v[96:99], v10, s[20:23], s55 offen offset:0
    ds_read_b128 v[48:51], v20 offset:14336
    s_waitcnt lgkmcnt(3)
    v_mfma_f32_16x16x32_bf16 v[112:115], v[56:59], v[72:75], v[112:115]
    buffer_load_dwordx4 v[104:107], v10, s[20:23], s55 offen offset:1024
    v_mfma_f32_16x16x32_bf16 v[116:119], v[56:59], v[76:79], v[116:119]
    s_add_u32 s55, s58, 22528
    ds_read_b128 v[52:55], v20 offset:15360
    v_mfma_f32_16x16x32_bf16 v[184:187], v[60:63], v[72:75], v[184:187]
    buffer_load_dwordx4 v[100:103], v10, s[20:23], s55 offen offset:0
    v_mfma_f32_16x16x32_bf16 v[188:191], v[60:63], v[76:79], v[188:191]
    buffer_load_dwordx4 v[108:111], v10, s[20:23], s55 offen offset:1024
    ds_read_b128 v[56:59], v20 offset:16384
    s_waitcnt lgkmcnt(3)
    v_mfma_f32_16x16x32_bf16 v[120:123], v[40:43], v[72:75], v[120:123]
    s_add_u32 m0, s53, 61440
    v_mfma_f32_16x16x32_bf16 v[124:127], v[40:43], v[76:79], v[124:127]
    s_add_u32 s56, s50, 61440
    ds_read_b128 v[60:63], v20 offset:17408
    v_mfma_f32_16x16x32_bf16 v[192:195], v[44:47], v[72:75], v[192:195]
    s_add_u32 s57, s56, s53
    v_mfma_f32_16x16x32_bf16 v[196:199], v[44:47], v[76:79], v[196:199]
    buffer_load_dwordx4 v10, s[12:15], s57 offen lds
    ds_read_b128 v[40:43], v20 offset:18432
    s_waitcnt lgkmcnt(3)
    v_mfma_f32_16x16x32_bf16 v[128:131], v[48:51], v[72:75], v[128:131]
    s_add_u32 m0, s53, 69632
    v_mfma_f32_16x16x32_bf16 v[132:135], v[48:51], v[76:79], v[132:135]
    s_add_u32 s57, s57, 8192
    ds_read_b128 v[44:47], v20 offset:19456
    v_mfma_f32_16x16x32_bf16 v[200:203], v[52:55], v[72:75], v[200:203]
    buffer_load_dwordx4 v10, s[12:15], s57 offen lds
    v_mfma_f32_16x16x32_bf16 v[204:207], v[52:55], v[76:79], v[204:207]
    s_add_u32 m0, s54, 61440
    ds_read_b128 v[48:51], v21 offset:0
    s_waitcnt lgkmcnt(3)
    v_mfma_f32_16x16x32_bf16 v[136:139], v[56:59], v[72:75], v[136:139]
    s_add_u32 s57, s56, s54
    v_mfma_f32_16x16x32_bf16 v[140:143], v[56:59], v[76:79], v[140:143]
    buffer_load_dwordx4 v10, s[12:15], s57 offen lds
    ds_read_b128 v[52:55], v21 offset:1024
    v_mfma_f32_16x16x32_bf16 v[208:211], v[60:63], v[72:75], v[208:211]
    v_mfma_f32_16x16x32_bf16 v[212:215], v[60:63], v[76:79], v[212:215]
    ds_read_b128 v[56:59], v21 offset:2048
    s_waitcnt lgkmcnt(3)
    v_mfma_f32_16x16x32_bf16 v[144:147], v[40:43], v[72:75], v[144:147]
    v_mfma_f32_16x16x32_bf16 v[148:151], v[40:43], v[76:79], v[148:151]
    ds_read_b128 v[60:63], v21 offset:3072
    v_mfma_f32_16x16x32_bf16 v[216:219], v[44:47], v[72:75], v[216:219]
    v_mfma_f32_16x16x32_bf16 v[220:223], v[44:47], v[76:79], v[220:223]
    ds_read_b128 v[40:43], v21 offset:4096
    s_waitcnt lgkmcnt(3)
    v_mfma_f32_16x16x32_bf16 v[112:115], v[48:51], v[80:83], v[112:115]
    v_mfma_f32_16x16x32_bf16 v[116:119], v[48:51], v[84:87], v[116:119]
    ds_read_b128 v[44:47], v21 offset:5120
    v_mfma_f32_16x16x32_bf16 v[184:187], v[52:55], v[80:83], v[184:187]
    v_mfma_f32_16x16x32_bf16 v[188:191], v[52:55], v[84:87], v[188:191]
    ds_read_b128 v[48:51], v21 offset:6144
    s_waitcnt lgkmcnt(3)
    v_mfma_f32_16x16x32_bf16 v[120:123], v[56:59], v[80:83], v[120:123]
    v_mfma_f32_16x16x32_bf16 v[124:127], v[56:59], v[84:87], v[124:127]
    ds_read_b128 v[52:55], v21 offset:7168
    v_mfma_f32_16x16x32_bf16 v[192:195], v[60:63], v[80:83], v[192:195]
    v_mfma_f32_16x16x32_bf16 v[196:199], v[60:63], v[84:87], v[196:199]
    ds_read_b128 v[56:59], v21 offset:8192
    s_waitcnt lgkmcnt(3)
    v_mfma_f32_16x16x32_bf16 v[128:131], v[40:43], v[80:83], v[128:131]
    v_mfma_f32_16x16x32_bf16 v[132:135], v[40:43], v[84:87], v[132:135]
    ds_read_b128 v[60:63], v21 offset:9216
    v_mfma_f32_16x16x32_bf16 v[200:203], v[44:47], v[80:83], v[200:203]
    v_mfma_f32_16x16x32_bf16 v[204:207], v[44:47], v[84:87], v[204:207]
    ds_read_b128 v[40:43], v21 offset:10240
    s_waitcnt lgkmcnt(3)
    v_mfma_f32_16x16x32_bf16 v[136:139], v[48:51], v[80:83], v[136:139]
    v_mfma_f32_16x16x32_bf16 v[140:143], v[48:51], v[84:87], v[140:143]
    ds_read_b128 v[44:47], v21 offset:11264
    v_mfma_f32_16x16x32_bf16 v[208:211], v[52:55], v[80:83], v[208:211]
    v_mfma_f32_16x16x32_bf16 v[212:215], v[52:55], v[84:87], v[212:215]
    ds_read_b128 v[48:51], v21 offset:12288
    s_waitcnt lgkmcnt(3)
    v_mfma_f32_16x16x32_bf16 v[144:147], v[56:59], v[80:83], v[144:147]
    v_mfma_f32_16x16x32_bf16 v[148:151], v[56:59], v[84:87], v[148:151]
    s_waitcnt vmcnt(3)
    s_barrier
    v_add_u32 v20, 40960, v14
    ds_read_b128 v[52:55], v21 offset:13312
    v_mfma_f32_16x16x32_bf16 v[216:219], v[60:63], v[80:83], v[216:219]
    s_add_u32 s55, s58, 6144
    v_mfma_f32_16x16x32_bf16 v[220:223], v[60:63], v[84:87], v[220:223]
    buffer_load_dwordx4 v[64:67], v10, s[20:23], s55 offen offset:0
    ds_read_b128 v[56:59], v21 offset:14336
    s_waitcnt lgkmcnt(3)
    v_mfma_f32_16x16x32_bf16 v[112:115], v[40:43], v[88:91], v[112:115]
    buffer_load_dwordx4 v[72:75], v10, s[20:23], s55 offen offset:1024
    v_mfma_f32_16x16x32_bf16 v[116:119], v[40:43], v[92:95], v[116:119]
    s_add_u32 s55, s58, 24576
    ds_read_b128 v[60:63], v21 offset:15360
    v_mfma_f32_16x16x32_bf16 v[184:187], v[44:47], v[88:91], v[184:187]
    buffer_load_dwordx4 v[68:71], v10, s[20:23], s55 offen offset:0
    v_mfma_f32_16x16x32_bf16 v[188:191], v[44:47], v[92:95], v[188:191]
    buffer_load_dwordx4 v[76:79], v10, s[20:23], s55 offen offset:1024
    ds_read_b128 v[40:43], v21 offset:16384
    s_waitcnt lgkmcnt(3)
    v_mfma_f32_16x16x32_bf16 v[120:123], v[48:51], v[88:91], v[120:123]
    s_add_u32 m0, s53, 0
    v_mfma_f32_16x16x32_bf16 v[124:127], v[48:51], v[92:95], v[124:127]
    s_add_u32 s56, s50, 81920
    ds_read_b128 v[44:47], v21 offset:17408
    v_mfma_f32_16x16x32_bf16 v[192:195], v[52:55], v[88:91], v[192:195]
    s_add_u32 s57, s56, s53
    v_mfma_f32_16x16x32_bf16 v[196:199], v[52:55], v[92:95], v[196:199]
    buffer_load_dwordx4 v10, s[12:15], s57 offen lds
    ds_read_b128 v[48:51], v21 offset:18432
    s_waitcnt lgkmcnt(3)
    v_mfma_f32_16x16x32_bf16 v[128:131], v[56:59], v[88:91], v[128:131]
    s_add_u32 m0, s53, 8192
    v_mfma_f32_16x16x32_bf16 v[132:135], v[56:59], v[92:95], v[132:135]
    s_add_u32 s57, s57, 8192
    ds_read_b128 v[52:55], v21 offset:19456
    v_mfma_f32_16x16x32_bf16 v[200:203], v[60:63], v[88:91], v[200:203]
    buffer_load_dwordx4 v10, s[12:15], s57 offen lds
    v_mfma_f32_16x16x32_bf16 v[204:207], v[60:63], v[92:95], v[204:207]
    s_add_u32 m0, s54, 0
    ds_read_b128 v[56:59], v20 offset:0
    s_waitcnt lgkmcnt(3)
    v_mfma_f32_16x16x32_bf16 v[136:139], v[40:43], v[88:91], v[136:139]
    s_add_u32 s57, s56, s54
    v_mfma_f32_16x16x32_bf16 v[140:143], v[40:43], v[92:95], v[140:143]
    buffer_load_dwordx4 v10, s[12:15], s57 offen lds
    ds_read_b128 v[60:63], v20 offset:1024
    v_mfma_f32_16x16x32_bf16 v[208:211], v[44:47], v[88:91], v[208:211]
    v_mfma_f32_16x16x32_bf16 v[212:215], v[44:47], v[92:95], v[212:215]
    ds_read_b128 v[40:43], v20 offset:2048
    s_waitcnt lgkmcnt(3)
    v_mfma_f32_16x16x32_bf16 v[144:147], v[48:51], v[88:91], v[144:147]
    v_mfma_f32_16x16x32_bf16 v[148:151], v[48:51], v[92:95], v[148:151]
    ds_read_b128 v[44:47], v20 offset:3072
    v_mfma_f32_16x16x32_bf16 v[216:219], v[52:55], v[88:91], v[216:219]
    v_mfma_f32_16x16x32_bf16 v[220:223], v[52:55], v[92:95], v[220:223]
    ds_read_b128 v[48:51], v20 offset:4096
    s_waitcnt lgkmcnt(3)
    v_mfma_f32_16x16x32_bf16 v[112:115], v[56:59], v[96:99], v[112:115]
    v_mfma_f32_16x16x32_bf16 v[116:119], v[56:59], v[100:103], v[116:119]
    ds_read_b128 v[52:55], v20 offset:5120
    v_mfma_f32_16x16x32_bf16 v[184:187], v[60:63], v[96:99], v[184:187]
    v_mfma_f32_16x16x32_bf16 v[188:191], v[60:63], v[100:103], v[188:191]
    ds_read_b128 v[56:59], v20 offset:6144
    s_waitcnt lgkmcnt(3)
    v_mfma_f32_16x16x32_bf16 v[120:123], v[40:43], v[96:99], v[120:123]
    v_mfma_f32_16x16x32_bf16 v[124:127], v[40:43], v[100:103], v[124:127]
    ds_read_b128 v[60:63], v20 offset:7168
    v_mfma_f32_16x16x32_bf16 v[192:195], v[44:47], v[96:99], v[192:195]
    v_mfma_f32_16x16x32_bf16 v[196:199], v[44:47], v[100:103], v[196:199]
    ds_read_b128 v[40:43], v20 offset:8192
    s_waitcnt lgkmcnt(3)
    v_mfma_f32_16x16x32_bf16 v[128:131], v[48:51], v[96:99], v[128:131]
    v_mfma_f32_16x16x32_bf16 v[132:135], v[48:51], v[100:103], v[132:135]
    ds_read_b128 v[44:47], v20 offset:9216
    v_mfma_f32_16x16x32_bf16 v[200:203], v[52:55], v[96:99], v[200:203]
    v_mfma_f32_16x16x32_bf16 v[204:207], v[52:55], v[100:103], v[204:207]
    ds_read_b128 v[48:51], v20 offset:10240
    s_waitcnt lgkmcnt(3)
    v_mfma_f32_16x16x32_bf16 v[136:139], v[56:59], v[96:99], v[136:139]
    v_mfma_f32_16x16x32_bf16 v[140:143], v[56:59], v[100:103], v[140:143]
    ds_read_b128 v[52:55], v20 offset:11264
    v_mfma_f32_16x16x32_bf16 v[208:211], v[60:63], v[96:99], v[208:211]
    v_mfma_f32_16x16x32_bf16 v[212:215], v[60:63], v[100:103], v[212:215]
    ds_read_b128 v[56:59], v20 offset:12288
    s_waitcnt lgkmcnt(3)
    v_mfma_f32_16x16x32_bf16 v[144:147], v[40:43], v[96:99], v[144:147]
    v_mfma_f32_16x16x32_bf16 v[148:151], v[40:43], v[100:103], v[148:151]
    s_waitcnt vmcnt(3)
    s_barrier
    v_add_u32 v21, 61440, v14
    ds_read_b128 v[60:63], v20 offset:13312
    v_mfma_f32_16x16x32_bf16 v[216:219], v[44:47], v[96:99], v[216:219]
    s_add_u32 s55, s58, 8192
    v_mfma_f32_16x16x32_bf16 v[220:223], v[44:47], v[100:103], v[220:223]
    buffer_load_dwordx4 v[80:83], v10, s[20:23], s55 offen offset:0
    ds_read_b128 v[40:43], v20 offset:14336
    s_waitcnt lgkmcnt(3)
    v_mfma_f32_16x16x32_bf16 v[112:115], v[48:51], v[104:107], v[112:115]
    buffer_load_dwordx4 v[88:91], v10, s[20:23], s55 offen offset:1024
    v_mfma_f32_16x16x32_bf16 v[116:119], v[48:51], v[108:111], v[116:119]
    s_add_u32 s55, s58, 26624
    ds_read_b128 v[44:47], v20 offset:15360
    v_mfma_f32_16x16x32_bf16 v[184:187], v[52:55], v[104:107], v[184:187]
    buffer_load_dwordx4 v[84:87], v10, s[20:23], s55 offen offset:0
    v_mfma_f32_16x16x32_bf16 v[188:191], v[52:55], v[108:111], v[188:191]
    buffer_load_dwordx4 v[92:95], v10, s[20:23], s55 offen offset:1024
    ds_read_b128 v[48:51], v20 offset:16384
    s_waitcnt lgkmcnt(3)
    v_mfma_f32_16x16x32_bf16 v[120:123], v[56:59], v[104:107], v[120:123]
    s_add_u32 m0, s53, 20480
    v_mfma_f32_16x16x32_bf16 v[124:127], v[56:59], v[108:111], v[124:127]
    s_add_u32 s56, s50, 102400
    ds_read_b128 v[52:55], v20 offset:17408
    v_mfma_f32_16x16x32_bf16 v[192:195], v[60:63], v[104:107], v[192:195]
    s_add_u32 s57, s56, s53
    v_mfma_f32_16x16x32_bf16 v[196:199], v[60:63], v[108:111], v[196:199]
    buffer_load_dwordx4 v10, s[12:15], s57 offen lds
    ds_read_b128 v[56:59], v20 offset:18432
    s_waitcnt lgkmcnt(3)
    v_mfma_f32_16x16x32_bf16 v[128:131], v[40:43], v[104:107], v[128:131]
    s_add_u32 m0, s53, 28672
    v_mfma_f32_16x16x32_bf16 v[132:135], v[40:43], v[108:111], v[132:135]
    s_add_u32 s57, s57, 8192
    ds_read_b128 v[60:63], v20 offset:19456
    v_mfma_f32_16x16x32_bf16 v[200:203], v[44:47], v[104:107], v[200:203]
    buffer_load_dwordx4 v10, s[12:15], s57 offen lds
    v_mfma_f32_16x16x32_bf16 v[204:207], v[44:47], v[108:111], v[204:207]
    s_add_u32 m0, s54, 20480
    ds_read_b128 v[40:43], v21 offset:0
    s_waitcnt lgkmcnt(3)
    v_mfma_f32_16x16x32_bf16 v[136:139], v[48:51], v[104:107], v[136:139]
    s_add_u32 s57, s56, s54
    v_mfma_f32_16x16x32_bf16 v[140:143], v[48:51], v[108:111], v[140:143]
    buffer_load_dwordx4 v10, s[12:15], s57 offen lds
    ds_read_b128 v[44:47], v21 offset:1024
    v_mfma_f32_16x16x32_bf16 v[208:211], v[52:55], v[104:107], v[208:211]
    v_mfma_f32_16x16x32_bf16 v[212:215], v[52:55], v[108:111], v[212:215]
    ds_read_b128 v[48:51], v21 offset:2048
    s_waitcnt lgkmcnt(3)
    v_mfma_f32_16x16x32_bf16 v[144:147], v[56:59], v[104:107], v[144:147]
    v_mfma_f32_16x16x32_bf16 v[148:151], v[56:59], v[108:111], v[148:151]
    ds_read_b128 v[52:55], v21 offset:3072
    v_mfma_f32_16x16x32_bf16 v[216:219], v[60:63], v[104:107], v[216:219]
    v_mfma_f32_16x16x32_bf16 v[220:223], v[60:63], v[108:111], v[220:223]
    ds_read_b128 v[56:59], v21 offset:4096
    s_waitcnt lgkmcnt(3)
    v_mfma_f32_16x16x32_bf16 v[112:115], v[40:43], v[64:67], v[112:115]
    v_mfma_f32_16x16x32_bf16 v[116:119], v[40:43], v[68:71], v[116:119]
    ds_read_b128 v[60:63], v21 offset:5120
    v_mfma_f32_16x16x32_bf16 v[184:187], v[44:47], v[64:67], v[184:187]
    v_mfma_f32_16x16x32_bf16 v[188:191], v[44:47], v[68:71], v[188:191]
    ds_read_b128 v[40:43], v21 offset:6144
    s_waitcnt lgkmcnt(3)
    v_mfma_f32_16x16x32_bf16 v[120:123], v[48:51], v[64:67], v[120:123]
    v_mfma_f32_16x16x32_bf16 v[124:127], v[48:51], v[68:71], v[124:127]
    ds_read_b128 v[44:47], v21 offset:7168
    v_mfma_f32_16x16x32_bf16 v[192:195], v[52:55], v[64:67], v[192:195]
    v_mfma_f32_16x16x32_bf16 v[196:199], v[52:55], v[68:71], v[196:199]
    ds_read_b128 v[48:51], v21 offset:8192
    s_waitcnt lgkmcnt(3)
    v_mfma_f32_16x16x32_bf16 v[128:131], v[56:59], v[64:67], v[128:131]
    v_mfma_f32_16x16x32_bf16 v[132:135], v[56:59], v[68:71], v[132:135]
    ds_read_b128 v[52:55], v21 offset:9216
    v_mfma_f32_16x16x32_bf16 v[200:203], v[60:63], v[64:67], v[200:203]
    v_mfma_f32_16x16x32_bf16 v[204:207], v[60:63], v[68:71], v[204:207]
    ds_read_b128 v[56:59], v21 offset:10240
    s_waitcnt lgkmcnt(3)
    v_mfma_f32_16x16x32_bf16 v[136:139], v[40:43], v[64:67], v[136:139]
    v_mfma_f32_16x16x32_bf16 v[140:143], v[40:43], v[68:71], v[140:143]
    ds_read_b128 v[60:63], v21 offset:11264
    v_mfma_f32_16x16x32_bf16 v[208:211], v[44:47], v[64:67], v[208:211]
    v_mfma_f32_16x16x32_bf16 v[212:215], v[44:47], v[68:71], v[212:215]
    ds_read_b128 v[40:43], v21 offset:12288
    s_waitcnt lgkmcnt(3)
    v_mfma_f32_16x16x32_bf16 v[144:147], v[48:51], v[64:67], v[144:147]
    v_mfma_f32_16x16x32_bf16 v[148:151], v[48:51], v[68:71], v[148:151]
    s_waitcnt vmcnt(3)
    s_barrier
    v_add_u32 v20, 0, v14
    ds_read_b128 v[44:47], v21 offset:13312
    v_mfma_f32_16x16x32_bf16 v[216:219], v[52:55], v[64:67], v[216:219]
    s_add_u32 s55, s58, 10240
    v_mfma_f32_16x16x32_bf16 v[220:223], v[52:55], v[68:71], v[220:223]
    buffer_load_dwordx4 v[96:99], v10, s[20:23], s55 offen offset:0
    ds_read_b128 v[48:51], v21 offset:14336
    s_waitcnt lgkmcnt(3)
    v_mfma_f32_16x16x32_bf16 v[112:115], v[56:59], v[72:75], v[112:115]
    buffer_load_dwordx4 v[104:107], v10, s[20:23], s55 offen offset:1024
    v_mfma_f32_16x16x32_bf16 v[116:119], v[56:59], v[76:79], v[116:119]
    s_add_u32 s55, s58, 28672
    ds_read_b128 v[52:55], v21 offset:15360
    v_mfma_f32_16x16x32_bf16 v[184:187], v[60:63], v[72:75], v[184:187]
    buffer_load_dwordx4 v[100:103], v10, s[20:23], s55 offen offset:0
    v_mfma_f32_16x16x32_bf16 v[188:191], v[60:63], v[76:79], v[188:191]
    buffer_load_dwordx4 v[108:111], v10, s[20:23], s55 offen offset:1024
    ds_read_b128 v[56:59], v21 offset:16384
    s_waitcnt lgkmcnt(3)
    v_mfma_f32_16x16x32_bf16 v[120:123], v[40:43], v[72:75], v[120:123]
    s_add_u32 m0, s53, 40960
    v_mfma_f32_16x16x32_bf16 v[124:127], v[40:43], v[76:79], v[124:127]
    s_add_u32 s56, s50, 122880
    ds_read_b128 v[60:63], v21 offset:17408
    v_mfma_f32_16x16x32_bf16 v[192:195], v[44:47], v[72:75], v[192:195]
    s_add_u32 s57, s56, s53
    v_mfma_f32_16x16x32_bf16 v[196:199], v[44:47], v[76:79], v[196:199]
    buffer_load_dwordx4 v10, s[12:15], s57 offen lds
    ds_read_b128 v[40:43], v21 offset:18432
    s_waitcnt lgkmcnt(3)
    v_mfma_f32_16x16x32_bf16 v[128:131], v[48:51], v[72:75], v[128:131]
    s_add_u32 m0, s53, 49152
    v_mfma_f32_16x16x32_bf16 v[132:135], v[48:51], v[76:79], v[132:135]
    s_add_u32 s57, s57, 8192
    ds_read_b128 v[44:47], v21 offset:19456
    v_mfma_f32_16x16x32_bf16 v[200:203], v[52:55], v[72:75], v[200:203]
    buffer_load_dwordx4 v10, s[12:15], s57 offen lds
    v_mfma_f32_16x16x32_bf16 v[204:207], v[52:55], v[76:79], v[204:207]
    s_add_u32 m0, s54, 40960
    ds_read_b128 v[48:51], v20 offset:0
    s_waitcnt lgkmcnt(3)
    v_mfma_f32_16x16x32_bf16 v[136:139], v[56:59], v[72:75], v[136:139]
    s_add_u32 s57, s56, s54
    v_mfma_f32_16x16x32_bf16 v[140:143], v[56:59], v[76:79], v[140:143]
    buffer_load_dwordx4 v10, s[12:15], s57 offen lds
    ds_read_b128 v[52:55], v20 offset:1024
    v_mfma_f32_16x16x32_bf16 v[208:211], v[60:63], v[72:75], v[208:211]
    v_mfma_f32_16x16x32_bf16 v[212:215], v[60:63], v[76:79], v[212:215]
    ds_read_b128 v[56:59], v20 offset:2048
    s_waitcnt lgkmcnt(3)
    v_mfma_f32_16x16x32_bf16 v[144:147], v[40:43], v[72:75], v[144:147]
    v_mfma_f32_16x16x32_bf16 v[148:151], v[40:43], v[76:79], v[148:151]
    ds_read_b128 v[60:63], v20 offset:3072
    v_mfma_f32_16x16x32_bf16 v[216:219], v[44:47], v[72:75], v[216:219]
    v_mfma_f32_16x16x32_bf16 v[220:223], v[44:47], v[76:79], v[220:223]
    ds_read_b128 v[40:43], v20 offset:4096
    s_waitcnt lgkmcnt(3)
    v_mfma_f32_16x16x32_bf16 v[112:115], v[48:51], v[80:83], v[112:115]
    v_mfma_f32_16x16x32_bf16 v[116:119], v[48:51], v[84:87], v[116:119]
    ds_read_b128 v[44:47], v20 offset:5120
    v_mfma_f32_16x16x32_bf16 v[184:187], v[52:55], v[80:83], v[184:187]
    v_mfma_f32_16x16x32_bf16 v[188:191], v[52:55], v[84:87], v[188:191]
    ds_read_b128 v[48:51], v20 offset:6144
    s_waitcnt lgkmcnt(3)
    v_mfma_f32_16x16x32_bf16 v[120:123], v[56:59], v[80:83], v[120:123]
    v_mfma_f32_16x16x32_bf16 v[124:127], v[56:59], v[84:87], v[124:127]
    ds_read_b128 v[52:55], v20 offset:7168
    v_mfma_f32_16x16x32_bf16 v[192:195], v[60:63], v[80:83], v[192:195]
    v_mfma_f32_16x16x32_bf16 v[196:199], v[60:63], v[84:87], v[196:199]
    ds_read_b128 v[56:59], v20 offset:8192
    s_waitcnt lgkmcnt(3)
    v_mfma_f32_16x16x32_bf16 v[128:131], v[40:43], v[80:83], v[128:131]
    v_mfma_f32_16x16x32_bf16 v[132:135], v[40:43], v[84:87], v[132:135]
    ds_read_b128 v[60:63], v20 offset:9216
    v_mfma_f32_16x16x32_bf16 v[200:203], v[44:47], v[80:83], v[200:203]
    v_mfma_f32_16x16x32_bf16 v[204:207], v[44:47], v[84:87], v[204:207]
    ds_read_b128 v[40:43], v20 offset:10240
    s_waitcnt lgkmcnt(3)
    v_mfma_f32_16x16x32_bf16 v[136:139], v[48:51], v[80:83], v[136:139]
    v_mfma_f32_16x16x32_bf16 v[140:143], v[48:51], v[84:87], v[140:143]
    ds_read_b128 v[44:47], v20 offset:11264
    v_mfma_f32_16x16x32_bf16 v[208:211], v[52:55], v[80:83], v[208:211]
    v_mfma_f32_16x16x32_bf16 v[212:215], v[52:55], v[84:87], v[212:215]
    ds_read_b128 v[48:51], v20 offset:12288
    s_waitcnt lgkmcnt(3)
    v_mfma_f32_16x16x32_bf16 v[144:147], v[56:59], v[80:83], v[144:147]
    v_mfma_f32_16x16x32_bf16 v[148:151], v[56:59], v[84:87], v[148:151]
    s_waitcnt vmcnt(3)
    s_barrier
    v_add_u32 v21, 20480, v14
    ds_read_b128 v[52:55], v20 offset:13312
    v_mfma_f32_16x16x32_bf16 v[216:219], v[60:63], v[80:83], v[216:219]
    s_add_u32 s55, s58, 12288
    v_mfma_f32_16x16x32_bf16 v[220:223], v[60:63], v[84:87], v[220:223]
    buffer_load_dwordx4 v[64:67], v10, s[20:23], s55 offen offset:0
    ds_read_b128 v[56:59], v20 offset:14336
    s_waitcnt lgkmcnt(3)
    v_mfma_f32_16x16x32_bf16 v[112:115], v[40:43], v[88:91], v[112:115]
    buffer_load_dwordx4 v[72:75], v10, s[20:23], s55 offen offset:1024
    v_mfma_f32_16x16x32_bf16 v[116:119], v[40:43], v[92:95], v[116:119]
    s_add_u32 s55, s58, 30720
    ds_read_b128 v[60:63], v20 offset:15360
    v_mfma_f32_16x16x32_bf16 v[184:187], v[44:47], v[88:91], v[184:187]
    buffer_load_dwordx4 v[68:71], v10, s[20:23], s55 offen offset:0
    v_mfma_f32_16x16x32_bf16 v[188:191], v[44:47], v[92:95], v[188:191]
    buffer_load_dwordx4 v[76:79], v10, s[20:23], s55 offen offset:1024
    ds_read_b128 v[40:43], v20 offset:16384
    s_waitcnt lgkmcnt(3)
    v_mfma_f32_16x16x32_bf16 v[120:123], v[48:51], v[88:91], v[120:123]
    s_add_u32 m0, s53, 61440
    v_mfma_f32_16x16x32_bf16 v[124:127], v[48:51], v[92:95], v[124:127]
    s_add_u32 s56, s50, 143360
    ds_read_b128 v[44:47], v20 offset:17408
    v_mfma_f32_16x16x32_bf16 v[192:195], v[52:55], v[88:91], v[192:195]
    s_add_u32 s57, s56, s53
    v_mfma_f32_16x16x32_bf16 v[196:199], v[52:55], v[92:95], v[196:199]
    buffer_load_dwordx4 v10, s[12:15], s57 offen lds
    ds_read_b128 v[48:51], v20 offset:18432
    s_waitcnt lgkmcnt(3)
    v_mfma_f32_16x16x32_bf16 v[128:131], v[56:59], v[88:91], v[128:131]
    s_add_u32 m0, s53, 69632
    v_mfma_f32_16x16x32_bf16 v[132:135], v[56:59], v[92:95], v[132:135]
    s_add_u32 s57, s57, 8192
    ds_read_b128 v[52:55], v20 offset:19456
    v_mfma_f32_16x16x32_bf16 v[200:203], v[60:63], v[88:91], v[200:203]
    buffer_load_dwordx4 v10, s[12:15], s57 offen lds
    v_mfma_f32_16x16x32_bf16 v[204:207], v[60:63], v[92:95], v[204:207]
    s_add_u32 m0, s54, 61440
    ds_read_b128 v[56:59], v21 offset:0
    s_waitcnt lgkmcnt(3)
    v_mfma_f32_16x16x32_bf16 v[136:139], v[40:43], v[88:91], v[136:139]
    s_add_u32 s57, s56, s54
    v_mfma_f32_16x16x32_bf16 v[140:143], v[40:43], v[92:95], v[140:143]
    buffer_load_dwordx4 v10, s[12:15], s57 offen lds
    ds_read_b128 v[60:63], v21 offset:1024
    v_mfma_f32_16x16x32_bf16 v[208:211], v[44:47], v[88:91], v[208:211]
    v_mfma_f32_16x16x32_bf16 v[212:215], v[44:47], v[92:95], v[212:215]
    ds_read_b128 v[40:43], v21 offset:2048
    s_waitcnt lgkmcnt(3)
    v_mfma_f32_16x16x32_bf16 v[144:147], v[48:51], v[88:91], v[144:147]
    v_mfma_f32_16x16x32_bf16 v[148:151], v[48:51], v[92:95], v[148:151]
    ds_read_b128 v[44:47], v21 offset:3072
    v_mfma_f32_16x16x32_bf16 v[216:219], v[52:55], v[88:91], v[216:219]
    v_mfma_f32_16x16x32_bf16 v[220:223], v[52:55], v[92:95], v[220:223]
    ds_read_b128 v[48:51], v21 offset:4096
    s_waitcnt lgkmcnt(3)
    v_mfma_f32_16x16x32_bf16 v[112:115], v[56:59], v[96:99], v[112:115]
    v_mfma_f32_16x16x32_bf16 v[116:119], v[56:59], v[100:103], v[116:119]
    ds_read_b128 v[52:55], v21 offset:5120
    v_mfma_f32_16x16x32_bf16 v[184:187], v[60:63], v[96:99], v[184:187]
    v_mfma_f32_16x16x32_bf16 v[188:191], v[60:63], v[100:103], v[188:191]
    ds_read_b128 v[56:59], v21 offset:6144
    s_waitcnt lgkmcnt(3)
    v_mfma_f32_16x16x32_bf16 v[120:123], v[40:43], v[96:99], v[120:123]
    v_mfma_f32_16x16x32_bf16 v[124:127], v[40:43], v[100:103], v[124:127]
    ds_read_b128 v[60:63], v21 offset:7168
    v_mfma_f32_16x16x32_bf16 v[192:195], v[44:47], v[96:99], v[192:195]
    v_mfma_f32_16x16x32_bf16 v[196:199], v[44:47], v[100:103], v[196:199]
    ds_read_b128 v[40:43], v21 offset:8192
    s_waitcnt lgkmcnt(3)
    v_mfma_f32_16x16x32_bf16 v[128:131], v[48:51], v[96:99], v[128:131]
    v_mfma_f32_16x16x32_bf16 v[132:135], v[48:51], v[100:103], v[132:135]
    ds_read_b128 v[44:47], v21 offset:9216
    v_mfma_f32_16x16x32_bf16 v[200:203], v[52:55], v[96:99], v[200:203]
    v_mfma_f32_16x16x32_bf16 v[204:207], v[52:55], v[100:103], v[204:207]
    ds_read_b128 v[48:51], v21 offset:10240
    s_waitcnt lgkmcnt(3)
    v_mfma_f32_16x16x32_bf16 v[136:139], v[56:59], v[96:99], v[136:139]
    v_mfma_f32_16x16x32_bf16 v[140:143], v[56:59], v[100:103], v[140:143]
    ds_read_b128 v[52:55], v21 offset:11264
    v_mfma_f32_16x16x32_bf16 v[208:211], v[60:63], v[96:99], v[208:211]
    v_mfma_f32_16x16x32_bf16 v[212:215], v[60:63], v[100:103], v[212:215]
    ds_read_b128 v[56:59], v21 offset:12288
    s_waitcnt lgkmcnt(3)
    v_mfma_f32_16x16x32_bf16 v[144:147], v[40:43], v[96:99], v[144:147]
    v_mfma_f32_16x16x32_bf16 v[148:151], v[40:43], v[100:103], v[148:151]
    s_waitcnt vmcnt(3)
    s_barrier
    v_add_u32 v20, 40960, v14
    ds_read_b128 v[60:63], v21 offset:13312
    v_mfma_f32_16x16x32_bf16 v[216:219], v[44:47], v[96:99], v[216:219]
    s_add_u32 s55, s58, 14336
    v_mfma_f32_16x16x32_bf16 v[220:223], v[44:47], v[100:103], v[220:223]
    buffer_load_dwordx4 v[80:83], v10, s[20:23], s55 offen offset:0
    ds_read_b128 v[40:43], v21 offset:14336
    s_waitcnt lgkmcnt(3)
    v_mfma_f32_16x16x32_bf16 v[112:115], v[48:51], v[104:107], v[112:115]
    buffer_load_dwordx4 v[88:91], v10, s[20:23], s55 offen offset:1024
    v_mfma_f32_16x16x32_bf16 v[116:119], v[48:51], v[108:111], v[116:119]
    s_add_u32 s55, s58, 32768
    ds_read_b128 v[44:47], v21 offset:15360
    v_mfma_f32_16x16x32_bf16 v[184:187], v[52:55], v[104:107], v[184:187]
    buffer_load_dwordx4 v[84:87], v10, s[20:23], s55 offen offset:0
    v_mfma_f32_16x16x32_bf16 v[188:191], v[52:55], v[108:111], v[188:191]
    buffer_load_dwordx4 v[92:95], v10, s[20:23], s55 offen offset:1024
    ds_read_b128 v[48:51], v21 offset:16384
    s_waitcnt lgkmcnt(3)
    v_mfma_f32_16x16x32_bf16 v[120:123], v[56:59], v[104:107], v[120:123]
    s_add_u32 m0, s53, 0
    v_mfma_f32_16x16x32_bf16 v[124:127], v[56:59], v[108:111], v[124:127]
    s_add_u32 s56, s50, 163840
    ds_read_b128 v[52:55], v21 offset:17408
    v_mfma_f32_16x16x32_bf16 v[192:195], v[60:63], v[104:107], v[192:195]
    s_add_u32 s57, s56, s53
    v_mfma_f32_16x16x32_bf16 v[196:199], v[60:63], v[108:111], v[196:199]
    buffer_load_dwordx4 v10, s[12:15], s57 offen lds
    ds_read_b128 v[56:59], v21 offset:18432
    s_waitcnt lgkmcnt(3)
    v_mfma_f32_16x16x32_bf16 v[128:131], v[40:43], v[104:107], v[128:131]
    s_add_u32 m0, s53, 8192
    v_mfma_f32_16x16x32_bf16 v[132:135], v[40:43], v[108:111], v[132:135]
    s_add_u32 s57, s57, 8192
    ds_read_b128 v[60:63], v21 offset:19456
    v_mfma_f32_16x16x32_bf16 v[200:203], v[44:47], v[104:107], v[200:203]
    buffer_load_dwordx4 v10, s[12:15], s57 offen lds
    v_mfma_f32_16x16x32_bf16 v[204:207], v[44:47], v[108:111], v[204:207]
    s_add_u32 m0, s54, 0
    ds_read_b128 v[40:43], v20 offset:0
    s_waitcnt lgkmcnt(3)
    v_mfma_f32_16x16x32_bf16 v[136:139], v[48:51], v[104:107], v[136:139]
    s_add_u32 s57, s56, s54
    v_mfma_f32_16x16x32_bf16 v[140:143], v[48:51], v[108:111], v[140:143]
    buffer_load_dwordx4 v10, s[12:15], s57 offen lds
    ds_read_b128 v[44:47], v20 offset:1024
    v_mfma_f32_16x16x32_bf16 v[208:211], v[52:55], v[104:107], v[208:211]
    v_mfma_f32_16x16x32_bf16 v[212:215], v[52:55], v[108:111], v[212:215]
    ds_read_b128 v[48:51], v20 offset:2048
    s_waitcnt lgkmcnt(3)
    v_mfma_f32_16x16x32_bf16 v[144:147], v[56:59], v[104:107], v[144:147]
    v_mfma_f32_16x16x32_bf16 v[148:151], v[56:59], v[108:111], v[148:151]
    ds_read_b128 v[52:55], v20 offset:3072
    v_mfma_f32_16x16x32_bf16 v[216:219], v[60:63], v[104:107], v[216:219]
    v_mfma_f32_16x16x32_bf16 v[220:223], v[60:63], v[108:111], v[220:223]
    ds_read_b128 v[56:59], v20 offset:4096
    s_waitcnt lgkmcnt(3)
    v_mfma_f32_16x16x32_bf16 v[112:115], v[40:43], v[64:67], v[112:115]
    v_mfma_f32_16x16x32_bf16 v[116:119], v[40:43], v[68:71], v[116:119]
    ds_read_b128 v[60:63], v20 offset:5120
    v_mfma_f32_16x16x32_bf16 v[184:187], v[44:47], v[64:67], v[184:187]
    v_mfma_f32_16x16x32_bf16 v[188:191], v[44:47], v[68:71], v[188:191]
    ds_read_b128 v[40:43], v20 offset:6144
    s_waitcnt lgkmcnt(3)
    v_mfma_f32_16x16x32_bf16 v[120:123], v[48:51], v[64:67], v[120:123]
    v_mfma_f32_16x16x32_bf16 v[124:127], v[48:51], v[68:71], v[124:127]
    ds_read_b128 v[44:47], v20 offset:7168
    v_mfma_f32_16x16x32_bf16 v[192:195], v[52:55], v[64:67], v[192:195]
    v_mfma_f32_16x16x32_bf16 v[196:199], v[52:55], v[68:71], v[196:199]
    ds_read_b128 v[48:51], v20 offset:8192
    s_waitcnt lgkmcnt(3)
    v_mfma_f32_16x16x32_bf16 v[128:131], v[56:59], v[64:67], v[128:131]
    v_mfma_f32_16x16x32_bf16 v[132:135], v[56:59], v[68:71], v[132:135]
    ds_read_b128 v[52:55], v20 offset:9216
    v_mfma_f32_16x16x32_bf16 v[200:203], v[60:63], v[64:67], v[200:203]
    v_mfma_f32_16x16x32_bf16 v[204:207], v[60:63], v[68:71], v[204:207]
    ds_read_b128 v[56:59], v20 offset:10240
    s_waitcnt lgkmcnt(3)
    v_mfma_f32_16x16x32_bf16 v[136:139], v[40:43], v[64:67], v[136:139]
    v_mfma_f32_16x16x32_bf16 v[140:143], v[40:43], v[68:71], v[140:143]
    ds_read_b128 v[60:63], v20 offset:11264
    v_mfma_f32_16x16x32_bf16 v[208:211], v[44:47], v[64:67], v[208:211]
    v_mfma_f32_16x16x32_bf16 v[212:215], v[44:47], v[68:71], v[212:215]
    ds_read_b128 v[40:43], v20 offset:12288
    s_waitcnt lgkmcnt(3)
    v_mfma_f32_16x16x32_bf16 v[144:147], v[48:51], v[64:67], v[144:147]
    v_mfma_f32_16x16x32_bf16 v[148:151], v[48:51], v[68:71], v[148:151]
    s_waitcnt vmcnt(3)
    s_barrier
    v_add_u32 v21, 61440, v14
    ds_read_b128 v[44:47], v20 offset:13312
    v_mfma_f32_16x16x32_bf16 v[216:219], v[52:55], v[64:67], v[216:219]
    s_add_u32 s55, s58, 16384
    v_mfma_f32_16x16x32_bf16 v[220:223], v[52:55], v[68:71], v[220:223]
    buffer_load_dwordx4 v[96:99], v10, s[20:23], s55 offen offset:0
    ds_read_b128 v[48:51], v20 offset:14336
    s_waitcnt lgkmcnt(3)
    v_mfma_f32_16x16x32_bf16 v[112:115], v[56:59], v[72:75], v[112:115]
    buffer_load_dwordx4 v[104:107], v10, s[20:23], s55 offen offset:1024
    v_mfma_f32_16x16x32_bf16 v[116:119], v[56:59], v[76:79], v[116:119]
    s_add_u32 s55, s58, 34816
    ds_read_b128 v[52:55], v20 offset:15360
    v_mfma_f32_16x16x32_bf16 v[184:187], v[60:63], v[72:75], v[184:187]
    buffer_load_dwordx4 v[100:103], v10, s[20:23], s55 offen offset:0
    v_mfma_f32_16x16x32_bf16 v[188:191], v[60:63], v[76:79], v[188:191]
    buffer_load_dwordx4 v[108:111], v10, s[20:23], s55 offen offset:1024
    ds_read_b128 v[56:59], v20 offset:16384
    s_waitcnt lgkmcnt(3)
    v_mfma_f32_16x16x32_bf16 v[120:123], v[40:43], v[72:75], v[120:123]
    s_add_u32 m0, s53, 20480
    v_mfma_f32_16x16x32_bf16 v[124:127], v[40:43], v[76:79], v[124:127]
    s_add_u32 s56, s50, 184320
    ds_read_b128 v[60:63], v20 offset:17408
    v_mfma_f32_16x16x32_bf16 v[192:195], v[44:47], v[72:75], v[192:195]
    s_add_u32 s57, s56, s53
    v_mfma_f32_16x16x32_bf16 v[196:199], v[44:47], v[76:79], v[196:199]
    buffer_load_dwordx4 v10, s[12:15], s57 offen lds
    ds_read_b128 v[40:43], v20 offset:18432
    s_waitcnt lgkmcnt(3)
    v_mfma_f32_16x16x32_bf16 v[128:131], v[48:51], v[72:75], v[128:131]
    s_add_u32 m0, s53, 28672
    v_mfma_f32_16x16x32_bf16 v[132:135], v[48:51], v[76:79], v[132:135]
    s_add_u32 s57, s57, 8192
    ds_read_b128 v[44:47], v20 offset:19456
    v_mfma_f32_16x16x32_bf16 v[200:203], v[52:55], v[72:75], v[200:203]
    buffer_load_dwordx4 v10, s[12:15], s57 offen lds
    v_mfma_f32_16x16x32_bf16 v[204:207], v[52:55], v[76:79], v[204:207]
    ds_read_b128 v[48:51], v21 offset:0
    s_waitcnt lgkmcnt(3)
    v_mfma_f32_16x16x32_bf16 v[136:139], v[56:59], v[72:75], v[136:139]
    v_mfma_f32_16x16x32_bf16 v[140:143], v[56:59], v[76:79], v[140:143]
    ds_read_b128 v[52:55], v21 offset:1024
    v_mfma_f32_16x16x32_bf16 v[208:211], v[60:63], v[72:75], v[208:211]
    v_mfma_f32_16x16x32_bf16 v[212:215], v[60:63], v[76:79], v[212:215]
    ds_read_b128 v[56:59], v21 offset:2048
    s_waitcnt lgkmcnt(3)
    v_mfma_f32_16x16x32_bf16 v[144:147], v[40:43], v[72:75], v[144:147]
    v_mfma_f32_16x16x32_bf16 v[148:151], v[40:43], v[76:79], v[148:151]
    ds_read_b128 v[60:63], v21 offset:3072
    v_mfma_f32_16x16x32_bf16 v[216:219], v[44:47], v[72:75], v[216:219]
    v_mfma_f32_16x16x32_bf16 v[220:223], v[44:47], v[76:79], v[220:223]
    ds_read_b128 v[40:43], v21 offset:4096
    s_waitcnt lgkmcnt(3)
    v_mfma_f32_16x16x32_bf16 v[112:115], v[48:51], v[80:83], v[112:115]
    v_mfma_f32_16x16x32_bf16 v[116:119], v[48:51], v[84:87], v[116:119]
    ds_read_b128 v[44:47], v21 offset:5120
    v_mfma_f32_16x16x32_bf16 v[184:187], v[52:55], v[80:83], v[184:187]
    v_mfma_f32_16x16x32_bf16 v[188:191], v[52:55], v[84:87], v[188:191]
    ds_read_b128 v[48:51], v21 offset:6144
    s_waitcnt lgkmcnt(3)
    v_mfma_f32_16x16x32_bf16 v[120:123], v[56:59], v[80:83], v[120:123]
    v_mfma_f32_16x16x32_bf16 v[124:127], v[56:59], v[84:87], v[124:127]
    ds_read_b128 v[52:55], v21 offset:7168
    v_mfma_f32_16x16x32_bf16 v[192:195], v[60:63], v[80:83], v[192:195]
    v_mfma_f32_16x16x32_bf16 v[196:199], v[60:63], v[84:87], v[196:199]
    ds_read_b128 v[56:59], v21 offset:8192
    s_waitcnt lgkmcnt(3)
    v_mfma_f32_16x16x32_bf16 v[128:131], v[40:43], v[80:83], v[128:131]
    v_mfma_f32_16x16x32_bf16 v[132:135], v[40:43], v[84:87], v[132:135]
    ds_read_b128 v[60:63], v21 offset:9216
    v_mfma_f32_16x16x32_bf16 v[200:203], v[44:47], v[80:83], v[200:203]
    v_mfma_f32_16x16x32_bf16 v[204:207], v[44:47], v[84:87], v[204:207]
    ds_read_b128 v[40:43], v21 offset:10240
    s_waitcnt lgkmcnt(3)
    v_mfma_f32_16x16x32_bf16 v[136:139], v[48:51], v[80:83], v[136:139]
    v_mfma_f32_16x16x32_bf16 v[140:143], v[48:51], v[84:87], v[140:143]
    ds_read_b128 v[44:47], v21 offset:11264
    v_mfma_f32_16x16x32_bf16 v[208:211], v[52:55], v[80:83], v[208:211]
    v_mfma_f32_16x16x32_bf16 v[212:215], v[52:55], v[84:87], v[212:215]
    ds_read_b128 v[48:51], v21 offset:12288
    s_waitcnt lgkmcnt(3)
    v_mfma_f32_16x16x32_bf16 v[144:147], v[56:59], v[80:83], v[144:147]
    v_mfma_f32_16x16x32_bf16 v[148:151], v[56:59], v[84:87], v[148:151]
    s_waitcnt vmcnt(2)
    s_barrier
    v_add_u32 v20, 0, v14
    ds_read_b128 v[52:55], v21 offset:13312
    v_mfma_f32_16x16x32_bf16 v[216:219], v[60:63], v[80:83], v[216:219]
    s_add_u32 s55, s58, 0
    v_mfma_f32_16x16x32_bf16 v[220:223], v[60:63], v[84:87], v[220:223]
    buffer_load_dwordx4 v[64:67], v10, s[20:23], s55 offen offset:0
    ds_read_b128 v[56:59], v21 offset:14336
    s_waitcnt lgkmcnt(3)
    v_mfma_f32_16x16x32_bf16 v[112:115], v[40:43], v[88:91], v[112:115]
    buffer_load_dwordx4 v[72:75], v10, s[20:23], s55 offen offset:1024
    v_mfma_f32_16x16x32_bf16 v[116:119], v[40:43], v[92:95], v[116:119]
    s_add_u32 s55, s58, 18432
    ds_read_b128 v[60:63], v21 offset:15360
    v_mfma_f32_16x16x32_bf16 v[184:187], v[44:47], v[88:91], v[184:187]
    buffer_load_dwordx4 v[68:71], v10, s[20:23], s55 offen offset:0
    v_mfma_f32_16x16x32_bf16 v[188:191], v[44:47], v[92:95], v[188:191]
    buffer_load_dwordx4 v[76:79], v10, s[20:23], s55 offen offset:1024
    ds_read_b128 v[40:43], v21 offset:16384
    s_waitcnt lgkmcnt(3)
    v_mfma_f32_16x16x32_bf16 v[120:123], v[48:51], v[88:91], v[120:123]
    s_add_u32 m0, s53, 40960
    v_mfma_f32_16x16x32_bf16 v[124:127], v[48:51], v[92:95], v[124:127]
    s_add_u32 s56, s50, 200704
    ds_read_b128 v[44:47], v21 offset:17408
    v_mfma_f32_16x16x32_bf16 v[192:195], v[52:55], v[88:91], v[192:195]
    s_add_u32 s57, s56, s53
    v_mfma_f32_16x16x32_bf16 v[196:199], v[52:55], v[92:95], v[196:199]
    buffer_load_dwordx4 v10, s[12:15], s57 offen lds
    ds_read_b128 v[48:51], v21 offset:18432
    s_waitcnt lgkmcnt(3)
    v_mfma_f32_16x16x32_bf16 v[128:131], v[56:59], v[88:91], v[128:131]
    s_add_u32 m0, s53, 49152
    v_mfma_f32_16x16x32_bf16 v[132:135], v[56:59], v[92:95], v[132:135]
    s_add_u32 s57, s57, 8192
    ds_read_b128 v[52:55], v21 offset:19456
    v_mfma_f32_16x16x32_bf16 v[200:203], v[60:63], v[88:91], v[200:203]
    buffer_load_dwordx4 v10, s[12:15], s57 offen lds
    v_mfma_f32_16x16x32_bf16 v[204:207], v[60:63], v[92:95], v[204:207]
    ds_read_b128 v[56:59], v20 offset:0
    s_waitcnt lgkmcnt(3)
    v_mfma_f32_16x16x32_bf16 v[136:139], v[40:43], v[88:91], v[136:139]
    v_mfma_f32_16x16x32_bf16 v[140:143], v[40:43], v[92:95], v[140:143]
    ds_read_b128 v[60:63], v20 offset:1024
    v_mfma_f32_16x16x32_bf16 v[208:211], v[44:47], v[88:91], v[208:211]
    v_mfma_f32_16x16x32_bf16 v[212:215], v[44:47], v[92:95], v[212:215]
    ds_read_b128 v[40:43], v20 offset:2048
    s_waitcnt lgkmcnt(3)
    v_mfma_f32_16x16x32_bf16 v[144:147], v[48:51], v[88:91], v[144:147]
    v_mfma_f32_16x16x32_bf16 v[148:151], v[48:51], v[92:95], v[148:151]
    ds_read_b128 v[44:47], v20 offset:3072
    v_mfma_f32_16x16x32_bf16 v[216:219], v[52:55], v[88:91], v[216:219]
    v_mfma_f32_16x16x32_bf16 v[220:223], v[52:55], v[92:95], v[220:223]
    ds_read_b128 v[48:51], v20 offset:4096
    s_waitcnt lgkmcnt(3)
    v_mfma_f32_16x16x32_bf16 v[112:115], v[56:59], v[96:99], v[112:115]
    v_mfma_f32_16x16x32_bf16 v[116:119], v[56:59], v[100:103], v[116:119]
    ds_read_b128 v[52:55], v20 offset:5120
    v_mfma_f32_16x16x32_bf16 v[184:187], v[60:63], v[96:99], v[184:187]
    v_mfma_f32_16x16x32_bf16 v[188:191], v[60:63], v[100:103], v[188:191]
    ds_read_b128 v[56:59], v20 offset:6144
    s_waitcnt lgkmcnt(3)
    v_mfma_f32_16x16x32_bf16 v[120:123], v[40:43], v[96:99], v[120:123]
    v_mfma_f32_16x16x32_bf16 v[124:127], v[40:43], v[100:103], v[124:127]
    ds_read_b128 v[60:63], v20 offset:7168
    v_mfma_f32_16x16x32_bf16 v[192:195], v[44:47], v[96:99], v[192:195]
    v_mfma_f32_16x16x32_bf16 v[196:199], v[44:47], v[100:103], v[196:199]
    ds_read_b128 v[40:43], v20 offset:8192
    s_waitcnt lgkmcnt(3)
    v_mfma_f32_16x16x32_bf16 v[128:131], v[48:51], v[96:99], v[128:131]
    v_mfma_f32_16x16x32_bf16 v[132:135], v[48:51], v[100:103], v[132:135]
    ds_read_b128 v[44:47], v20 offset:9216
    v_mfma_f32_16x16x32_bf16 v[200:203], v[52:55], v[96:99], v[200:203]
    v_mfma_f32_16x16x32_bf16 v[204:207], v[52:55], v[100:103], v[204:207]
    ds_read_b128 v[48:51], v20 offset:10240
    s_waitcnt lgkmcnt(3)
    v_mfma_f32_16x16x32_bf16 v[136:139], v[56:59], v[96:99], v[136:139]
    v_mfma_f32_16x16x32_bf16 v[140:143], v[56:59], v[100:103], v[140:143]
    ds_read_b128 v[52:55], v20 offset:11264
    v_mfma_f32_16x16x32_bf16 v[208:211], v[60:63], v[96:99], v[208:211]
    v_mfma_f32_16x16x32_bf16 v[212:215], v[60:63], v[100:103], v[212:215]
    ds_read_b128 v[56:59], v20 offset:12288
    s_waitcnt lgkmcnt(3)
    v_mfma_f32_16x16x32_bf16 v[144:147], v[40:43], v[96:99], v[144:147]
    v_mfma_f32_16x16x32_bf16 v[148:151], v[40:43], v[100:103], v[148:151]
    s_waitcnt vmcnt(2)
    s_barrier
    v_add_u32 v21, 20480, v14
    ds_read_b128 v[60:63], v20 offset:13312
    v_mfma_f32_16x16x32_bf16 v[216:219], v[44:47], v[96:99], v[216:219]
    s_add_u32 s55, s58, 2048
    v_mfma_f32_16x16x32_bf16 v[220:223], v[44:47], v[100:103], v[220:223]
    buffer_load_dwordx4 v[80:83], v10, s[20:23], s55 offen offset:0
    ds_read_b128 v[40:43], v20 offset:14336
    s_waitcnt lgkmcnt(3)
    v_mfma_f32_16x16x32_bf16 v[112:115], v[48:51], v[104:107], v[112:115]
    buffer_load_dwordx4 v[88:91], v10, s[20:23], s55 offen offset:1024
    v_mfma_f32_16x16x32_bf16 v[116:119], v[48:51], v[108:111], v[116:119]
    s_add_u32 s55, s58, 20480
    ds_read_b128 v[44:47], v20 offset:15360
    v_mfma_f32_16x16x32_bf16 v[184:187], v[52:55], v[104:107], v[184:187]
    buffer_load_dwordx4 v[84:87], v10, s[20:23], s55 offen offset:0
    v_mfma_f32_16x16x32_bf16 v[188:191], v[52:55], v[108:111], v[188:191]
    buffer_load_dwordx4 v[92:95], v10, s[20:23], s55 offen offset:1024
    ds_read_b128 v[48:51], v20 offset:16384
    s_waitcnt lgkmcnt(3)
    v_mfma_f32_16x16x32_bf16 v[120:123], v[56:59], v[104:107], v[120:123]
    s_add_u32 m0, s53, 61440
    v_mfma_f32_16x16x32_bf16 v[124:127], v[56:59], v[108:111], v[124:127]
    s_add_u32 s56, s50, 217088
    ds_read_b128 v[52:55], v20 offset:17408
    v_mfma_f32_16x16x32_bf16 v[192:195], v[60:63], v[104:107], v[192:195]
    s_add_u32 s57, s56, s53
    v_mfma_f32_16x16x32_bf16 v[196:199], v[60:63], v[108:111], v[196:199]
    buffer_load_dwordx4 v10, s[12:15], s57 offen lds
    ds_read_b128 v[56:59], v20 offset:18432
    s_waitcnt lgkmcnt(3)
    v_mfma_f32_16x16x32_bf16 v[128:131], v[40:43], v[104:107], v[128:131]
    s_add_u32 m0, s53, 69632
    v_mfma_f32_16x16x32_bf16 v[132:135], v[40:43], v[108:111], v[132:135]
    s_add_u32 s57, s57, 8192
    ds_read_b128 v[60:63], v20 offset:19456
    v_mfma_f32_16x16x32_bf16 v[200:203], v[44:47], v[104:107], v[200:203]
    buffer_load_dwordx4 v10, s[12:15], s57 offen lds
    v_mfma_f32_16x16x32_bf16 v[204:207], v[44:47], v[108:111], v[204:207]
    ds_read_b128 v[40:43], v21 offset:0
    s_waitcnt lgkmcnt(3)
    v_mfma_f32_16x16x32_bf16 v[136:139], v[48:51], v[104:107], v[136:139]
    v_mfma_f32_16x16x32_bf16 v[140:143], v[48:51], v[108:111], v[140:143]
    ds_read_b128 v[44:47], v21 offset:1024
    v_mfma_f32_16x16x32_bf16 v[208:211], v[52:55], v[104:107], v[208:211]
    v_mfma_f32_16x16x32_bf16 v[212:215], v[52:55], v[108:111], v[212:215]
    ds_read_b128 v[48:51], v21 offset:2048
    s_waitcnt lgkmcnt(3)
    v_mfma_f32_16x16x32_bf16 v[144:147], v[56:59], v[104:107], v[144:147]
    v_mfma_f32_16x16x32_bf16 v[148:151], v[56:59], v[108:111], v[148:151]
    ds_read_b128 v[52:55], v21 offset:3072
    v_mfma_f32_16x16x32_bf16 v[216:219], v[60:63], v[104:107], v[216:219]
    v_mfma_f32_16x16x32_bf16 v[220:223], v[60:63], v[108:111], v[220:223]
    ds_read_b128 v[56:59], v21 offset:4096
    s_waitcnt lgkmcnt(3)
    v_mfma_f32_16x16x32_bf16 v[152:155], v[40:43], v[64:67], v[152:155]
    v_mfma_f32_16x16x32_bf16 v[156:159], v[40:43], v[68:71], v[156:159]
    ds_read_b128 v[60:63], v21 offset:5120
    v_mfma_f32_16x16x32_bf16 v[224:227], v[44:47], v[64:67], v[224:227]
    v_mfma_f32_16x16x32_bf16 v[228:231], v[44:47], v[68:71], v[228:231]
    ds_read_b128 v[40:43], v21 offset:6144
    s_waitcnt lgkmcnt(3)
    v_mfma_f32_16x16x32_bf16 v[160:163], v[48:51], v[64:67], v[160:163]
    v_mfma_f32_16x16x32_bf16 v[164:167], v[48:51], v[68:71], v[164:167]
    ds_read_b128 v[44:47], v21 offset:7168
    v_mfma_f32_16x16x32_bf16 v[232:235], v[52:55], v[64:67], v[232:235]
    v_mfma_f32_16x16x32_bf16 v[236:239], v[52:55], v[68:71], v[236:239]
    ds_read_b128 v[48:51], v21 offset:8192
    s_waitcnt lgkmcnt(3)
    v_mfma_f32_16x16x32_bf16 v[168:171], v[56:59], v[64:67], v[168:171]
    v_mfma_f32_16x16x32_bf16 v[172:175], v[56:59], v[68:71], v[172:175]
    ds_read_b128 v[52:55], v21 offset:9216
    v_mfma_f32_16x16x32_bf16 v[240:243], v[60:63], v[64:67], v[240:243]
    v_mfma_f32_16x16x32_bf16 v[244:247], v[60:63], v[68:71], v[244:247]
    ds_read_b128 v[56:59], v21 offset:10240
    s_waitcnt lgkmcnt(3)
    v_mfma_f32_16x16x32_bf16 v[176:179], v[40:43], v[64:67], v[176:179]
    v_mfma_f32_16x16x32_bf16 v[180:183], v[40:43], v[68:71], v[180:183]
    s_waitcnt vmcnt(2)
    s_barrier
    v_add_u32 v20, 40960, v14
    ds_read_b128 v[60:63], v21 offset:11264
    v_mfma_f32_16x16x32_bf16 v[248:251], v[44:47], v[64:67], v[248:251]
    s_add_u32 s55, s58, 4096
    v_mfma_f32_16x16x32_bf16 v[252:255], v[44:47], v[68:71], v[252:255]
    buffer_load_dwordx4 v[96:99], v10, s[20:23], s55 offen offset:0
    ds_read_b128 v[40:43], v21 offset:12288
    s_waitcnt lgkmcnt(3)
    v_mfma_f32_16x16x32_bf16 v[152:155], v[48:51], v[72:75], v[152:155]
    buffer_load_dwordx4 v[104:107], v10, s[20:23], s55 offen offset:1024
    v_mfma_f32_16x16x32_bf16 v[156:159], v[48:51], v[76:79], v[156:159]
    s_add_u32 s55, s58, 22528
    ds_read_b128 v[44:47], v21 offset:13312
    v_mfma_f32_16x16x32_bf16 v[224:227], v[52:55], v[72:75], v[224:227]
    buffer_load_dwordx4 v[100:103], v10, s[20:23], s55 offen offset:0
    v_mfma_f32_16x16x32_bf16 v[228:231], v[52:55], v[76:79], v[228:231]
    buffer_load_dwordx4 v[108:111], v10, s[20:23], s55 offen offset:1024
    ds_read_b128 v[48:51], v21 offset:14336
    s_waitcnt lgkmcnt(3)
    v_mfma_f32_16x16x32_bf16 v[160:163], v[56:59], v[72:75], v[160:163]
    s_add_u32 m0, s53, 0
    v_mfma_f32_16x16x32_bf16 v[164:167], v[56:59], v[76:79], v[164:167]
    s_add_u32 s56, s50, 233472
    ds_read_b128 v[52:55], v21 offset:15360
    v_mfma_f32_16x16x32_bf16 v[232:235], v[60:63], v[72:75], v[232:235]
    s_add_u32 s57, s56, s53
    v_mfma_f32_16x16x32_bf16 v[236:239], v[60:63], v[76:79], v[236:239]
    buffer_load_dwordx4 v10, s[12:15], s57 offen lds
    ds_read_b128 v[56:59], v20 offset:0
    s_waitcnt lgkmcnt(3)
    v_mfma_f32_16x16x32_bf16 v[168:171], v[40:43], v[72:75], v[168:171]
    s_add_u32 m0, s53, 8192
    v_mfma_f32_16x16x32_bf16 v[172:175], v[40:43], v[76:79], v[172:175]
    s_add_u32 s57, s57, 8192
    ds_read_b128 v[60:63], v20 offset:1024
    v_mfma_f32_16x16x32_bf16 v[240:243], v[44:47], v[72:75], v[240:243]
    buffer_load_dwordx4 v10, s[12:15], s57 offen lds
    v_mfma_f32_16x16x32_bf16 v[244:247], v[44:47], v[76:79], v[244:247]
    v_pk_mul_f32 v[24:25], v[112:113], v[28:29]
    v_pk_mul_f32 v[26:27], v[114:115], v[28:29]
    ds_read_b128 v[40:43], v20 offset:2048
    s_waitcnt lgkmcnt(3)
    v_mfma_f32_16x16x32_bf16 v[176:179], v[48:51], v[72:75], v[176:179]
    v_exp_f32 v24, v24
    v_exp_f32 v25, v25
    v_mfma_f32_16x16x32_bf16 v[180:183], v[48:51], v[76:79], v[180:183]
    v_exp_f32 v26, v26
    v_exp_f32 v27, v27
    ds_read_b128 v[44:47], v20 offset:3072
    v_mfma_f32_16x16x32_bf16 v[248:251], v[52:55], v[72:75], v[248:251]
    v_pk_mul_f32 v[112:113], v[112:113], v[184:185]
    v_pk_mul_f32 v[114:115], v[114:115], v[186:187]
    v_mfma_f32_16x16x32_bf16 v[252:255], v[52:55], v[76:79], v[252:255]
    v_pk_add_f32 v[24:25], v[24:25], v[22:23]
    v_pk_add_f32 v[26:27], v[26:27], v[22:23]
    ds_read_b128 v[48:51], v20 offset:4096
    s_waitcnt lgkmcnt(3)
    v_mfma_f32_16x16x32_bf16 v[152:155], v[56:59], v[80:83], v[152:155]
    v_rcp_f32 v24, v24
    v_rcp_f32 v25, v25
    v_mfma_f32_16x16x32_bf16 v[156:159], v[56:59], v[84:87], v[156:159]
    v_rcp_f32 v26, v26
    v_rcp_f32 v27, v27
    ds_read_b128 v[52:55], v20 offset:5120
    v_mfma_f32_16x16x32_bf16 v[224:227], v[60:63], v[80:83], v[224:227]
    s_nop 0
    v_pk_mul_f32 v[112:113], v[112:113], v[24:25]
    v_mfma_f32_16x16x32_bf16 v[228:231], v[60:63], v[84:87], v[228:231]
    v_pk_mul_f32 v[114:115], v[114:115], v[26:27]
    v_cvt_pk_bf16_f32 v184, v112, v113
    ds_read_b128 v[56:59], v20 offset:6144
    s_waitcnt lgkmcnt(3)
    v_mfma_f32_16x16x32_bf16 v[160:163], v[40:43], v[80:83], v[160:163]
    v_cvt_pk_bf16_f32 v185, v114, v115
    buffer_store_dwordx2 v[184:185], v12, s[24:27], 0 offen offset:0
    v_mfma_f32_16x16x32_bf16 v[164:167], v[40:43], v[84:87], v[164:167]
    v_pk_mul_f32 v[24:25], v[120:121], v[28:29]
    v_pk_mul_f32 v[26:27], v[122:123], v[28:29]
    ds_read_b128 v[60:63], v20 offset:7168
    v_mfma_f32_16x16x32_bf16 v[232:235], v[44:47], v[80:83], v[232:235]
    v_exp_f32 v24, v24
    v_exp_f32 v25, v25
    v_mfma_f32_16x16x32_bf16 v[236:239], v[44:47], v[84:87], v[236:239]
    v_exp_f32 v26, v26
    v_exp_f32 v27, v27
    ds_read_b128 v[40:43], v20 offset:8192
    s_waitcnt lgkmcnt(3)
    v_mfma_f32_16x16x32_bf16 v[168:171], v[48:51], v[80:83], v[168:171]
    v_pk_mul_f32 v[120:121], v[120:121], v[192:193]
    v_pk_mul_f32 v[122:123], v[122:123], v[194:195]
    v_mfma_f32_16x16x32_bf16 v[172:175], v[48:51], v[84:87], v[172:175]
    v_pk_add_f32 v[24:25], v[24:25], v[22:23]
    v_pk_add_f32 v[26:27], v[26:27], v[22:23]
    ds_read_b128 v[44:47], v20 offset:9216
    v_mfma_f32_16x16x32_bf16 v[240:243], v[52:55], v[80:83], v[240:243]
    v_rcp_f32 v24, v24
    v_rcp_f32 v25, v25
    v_mfma_f32_16x16x32_bf16 v[244:247], v[52:55], v[84:87], v[244:247]
    v_rcp_f32 v26, v26
    v_rcp_f32 v27, v27
    ds_read_b128 v[48:51], v20 offset:10240
    s_waitcnt lgkmcnt(3)
    v_mfma_f32_16x16x32_bf16 v[176:179], v[56:59], v[80:83], v[176:179]
    s_nop 0
    v_pk_mul_f32 v[120:121], v[120:121], v[24:25]
    v_mfma_f32_16x16x32_bf16 v[180:183], v[56:59], v[84:87], v[180:183]
    v_pk_mul_f32 v[122:123], v[122:123], v[26:27]
    v_cvt_pk_bf16_f32 v192, v120, v121
    s_waitcnt vmcnt(3)
    s_barrier
    v_add_u32 v21, 61440, v14
    ds_read_b128 v[52:55], v20 offset:11264
    v_mfma_f32_16x16x32_bf16 v[248:251], v[60:63], v[80:83], v[248:251]
    s_add_u32 s55, s58, 6144
    v_mfma_f32_16x16x32_bf16 v[252:255], v[60:63], v[84:87], v[252:255]
    buffer_load_dwordx4 v[64:67], v10, s[20:23], s55 offen offset:0
    ds_read_b128 v[56:59], v20 offset:12288
    s_waitcnt lgkmcnt(3)
    v_mfma_f32_16x16x32_bf16 v[152:155], v[40:43], v[88:91], v[152:155]
    buffer_load_dwordx4 v[72:75], v10, s[20:23], s55 offen offset:1024
    v_mfma_f32_16x16x32_bf16 v[156:159], v[40:43], v[92:95], v[156:159]
    s_add_u32 s55, s58, 24576
    ds_read_b128 v[60:63], v20 offset:13312
    v_mfma_f32_16x16x32_bf16 v[224:227], v[44:47], v[88:91], v[224:227]
    buffer_load_dwordx4 v[68:71], v10, s[20:23], s55 offen offset:0
    v_mfma_f32_16x16x32_bf16 v[228:231], v[44:47], v[92:95], v[228:231]
    buffer_load_dwordx4 v[76:79], v10, s[20:23], s55 offen offset:1024
    ds_read_b128 v[40:43], v20 offset:14336
    s_waitcnt lgkmcnt(3)
    v_mfma_f32_16x16x32_bf16 v[160:163], v[48:51], v[88:91], v[160:163]
    s_add_u32 m0, s53, 20480
    v_mfma_f32_16x16x32_bf16 v[164:167], v[48:51], v[92:95], v[164:167]
    s_add_u32 s56, s50, 249856
    ds_read_b128 v[44:47], v20 offset:15360
    v_mfma_f32_16x16x32_bf16 v[232:235], v[52:55], v[88:91], v[232:235]
    s_add_u32 s57, s56, s53
    v_mfma_f32_16x16x32_bf16 v[236:239], v[52:55], v[92:95], v[236:239]
    buffer_load_dwordx4 v10, s[12:15], s57 offen lds
    ds_read_b128 v[48:51], v21 offset:0
    s_waitcnt lgkmcnt(3)
    v_mfma_f32_16x16x32_bf16 v[168:171], v[56:59], v[88:91], v[168:171]
    s_add_u32 m0, s53, 28672
    v_mfma_f32_16x16x32_bf16 v[172:175], v[56:59], v[92:95], v[172:175]
    s_add_u32 s57, s57, 8192
    ds_read_b128 v[52:55], v21 offset:1024
    v_mfma_f32_16x16x32_bf16 v[240:243], v[60:63], v[88:91], v[240:243]
    buffer_load_dwordx4 v10, s[12:15], s57 offen lds
    v_mfma_f32_16x16x32_bf16 v[244:247], v[60:63], v[92:95], v[244:247]
    v_cvt_pk_bf16_f32 v193, v122, v123
    buffer_store_dwordx2 v[192:193], v12, s[24:27], 0 offen offset:512
    ds_read_b128 v[56:59], v21 offset:2048
    s_waitcnt lgkmcnt(3)
    v_mfma_f32_16x16x32_bf16 v[176:179], v[40:43], v[88:91], v[176:179]
    v_pk_mul_f32 v[24:25], v[128:129], v[28:29]
    v_pk_mul_f32 v[26:27], v[130:131], v[28:29]
    v_mfma_f32_16x16x32_bf16 v[180:183], v[40:43], v[92:95], v[180:183]
    v_exp_f32 v24, v24
    v_exp_f32 v25, v25
    ds_read_b128 v[60:63], v21 offset:3072
    v_mfma_f32_16x16x32_bf16 v[248:251], v[44:47], v[88:91], v[248:251]
    v_exp_f32 v26, v26
    v_exp_f32 v27, v27
    v_mfma_f32_16x16x32_bf16 v[252:255], v[44:47], v[92:95], v[252:255]
    v_pk_mul_f32 v[128:129], v[128:129], v[200:201]
    v_pk_mul_f32 v[130:131], v[130:131], v[202:203]
    ds_read_b128 v[40:43], v21 offset:4096
    s_waitcnt lgkmcnt(3)
    v_mfma_f32_16x16x32_bf16 v[152:155], v[48:51], v[96:99], v[152:155]
    v_pk_add_f32 v[24:25], v[24:25], v[22:23]
    v_pk_add_f32 v[26:27], v[26:27], v[22:23]
    v_mfma_f32_16x16x32_bf16 v[156:159], v[48:51], v[100:103], v[156:159]
    v_rcp_f32 v24, v24
    v_rcp_f32 v25, v25
    ds_read_b128 v[44:47], v21 offset:5120
    v_mfma_f32_16x16x32_bf16 v[224:227], v[52:55], v[96:99], v[224:227]
    v_rcp_f32 v26, v26
    v_rcp_f32 v27, v27
    v_mfma_f32_16x16x32_bf16 v[228:231], v[52:55], v[100:103], v[228:231]
    s_nop 0
    v_pk_mul_f32 v[128:129], v[128:129], v[24:25]
    ds_read_b128 v[48:51], v21 offset:6144
    s_waitcnt lgkmcnt(3)
    v_mfma_f32_16x16x32_bf16 v[160:163], v[56:59], v[96:99], v[160:163]
    v_pk_mul_f32 v[130:131], v[130:131], v[26:27]
    v_cvt_pk_bf16_f32 v200, v128, v129
    v_mfma_f32_16x16x32_bf16 v[164:167], v[56:59], v[100:103], v[164:167]
    v_cvt_pk_bf16_f32 v201, v130, v131
    buffer_store_dwordx2 v[200:201], v12, s[24:27], 0 offen offset:1024
    ds_read_b128 v[52:55], v21 offset:7168
    v_mfma_f32_16x16x32_bf16 v[232:235], v[60:63], v[96:99], v[232:235]
    v_pk_mul_f32 v[24:25], v[136:137], v[28:29]
    v_pk_mul_f32 v[26:27], v[138:139], v[28:29]
    v_mfma_f32_16x16x32_bf16 v[236:239], v[60:63], v[100:103], v[236:239]
    v_exp_f32 v24, v24
    v_exp_f32 v25, v25
    ds_read_b128 v[56:59], v21 offset:8192
    s_waitcnt lgkmcnt(3)
    v_mfma_f32_16x16x32_bf16 v[168:171], v[40:43], v[96:99], v[168:171]
    v_exp_f32 v26, v26
    v_exp_f32 v27, v27
    v_mfma_f32_16x16x32_bf16 v[172:175], v[40:43], v[100:103], v[172:175]
    v_pk_mul_f32 v[136:137], v[136:137], v[208:209]
    v_pk_mul_f32 v[138:139], v[138:139], v[210:211]
    ds_read_b128 v[60:63], v21 offset:9216
    v_mfma_f32_16x16x32_bf16 v[240:243], v[44:47], v[96:99], v[240:243]
    v_pk_add_f32 v[24:25], v[24:25], v[22:23]
    v_pk_add_f32 v[26:27], v[26:27], v[22:23]
    v_mfma_f32_16x16x32_bf16 v[244:247], v[44:47], v[100:103], v[244:247]
    v_rcp_f32 v24, v24
    v_rcp_f32 v25, v25
    ds_read_b128 v[40:43], v21 offset:10240
    s_waitcnt lgkmcnt(3)
    v_mfma_f32_16x16x32_bf16 v[176:179], v[48:51], v[96:99], v[176:179]
    v_rcp_f32 v26, v26
    v_rcp_f32 v27, v27
    v_mfma_f32_16x16x32_bf16 v[180:183], v[48:51], v[100:103], v[180:183]
    s_nop 0
    v_pk_mul_f32 v[136:137], v[136:137], v[24:25]
    s_waitcnt vmcnt(4)
    s_barrier
    v_add_u32 v20, 0, v14
    ds_read_b128 v[44:47], v21 offset:11264
    v_mfma_f32_16x16x32_bf16 v[248:251], v[52:55], v[96:99], v[248:251]
    s_add_u32 s55, s58, 8192
    v_mfma_f32_16x16x32_bf16 v[252:255], v[52:55], v[100:103], v[252:255]
    buffer_load_dwordx4 v[80:83], v10, s[20:23], s55 offen offset:0
    ds_read_b128 v[48:51], v21 offset:12288
    s_waitcnt lgkmcnt(3)
    v_mfma_f32_16x16x32_bf16 v[152:155], v[56:59], v[104:107], v[152:155]
    buffer_load_dwordx4 v[88:91], v10, s[20:23], s55 offen offset:1024
    v_mfma_f32_16x16x32_bf16 v[156:159], v[56:59], v[108:111], v[156:159]
    s_add_u32 s55, s58, 26624
    ds_read_b128 v[52:55], v21 offset:13312
    v_mfma_f32_16x16x32_bf16 v[224:227], v[60:63], v[104:107], v[224:227]
    buffer_load_dwordx4 v[84:87], v10, s[20:23], s55 offen offset:0
    v_mfma_f32_16x16x32_bf16 v[228:231], v[60:63], v[108:111], v[228:231]
    buffer_load_dwordx4 v[92:95], v10, s[20:23], s55 offen offset:1024
    ds_read_b128 v[56:59], v21 offset:14336
    s_waitcnt lgkmcnt(3)
    v_mfma_f32_16x16x32_bf16 v[160:163], v[40:43], v[104:107], v[160:163]
    s_add_u32 m0, s53, 40960
    v_mfma_f32_16x16x32_bf16 v[164:167], v[40:43], v[108:111], v[164:167]
    s_add_u32 s56, s50, 266240
    ds_read_b128 v[60:63], v21 offset:15360
    v_mfma_f32_16x16x32_bf16 v[232:235], v[44:47], v[104:107], v[232:235]
    s_add_u32 s57, s56, s53
    v_mfma_f32_16x16x32_bf16 v[236:239], v[44:47], v[108:111], v[236:239]
    buffer_load_dwordx4 v10, s[12:15], s57 offen lds
    ds_read_b128 v[40:43], v20 offset:0
    s_waitcnt lgkmcnt(3)
    v_mfma_f32_16x16x32_bf16 v[168:171], v[48:51], v[104:107], v[168:171]
    s_add_u32 m0, s53, 49152
    v_mfma_f32_16x16x32_bf16 v[172:175], v[48:51], v[108:111], v[172:175]
    s_add_u32 s57, s57, 8192
    ds_read_b128 v[44:47], v20 offset:1024
    v_mfma_f32_16x16x32_bf16 v[240:243], v[52:55], v[104:107], v[240:243]
    buffer_load_dwordx4 v10, s[12:15], s57 offen lds
    v_mfma_f32_16x16x32_bf16 v[244:247], v[52:55], v[108:111], v[244:247]
    v_pk_mul_f32 v[138:139], v[138:139], v[26:27]
    v_cvt_pk_bf16_f32 v208, v136, v137
    ds_read_b128 v[48:51], v20 offset:2048
    s_waitcnt lgkmcnt(3)
    v_mfma_f32_16x16x32_bf16 v[176:179], v[56:59], v[104:107], v[176:179]
    v_cvt_pk_bf16_f32 v209, v138, v139
    buffer_store_dwordx2 v[208:209], v12, s[24:27], 0 offen offset:1536
    v_mfma_f32_16x16x32_bf16 v[180:183], v[56:59], v[108:111], v[180:183]
    v_pk_mul_f32 v[24:25], v[144:145], v[28:29]
    v_pk_mul_f32 v[26:27], v[146:147], v[28:29]
    ds_read_b128 v[52:55], v20 offset:3072
    v_mfma_f32_16x16x32_bf16 v[248:251], v[60:63], v[104:107], v[248:251]
    v_exp_f32 v24, v24
    v_exp_f32 v25, v25
    v_mfma_f32_16x16x32_bf16 v[252:255], v[60:63], v[108:111], v[252:255]
    v_exp_f32 v26, v26
    v_exp_f32 v27, v27
    ds_read_b128 v[56:59], v20 offset:4096
    s_waitcnt lgkmcnt(3)
    v_mfma_f32_16x16x32_bf16 v[152:155], v[40:43], v[64:67], v[152:155]
    v_pk_mul_f32 v[144:145], v[144:145], v[216:217]
    v_pk_mul_f32 v[146:147], v[146:147], v[218:219]
    v_mfma_f32_16x16x32_bf16 v[156:159], v[40:43], v[68:71], v[156:159]
    v_pk_add_f32 v[24:25], v[24:25], v[22:23]
    v_pk_add_f32 v[26:27], v[26:27], v[22:23]
    ds_read_b128 v[60:63], v20 offset:5120
    v_mfma_f32_16x16x32_bf16 v[224:227], v[44:47], v[64:67], v[224:227]
    v_rcp_f32 v24, v24
    v_rcp_f32 v25, v25
    v_mfma_f32_16x16x32_bf16 v[228:231], v[44:47], v[68:71], v[228:231]
    v_rcp_f32 v26, v26
    v_rcp_f32 v27, v27
    ds_read_b128 v[40:43], v20 offset:6144
    s_waitcnt lgkmcnt(3)
    v_mfma_f32_16x16x32_bf16 v[160:163], v[48:51], v[64:67], v[160:163]
    s_nop 0
    v_pk_mul_f32 v[144:145], v[144:145], v[24:25]
    v_mfma_f32_16x16x32_bf16 v[164:167], v[48:51], v[68:71], v[164:167]
    v_pk_mul_f32 v[146:147], v[146:147], v[26:27]
    v_cvt_pk_bf16_f32 v216, v144, v145
    ds_read_b128 v[44:47], v20 offset:7168
    v_mfma_f32_16x16x32_bf16 v[232:235], v[52:55], v[64:67], v[232:235]
    v_cvt_pk_bf16_f32 v217, v146, v147
    buffer_store_dwordx2 v[216:217], v12, s[24:27], 0 offen offset:2048
    v_mfma_f32_16x16x32_bf16 v[236:239], v[52:55], v[68:71], v[236:239]
    v_pk_mul_f32 v[24:25], v[116:117], v[28:29]
    v_pk_mul_f32 v[26:27], v[118:119], v[28:29]
    ds_read_b128 v[48:51], v20 offset:8192
    s_waitcnt lgkmcnt(3)
    v_mfma_f32_16x16x32_bf16 v[168:171], v[56:59], v[64:67], v[168:171]
    v_exp_f32 v24, v24
    v_exp_f32 v25, v25
    v_mfma_f32_16x16x32_bf16 v[172:175], v[56:59], v[68:71], v[172:175]
    v_exp_f32 v26, v26
    v_exp_f32 v27, v27
    ds_read_b128 v[52:55], v20 offset:9216
    v_mfma_f32_16x16x32_bf16 v[240:243], v[60:63], v[64:67], v[240:243]
    v_pk_mul_f32 v[116:117], v[116:117], v[188:189]
    v_pk_mul_f32 v[118:119], v[118:119], v[190:191]
    v_mfma_f32_16x16x32_bf16 v[244:247], v[60:63], v[68:71], v[244:247]
    v_pk_add_f32 v[24:25], v[24:25], v[22:23]
    v_pk_add_f32 v[26:27], v[26:27], v[22:23]
    ds_read_b128 v[56:59], v20 offset:10240
    s_waitcnt lgkmcnt(3)
    v_mfma_f32_16x16x32_bf16 v[176:179], v[40:43], v[64:67], v[176:179]
    v_rcp_f32 v24, v24
    v_rcp_f32 v25, v25
    v_mfma_f32_16x16x32_bf16 v[180:183], v[40:43], v[68:71], v[180:183]
    v_rcp_f32 v26, v26
    v_rcp_f32 v27, v27
    s_waitcnt vmcnt(4)
    s_barrier
    v_add_u32 v21, 20480, v14
    ds_read_b128 v[60:63], v20 offset:11264
    v_mfma_f32_16x16x32_bf16 v[248:251], v[44:47], v[64:67], v[248:251]
    s_add_u32 s55, s58, 10240
    v_mfma_f32_16x16x32_bf16 v[252:255], v[44:47], v[68:71], v[252:255]
    buffer_load_dwordx4 v[96:99], v10, s[20:23], s55 offen offset:0
    ds_read_b128 v[40:43], v20 offset:12288
    s_waitcnt lgkmcnt(3)
    v_mfma_f32_16x16x32_bf16 v[152:155], v[48:51], v[72:75], v[152:155]
    buffer_load_dwordx4 v[104:107], v10, s[20:23], s55 offen offset:1024
    v_mfma_f32_16x16x32_bf16 v[156:159], v[48:51], v[76:79], v[156:159]
    s_add_u32 s55, s58, 28672
    ds_read_b128 v[44:47], v20 offset:13312
    v_mfma_f32_16x16x32_bf16 v[224:227], v[52:55], v[72:75], v[224:227]
    buffer_load_dwordx4 v[100:103], v10, s[20:23], s55 offen offset:0
    v_mfma_f32_16x16x32_bf16 v[228:231], v[52:55], v[76:79], v[228:231]
    buffer_load_dwordx4 v[108:111], v10, s[20:23], s55 offen offset:1024
    ds_read_b128 v[48:51], v20 offset:14336
    s_waitcnt lgkmcnt(3)
    v_mfma_f32_16x16x32_bf16 v[160:163], v[56:59], v[72:75], v[160:163]
    s_add_u32 m0, s53, 61440
    v_mfma_f32_16x16x32_bf16 v[164:167], v[56:59], v[76:79], v[164:167]
    s_add_u32 s56, s50, 282624
    ds_read_b128 v[52:55], v20 offset:15360
    v_mfma_f32_16x16x32_bf16 v[232:235], v[60:63], v[72:75], v[232:235]
    s_add_u32 s57, s56, s53
    v_mfma_f32_16x16x32_bf16 v[236:239], v[60:63], v[76:79], v[236:239]
    buffer_load_dwordx4 v10, s[12:15], s57 offen lds
    ds_read_b128 v[56:59], v21 offset:0
    s_waitcnt lgkmcnt(3)
    v_mfma_f32_16x16x32_bf16 v[168:171], v[40:43], v[72:75], v[168:171]
    s_add_u32 m0, s53, 69632
    v_mfma_f32_16x16x32_bf16 v[172:175], v[40:43], v[76:79], v[172:175]
    s_add_u32 s57, s57, 8192
    ds_read_b128 v[60:63], v21 offset:1024
    v_mfma_f32_16x16x32_bf16 v[240:243], v[44:47], v[72:75], v[240:243]
    buffer_load_dwordx4 v10, s[12:15], s57 offen lds
    v_mfma_f32_16x16x32_bf16 v[244:247], v[44:47], v[76:79], v[244:247]
    s_nop 0
    v_pk_mul_f32 v[116:117], v[116:117], v[24:25]
    ds_read_b128 v[40:43], v21 offset:2048
    s_waitcnt lgkmcnt(3)
    v_mfma_f32_16x16x32_bf16 v[176:179], v[48:51], v[72:75], v[176:179]
    v_pk_mul_f32 v[118:119], v[118:119], v[26:27]
    v_cvt_pk_bf16_f32 v188, v116, v117
    v_mfma_f32_16x16x32_bf16 v[180:183], v[48:51], v[76:79], v[180:183]
    v_cvt_pk_bf16_f32 v189, v118, v119
    buffer_store_dwordx2 v[188:189], v13, s[24:27], 0 offen offset:0
    ds_read_b128 v[44:47], v21 offset:3072
    v_mfma_f32_16x16x32_bf16 v[248:251], v[52:55], v[72:75], v[248:251]
    v_pk_mul_f32 v[24:25], v[124:125], v[28:29]
    v_pk_mul_f32 v[26:27], v[126:127], v[28:29]
    v_mfma_f32_16x16x32_bf16 v[252:255], v[52:55], v[76:79], v[252:255]
    v_exp_f32 v24, v24
    v_exp_f32 v25, v25
    ds_read_b128 v[48:51], v21 offset:4096
    s_waitcnt lgkmcnt(3)
    v_mfma_f32_16x16x32_bf16 v[152:155], v[56:59], v[80:83], v[152:155]
    v_exp_f32 v26, v26
    v_exp_f32 v27, v27
    v_mfma_f32_16x16x32_bf16 v[156:159], v[56:59], v[84:87], v[156:159]
    v_pk_mul_f32 v[124:125], v[124:125], v[196:197]
    v_pk_mul_f32 v[126:127], v[126:127], v[198:199]
    ds_read_b128 v[52:55], v21 offset:5120
    v_mfma_f32_16x16x32_bf16 v[224:227], v[60:63], v[80:83], v[224:227]
    v_pk_add_f32 v[24:25], v[24:25], v[22:23]
    v_pk_add_f32 v[26:27], v[26:27], v[22:23]
    v_mfma_f32_16x16x32_bf16 v[228:231], v[60:63], v[84:87], v[228:231]
    v_rcp_f32 v24, v24
    v_rcp_f32 v25, v25
    ds_read_b128 v[56:59], v21 offset:6144
    s_waitcnt lgkmcnt(3)
    v_mfma_f32_16x16x32_bf16 v[160:163], v[40:43], v[80:83], v[160:163]
    v_rcp_f32 v26, v26
    v_rcp_f32 v27, v27
    v_mfma_f32_16x16x32_bf16 v[164:167], v[40:43], v[84:87], v[164:167]
    s_nop 0
    v_pk_mul_f32 v[124:125], v[124:125], v[24:25]
    ds_read_b128 v[60:63], v21 offset:7168
    v_mfma_f32_16x16x32_bf16 v[232:235], v[44:47], v[80:83], v[232:235]
    v_pk_mul_f32 v[126:127], v[126:127], v[26:27]
    v_cvt_pk_bf16_f32 v196, v124, v125
    v_mfma_f32_16x16x32_bf16 v[236:239], v[44:47], v[84:87], v[236:239]
    v_cvt_pk_bf16_f32 v197, v126, v127
    buffer_store_dwordx2 v[196:197], v13, s[24:27], 0 offen offset:512
    ds_read_b128 v[40:43], v21 offset:8192
    s_waitcnt lgkmcnt(3)
    v_mfma_f32_16x16x32_bf16 v[168:171], v[48:51], v[80:83], v[168:171]
    v_pk_mul_f32 v[24:25], v[132:133], v[28:29]
    v_pk_mul_f32 v[26:27], v[134:135], v[28:29]
    v_mfma_f32_16x16x32_bf16 v[172:175], v[48:51], v[84:87], v[172:175]
    v_exp_f32 v24, v24
    v_exp_f32 v25, v25
    ds_read_b128 v[44:47], v21 offset:9216
    v_mfma_f32_16x16x32_bf16 v[240:243], v[52:55], v[80:83], v[240:243]
    v_exp_f32 v26, v26
    v_exp_f32 v27, v27
    v_mfma_f32_16x16x32_bf16 v[244:247], v[52:55], v[84:87], v[244:247]
    v_pk_mul_f32 v[132:133], v[132:133], v[204:205]
    v_pk_mul_f32 v[134:135], v[134:135], v[206:207]
    ds_read_b128 v[48:51], v21 offset:10240
    s_waitcnt lgkmcnt(3)
    v_mfma_f32_16x16x32_bf16 v[176:179], v[56:59], v[80:83], v[176:179]
    v_pk_add_f32 v[24:25], v[24:25], v[22:23]
    v_pk_add_f32 v[26:27], v[26:27], v[22:23]
    v_mfma_f32_16x16x32_bf16 v[180:183], v[56:59], v[84:87], v[180:183]
    v_rcp_f32 v24, v24
    v_rcp_f32 v25, v25
    s_waitcnt vmcnt(4)
    s_barrier
    v_add_u32 v20, 40960, v14
    ds_read_b128 v[52:55], v21 offset:11264
    v_mfma_f32_16x16x32_bf16 v[248:251], v[60:63], v[80:83], v[248:251]
    s_add_u32 s55, s58, 12288
    v_mfma_f32_16x16x32_bf16 v[252:255], v[60:63], v[84:87], v[252:255]
    buffer_load_dwordx4 v[64:67], v10, s[20:23], s55 offen offset:0
    ds_read_b128 v[56:59], v21 offset:12288
    s_waitcnt lgkmcnt(3)
    v_mfma_f32_16x16x32_bf16 v[152:155], v[40:43], v[88:91], v[152:155]
    buffer_load_dwordx4 v[72:75], v10, s[20:23], s55 offen offset:1024
    v_mfma_f32_16x16x32_bf16 v[156:159], v[40:43], v[92:95], v[156:159]
    s_add_u32 s55, s58, 30720
    ds_read_b128 v[60:63], v21 offset:13312
    v_mfma_f32_16x16x32_bf16 v[224:227], v[44:47], v[88:91], v[224:227]
    buffer_load_dwordx4 v[68:71], v10, s[20:23], s55 offen offset:0
    v_mfma_f32_16x16x32_bf16 v[228:231], v[44:47], v[92:95], v[228:231]
    buffer_load_dwordx4 v[76:79], v10, s[20:23], s55 offen offset:1024
    ds_read_b128 v[40:43], v21 offset:14336
    s_waitcnt lgkmcnt(3)
    v_mfma_f32_16x16x32_bf16 v[160:163], v[48:51], v[88:91], v[160:163]
    s_add_u32 m0, s53, 0
    v_mfma_f32_16x16x32_bf16 v[164:167], v[48:51], v[92:95], v[164:167]
    s_add_u32 s56, s50, 299008
    ds_read_b128 v[44:47], v21 offset:15360
    v_mfma_f32_16x16x32_bf16 v[232:235], v[52:55], v[88:91], v[232:235]
    s_add_u32 s57, s56, s53
    v_mfma_f32_16x16x32_bf16 v[236:239], v[52:55], v[92:95], v[236:239]
    buffer_load_dwordx4 v10, s[12:15], s57 offen lds
    ds_read_b128 v[48:51], v20 offset:0
    s_waitcnt lgkmcnt(3)
    v_mfma_f32_16x16x32_bf16 v[168:171], v[56:59], v[88:91], v[168:171]
    s_add_u32 m0, s53, 8192
    v_mfma_f32_16x16x32_bf16 v[172:175], v[56:59], v[92:95], v[172:175]
    s_add_u32 s57, s57, 8192
    ds_read_b128 v[52:55], v20 offset:1024
    v_mfma_f32_16x16x32_bf16 v[240:243], v[60:63], v[88:91], v[240:243]
    buffer_load_dwordx4 v10, s[12:15], s57 offen lds
    v_mfma_f32_16x16x32_bf16 v[244:247], v[60:63], v[92:95], v[244:247]
    v_rcp_f32 v26, v26
    v_rcp_f32 v27, v27
    ds_read_b128 v[56:59], v20 offset:2048
    s_waitcnt lgkmcnt(3)
    v_mfma_f32_16x16x32_bf16 v[176:179], v[40:43], v[88:91], v[176:179]
    s_nop 0
    v_pk_mul_f32 v[132:133], v[132:133], v[24:25]
    v_mfma_f32_16x16x32_bf16 v[180:183], v[40:43], v[92:95], v[180:183]
    v_pk_mul_f32 v[134:135], v[134:135], v[26:27]
    v_cvt_pk_bf16_f32 v204, v132, v133
    ds_read_b128 v[60:63], v20 offset:3072
    v_mfma_f32_16x16x32_bf16 v[248:251], v[44:47], v[88:91], v[248:251]
    v_cvt_pk_bf16_f32 v205, v134, v135
    buffer_store_dwordx2 v[204:205], v13, s[24:27], 0 offen offset:1024
    v_mfma_f32_16x16x32_bf16 v[252:255], v[44:47], v[92:95], v[252:255]
    v_pk_mul_f32 v[24:25], v[140:141], v[28:29]
    v_pk_mul_f32 v[26:27], v[142:143], v[28:29]
    ds_read_b128 v[40:43], v20 offset:4096
    s_waitcnt lgkmcnt(3)
    v_mfma_f32_16x16x32_bf16 v[152:155], v[48:51], v[96:99], v[152:155]
    v_exp_f32 v24, v24
    v_exp_f32 v25, v25
    v_mfma_f32_16x16x32_bf16 v[156:159], v[48:51], v[100:103], v[156:159]
    v_exp_f32 v26, v26
    v_exp_f32 v27, v27
    ds_read_b128 v[44:47], v20 offset:5120
    v_mfma_f32_16x16x32_bf16 v[224:227], v[52:55], v[96:99], v[224:227]
    v_pk_mul_f32 v[140:141], v[140:141], v[212:213]
    v_pk_mul_f32 v[142:143], v[142:143], v[214:215]
    v_mfma_f32_16x16x32_bf16 v[228:231], v[52:55], v[100:103], v[228:231]
    v_pk_add_f32 v[24:25], v[24:25], v[22:23]
    v_pk_add_f32 v[26:27], v[26:27], v[22:23]
    ds_read_b128 v[48:51], v20 offset:6144
    s_waitcnt lgkmcnt(3)
    v_mfma_f32_16x16x32_bf16 v[160:163], v[56:59], v[96:99], v[160:163]
    v_rcp_f32 v24, v24
    v_rcp_f32 v25, v25
    v_mfma_f32_16x16x32_bf16 v[164:167], v[56:59], v[100:103], v[164:167]
    v_rcp_f32 v26, v26
    v_rcp_f32 v27, v27
    ds_read_b128 v[52:55], v20 offset:7168
    v_mfma_f32_16x16x32_bf16 v[232:235], v[60:63], v[96:99], v[232:235]
    s_nop 0
    v_pk_mul_f32 v[140:141], v[140:141], v[24:25]
    v_mfma_f32_16x16x32_bf16 v[236:239], v[60:63], v[100:103], v[236:239]
    v_pk_mul_f32 v[142:143], v[142:143], v[26:27]
    v_cvt_pk_bf16_f32 v212, v140, v141
    ds_read_b128 v[56:59], v20 offset:8192
    s_waitcnt lgkmcnt(3)
    v_mfma_f32_16x16x32_bf16 v[168:171], v[40:43], v[96:99], v[168:171]
    v_cvt_pk_bf16_f32 v213, v142, v143
    buffer_store_dwordx2 v[212:213], v13, s[24:27], 0 offen offset:1536
    v_mfma_f32_16x16x32_bf16 v[172:175], v[40:43], v[100:103], v[172:175]
    v_pk_mul_f32 v[24:25], v[148:149], v[28:29]
    v_pk_mul_f32 v[26:27], v[150:151], v[28:29]
    ds_read_b128 v[60:63], v20 offset:9216
    v_mfma_f32_16x16x32_bf16 v[240:243], v[44:47], v[96:99], v[240:243]
    v_exp_f32 v24, v24
    v_exp_f32 v25, v25
    v_mfma_f32_16x16x32_bf16 v[244:247], v[44:47], v[100:103], v[244:247]
    v_exp_f32 v26, v26
    v_exp_f32 v27, v27
    ds_read_b128 v[40:43], v20 offset:10240
    s_waitcnt lgkmcnt(3)
    v_mfma_f32_16x16x32_bf16 v[176:179], v[48:51], v[96:99], v[176:179]
    v_pk_mul_f32 v[148:149], v[148:149], v[220:221]
    v_pk_mul_f32 v[150:151], v[150:151], v[222:223]
    v_mfma_f32_16x16x32_bf16 v[180:183], v[48:51], v[100:103], v[180:183]
    v_pk_add_f32 v[24:25], v[24:25], v[22:23]
    v_pk_add_f32 v[26:27], v[26:27], v[22:23]
    s_waitcnt vmcnt(4)
    s_barrier
    v_add_u32 v21, 61440, v14
    ds_read_b128 v[44:47], v20 offset:11264
    v_mfma_f32_16x16x32_bf16 v[248:251], v[52:55], v[96:99], v[248:251]
    s_add_u32 s55, s58, 14336
    v_mfma_f32_16x16x32_bf16 v[252:255], v[52:55], v[100:103], v[252:255]
    buffer_load_dwordx4 v[80:83], v10, s[20:23], s55 offen offset:0
    ds_read_b128 v[48:51], v20 offset:12288
    s_waitcnt lgkmcnt(3)
    v_mfma_f32_16x16x32_bf16 v[152:155], v[56:59], v[104:107], v[152:155]
    buffer_load_dwordx4 v[88:91], v10, s[20:23], s55 offen offset:1024
    v_mfma_f32_16x16x32_bf16 v[156:159], v[56:59], v[108:111], v[156:159]
    s_add_u32 s55, s58, 32768
    ds_read_b128 v[52:55], v20 offset:13312
    v_mfma_f32_16x16x32_bf16 v[224:227], v[60:63], v[104:107], v[224:227]
    buffer_load_dwordx4 v[84:87], v10, s[20:23], s55 offen offset:0
    v_mfma_f32_16x16x32_bf16 v[228:231], v[60:63], v[108:111], v[228:231]
    buffer_load_dwordx4 v[92:95], v10, s[20:23], s55 offen offset:1024
    ds_read_b128 v[56:59], v20 offset:14336
    s_waitcnt lgkmcnt(3)
    v_mfma_f32_16x16x32_bf16 v[160:163], v[40:43], v[104:107], v[160:163]
    s_add_u32 m0, s53, 20480
    v_mfma_f32_16x16x32_bf16 v[164:167], v[40:43], v[108:111], v[164:167]
    s_add_u32 s56, s50, 315392
    ds_read_b128 v[60:63], v20 offset:15360
    v_mfma_f32_16x16x32_bf16 v[232:235], v[44:47], v[104:107], v[232:235]
    s_add_u32 s57, s56, s53
    v_mfma_f32_16x16x32_bf16 v[236:239], v[44:47], v[108:111], v[236:239]
    buffer_load_dwordx4 v10, s[12:15], s57 offen lds
    ds_read_b128 v[40:43], v21 offset:0
    s_waitcnt lgkmcnt(3)
    v_mfma_f32_16x16x32_bf16 v[168:171], v[48:51], v[104:107], v[168:171]
    s_add_u32 m0, s53, 28672
    v_mfma_f32_16x16x32_bf16 v[172:175], v[48:51], v[108:111], v[172:175]
    s_add_u32 s57, s57, 8192
    ds_read_b128 v[44:47], v21 offset:1024
    v_mfma_f32_16x16x32_bf16 v[240:243], v[52:55], v[104:107], v[240:243]
    buffer_load_dwordx4 v10, s[12:15], s57 offen lds
    v_mfma_f32_16x16x32_bf16 v[244:247], v[52:55], v[108:111], v[244:247]
    v_rcp_f32 v24, v24
    v_rcp_f32 v25, v25
    ds_read_b128 v[48:51], v21 offset:2048
    s_waitcnt lgkmcnt(3)
    v_mfma_f32_16x16x32_bf16 v[176:179], v[56:59], v[104:107], v[176:179]
    v_rcp_f32 v26, v26
    v_rcp_f32 v27, v27
    v_mfma_f32_16x16x32_bf16 v[180:183], v[56:59], v[108:111], v[180:183]
    s_nop 0
    v_pk_mul_f32 v[148:149], v[148:149], v[24:25]
    ds_read_b128 v[52:55], v21 offset:3072
    v_mfma_f32_16x16x32_bf16 v[248:251], v[60:63], v[104:107], v[248:251]
    v_pk_mul_f32 v[150:151], v[150:151], v[26:27]
    v_cvt_pk_bf16_f32 v220, v148, v149
    v_mfma_f32_16x16x32_bf16 v[252:255], v[60:63], v[108:111], v[252:255]
    v_cvt_pk_bf16_f32 v221, v150, v151
    buffer_store_dwordx2 v[220:221], v13, s[24:27], 0 offen offset:2048
    ds_read_b128 v[56:59], v21 offset:4096
    s_waitcnt lgkmcnt(3)
    v_mfma_f32_16x16x32_bf16 v[152:155], v[40:43], v[64:67], v[152:155]
    v_mfma_f32_16x16x32_bf16 v[156:159], v[40:43], v[68:71], v[156:159]
    ds_read_b128 v[60:63], v21 offset:5120
    v_mfma_f32_16x16x32_bf16 v[224:227], v[44:47], v[64:67], v[224:227]
    v_mfma_f32_16x16x32_bf16 v[228:231], v[44:47], v[68:71], v[228:231]
    ds_read_b128 v[40:43], v21 offset:6144
    s_waitcnt lgkmcnt(3)
    v_mfma_f32_16x16x32_bf16 v[160:163], v[48:51], v[64:67], v[160:163]
    v_mfma_f32_16x16x32_bf16 v[164:167], v[48:51], v[68:71], v[164:167]
    ds_read_b128 v[44:47], v21 offset:7168
    v_mfma_f32_16x16x32_bf16 v[232:235], v[52:55], v[64:67], v[232:235]
    v_mfma_f32_16x16x32_bf16 v[236:239], v[52:55], v[68:71], v[236:239]
    ds_read_b128 v[48:51], v21 offset:8192
    s_waitcnt lgkmcnt(3)
    v_mfma_f32_16x16x32_bf16 v[168:171], v[56:59], v[64:67], v[168:171]
    v_mfma_f32_16x16x32_bf16 v[172:175], v[56:59], v[68:71], v[172:175]
    ds_read_b128 v[52:55], v21 offset:9216
    v_mfma_f32_16x16x32_bf16 v[240:243], v[60:63], v[64:67], v[240:243]
    v_mfma_f32_16x16x32_bf16 v[244:247], v[60:63], v[68:71], v[244:247]
    ds_read_b128 v[56:59], v21 offset:10240
    s_waitcnt lgkmcnt(3)
    v_mfma_f32_16x16x32_bf16 v[176:179], v[40:43], v[64:67], v[176:179]
    v_mfma_f32_16x16x32_bf16 v[180:183], v[40:43], v[68:71], v[180:183]
    s_waitcnt vmcnt(3)
    s_barrier
    v_add_u32 v20, 0, v14
    ds_read_b128 v[60:63], v21 offset:11264
    v_mfma_f32_16x16x32_bf16 v[248:251], v[44:47], v[64:67], v[248:251]
    s_add_u32 s55, s58, 16384
    v_mfma_f32_16x16x32_bf16 v[252:255], v[44:47], v[68:71], v[252:255]
    buffer_load_dwordx4 v[96:99], v10, s[20:23], s55 offen offset:0
    ds_read_b128 v[40:43], v21 offset:12288
    s_waitcnt lgkmcnt(3)
    v_mfma_f32_16x16x32_bf16 v[152:155], v[48:51], v[72:75], v[152:155]
    buffer_load_dwordx4 v[104:107], v10, s[20:23], s55 offen offset:1024
    v_mfma_f32_16x16x32_bf16 v[156:159], v[48:51], v[76:79], v[156:159]
    s_add_u32 s55, s58, 34816
    ds_read_b128 v[44:47], v21 offset:13312
    v_mfma_f32_16x16x32_bf16 v[224:227], v[52:55], v[72:75], v[224:227]
    buffer_load_dwordx4 v[100:103], v10, s[20:23], s55 offen offset:0
    v_mfma_f32_16x16x32_bf16 v[228:231], v[52:55], v[76:79], v[228:231]
    buffer_load_dwordx4 v[108:111], v10, s[20:23], s55 offen offset:1024
    ds_read_b128 v[48:51], v21 offset:14336
    s_waitcnt lgkmcnt(3)
    v_mfma_f32_16x16x32_bf16 v[160:163], v[56:59], v[72:75], v[160:163]
    v_mfma_f32_16x16x32_bf16 v[164:167], v[56:59], v[76:79], v[164:167]
    ds_read_b128 v[52:55], v21 offset:15360
    v_mfma_f32_16x16x32_bf16 v[232:235], v[60:63], v[72:75], v[232:235]
    v_mfma_f32_16x16x32_bf16 v[236:239], v[60:63], v[76:79], v[236:239]
    ds_read_b128 v[56:59], v20 offset:0
    s_waitcnt lgkmcnt(3)
    v_mfma_f32_16x16x32_bf16 v[168:171], v[40:43], v[72:75], v[168:171]
    v_mfma_f32_16x16x32_bf16 v[172:175], v[40:43], v[76:79], v[172:175]
    ds_read_b128 v[60:63], v20 offset:1024
    v_mfma_f32_16x16x32_bf16 v[240:243], v[44:47], v[72:75], v[240:243]
    v_mfma_f32_16x16x32_bf16 v[244:247], v[44:47], v[76:79], v[244:247]
    ds_read_b128 v[40:43], v20 offset:2048
    s_waitcnt lgkmcnt(3)
    v_mfma_f32_16x16x32_bf16 v[176:179], v[48:51], v[72:75], v[176:179]
    v_mfma_f32_16x16x32_bf16 v[180:183], v[48:51], v[76:79], v[180:183]
    ds_read_b128 v[44:47], v20 offset:3072
    v_mfma_f32_16x16x32_bf16 v[248:251], v[52:55], v[72:75], v[248:251]
    v_mfma_f32_16x16x32_bf16 v[252:255], v[52:55], v[76:79], v[252:255]
    ds_read_b128 v[48:51], v20 offset:4096
    s_waitcnt lgkmcnt(3)
    v_mfma_f32_16x16x32_bf16 v[152:155], v[56:59], v[80:83], v[152:155]
    v_mfma_f32_16x16x32_bf16 v[156:159], v[56:59], v[84:87], v[156:159]
    ds_read_b128 v[52:55], v20 offset:5120
    v_mfma_f32_16x16x32_bf16 v[224:227], v[60:63], v[80:83], v[224:227]
    v_mfma_f32_16x16x32_bf16 v[228:231], v[60:63], v[84:87], v[228:231]
    ds_read_b128 v[56:59], v20 offset:6144
    s_waitcnt lgkmcnt(3)
    v_mfma_f32_16x16x32_bf16 v[160:163], v[40:43], v[80:83], v[160:163]
    v_mfma_f32_16x16x32_bf16 v[164:167], v[40:43], v[84:87], v[164:167]
    ds_read_b128 v[60:63], v20 offset:7168
    v_mfma_f32_16x16x32_bf16 v[232:235], v[44:47], v[80:83], v[232:235]
    v_mfma_f32_16x16x32_bf16 v[236:239], v[44:47], v[84:87], v[236:239]
    ds_read_b128 v[40:43], v20 offset:8192
    s_waitcnt lgkmcnt(3)
    v_mfma_f32_16x16x32_bf16 v[168:171], v[48:51], v[80:83], v[168:171]
    v_mfma_f32_16x16x32_bf16 v[172:175], v[48:51], v[84:87], v[172:175]
    ds_read_b128 v[44:47], v20 offset:9216
    v_mfma_f32_16x16x32_bf16 v[240:243], v[52:55], v[80:83], v[240:243]
    v_mfma_f32_16x16x32_bf16 v[244:247], v[52:55], v[84:87], v[244:247]
    ds_read_b128 v[48:51], v20 offset:10240
    s_waitcnt lgkmcnt(3)
    v_mfma_f32_16x16x32_bf16 v[176:179], v[56:59], v[80:83], v[176:179]
    v_mfma_f32_16x16x32_bf16 v[180:183], v[56:59], v[84:87], v[180:183]
    s_waitcnt vmcnt(0)
    s_barrier
    v_add_u32 v21, 20480, v14
    ds_read_b128 v[52:55], v20 offset:11264
    v_mfma_f32_16x16x32_bf16 v[248:251], v[60:63], v[80:83], v[248:251]
    v_mfma_f32_16x16x32_bf16 v[252:255], v[60:63], v[84:87], v[252:255]
    ds_read_b128 v[56:59], v20 offset:12288
    s_waitcnt lgkmcnt(3)
    v_mfma_f32_16x16x32_bf16 v[152:155], v[40:43], v[88:91], v[152:155]
    v_mfma_f32_16x16x32_bf16 v[156:159], v[40:43], v[92:95], v[156:159]
    ds_read_b128 v[60:63], v20 offset:13312
    v_mfma_f32_16x16x32_bf16 v[224:227], v[44:47], v[88:91], v[224:227]
    v_mfma_f32_16x16x32_bf16 v[228:231], v[44:47], v[92:95], v[228:231]
    ds_read_b128 v[40:43], v20 offset:14336
    s_waitcnt lgkmcnt(3)
    v_mfma_f32_16x16x32_bf16 v[160:163], v[48:51], v[88:91], v[160:163]
    v_mfma_f32_16x16x32_bf16 v[164:167], v[48:51], v[92:95], v[164:167]
    ds_read_b128 v[44:47], v20 offset:15360
    v_mfma_f32_16x16x32_bf16 v[232:235], v[52:55], v[88:91], v[232:235]
    v_mfma_f32_16x16x32_bf16 v[236:239], v[52:55], v[92:95], v[236:239]
    ds_read_b128 v[48:51], v21 offset:0
    s_waitcnt lgkmcnt(3)
    v_mfma_f32_16x16x32_bf16 v[168:171], v[56:59], v[88:91], v[168:171]
    v_mfma_f32_16x16x32_bf16 v[172:175], v[56:59], v[92:95], v[172:175]
    ds_read_b128 v[52:55], v21 offset:1024
    v_mfma_f32_16x16x32_bf16 v[240:243], v[60:63], v[88:91], v[240:243]
    v_mfma_f32_16x16x32_bf16 v[244:247], v[60:63], v[92:95], v[244:247]
    ds_read_b128 v[56:59], v21 offset:2048
    s_waitcnt lgkmcnt(3)
    v_mfma_f32_16x16x32_bf16 v[176:179], v[40:43], v[88:91], v[176:179]
    v_mfma_f32_16x16x32_bf16 v[180:183], v[40:43], v[92:95], v[180:183]
    ds_read_b128 v[60:63], v21 offset:3072
    v_mfma_f32_16x16x32_bf16 v[248:251], v[44:47], v[88:91], v[248:251]
    v_mfma_f32_16x16x32_bf16 v[252:255], v[44:47], v[92:95], v[252:255]
    ds_read_b128 v[40:43], v21 offset:4096
    s_waitcnt lgkmcnt(3)
    v_mfma_f32_16x16x32_bf16 v[152:155], v[48:51], v[96:99], v[152:155]
    v_mfma_f32_16x16x32_bf16 v[156:159], v[48:51], v[100:103], v[156:159]
    ds_read_b128 v[44:47], v21 offset:5120
    v_mfma_f32_16x16x32_bf16 v[224:227], v[52:55], v[96:99], v[224:227]
    v_mfma_f32_16x16x32_bf16 v[228:231], v[52:55], v[100:103], v[228:231]
    ds_read_b128 v[48:51], v21 offset:6144
    s_waitcnt lgkmcnt(3)
    v_mfma_f32_16x16x32_bf16 v[160:163], v[56:59], v[96:99], v[160:163]
    v_mfma_f32_16x16x32_bf16 v[164:167], v[56:59], v[100:103], v[164:167]
    ds_read_b128 v[52:55], v21 offset:7168
    v_mfma_f32_16x16x32_bf16 v[232:235], v[60:63], v[96:99], v[232:235]
    v_mfma_f32_16x16x32_bf16 v[236:239], v[60:63], v[100:103], v[236:239]
    ds_read_b128 v[56:59], v21 offset:8192
    s_waitcnt lgkmcnt(3)
    v_mfma_f32_16x16x32_bf16 v[168:171], v[40:43], v[96:99], v[168:171]
    v_mfma_f32_16x16x32_bf16 v[172:175], v[40:43], v[100:103], v[172:175]
    ds_read_b128 v[60:63], v21 offset:9216
    v_mfma_f32_16x16x32_bf16 v[240:243], v[44:47], v[96:99], v[240:243]
    v_mfma_f32_16x16x32_bf16 v[244:247], v[44:47], v[100:103], v[244:247]
    ds_read_b128 v[40:43], v21 offset:10240
    s_waitcnt lgkmcnt(3)
    v_mfma_f32_16x16x32_bf16 v[176:179], v[48:51], v[96:99], v[176:179]
    v_mfma_f32_16x16x32_bf16 v[180:183], v[48:51], v[100:103], v[180:183]
    ds_read_b128 v[44:47], v21 offset:11264
    v_mfma_f32_16x16x32_bf16 v[248:251], v[52:55], v[96:99], v[248:251]
    v_mfma_f32_16x16x32_bf16 v[252:255], v[52:55], v[100:103], v[252:255]
    ds_read_b128 v[48:51], v21 offset:12288
    s_waitcnt lgkmcnt(3)
    v_mfma_f32_16x16x32_bf16 v[152:155], v[56:59], v[104:107], v[152:155]
    v_mfma_f32_16x16x32_bf16 v[156:159], v[56:59], v[108:111], v[156:159]
    ds_read_b128 v[52:55], v21 offset:13312
    v_mfma_f32_16x16x32_bf16 v[224:227], v[60:63], v[104:107], v[224:227]
    v_mfma_f32_16x16x32_bf16 v[228:231], v[60:63], v[108:111], v[228:231]
    ds_read_b128 v[56:59], v21 offset:14336
    s_waitcnt lgkmcnt(3)
    v_mfma_f32_16x16x32_bf16 v[160:163], v[40:43], v[104:107], v[160:163]
    v_mfma_f32_16x16x32_bf16 v[164:167], v[40:43], v[108:111], v[164:167]
    ds_read_b128 v[60:63], v21 offset:15360
    v_mfma_f32_16x16x32_bf16 v[232:235], v[44:47], v[104:107], v[232:235]
    v_mfma_f32_16x16x32_bf16 v[236:239], v[44:47], v[108:111], v[236:239]
    s_waitcnt lgkmcnt(2)
    v_mfma_f32_16x16x32_bf16 v[168:171], v[48:51], v[104:107], v[168:171]
    v_mfma_f32_16x16x32_bf16 v[172:175], v[48:51], v[108:111], v[172:175]
    v_mfma_f32_16x16x32_bf16 v[240:243], v[52:55], v[104:107], v[240:243]
    v_mfma_f32_16x16x32_bf16 v[244:247], v[52:55], v[108:111], v[244:247]
    s_waitcnt lgkmcnt(0)
    v_mfma_f32_16x16x32_bf16 v[176:179], v[56:59], v[104:107], v[176:179]
    v_mfma_f32_16x16x32_bf16 v[180:183], v[56:59], v[108:111], v[180:183]
    v_mfma_f32_16x16x32_bf16 v[248:251], v[60:63], v[104:107], v[248:251]
    v_mfma_f32_16x16x32_bf16 v[252:255], v[60:63], v[108:111], v[252:255]
    s_nop 15
    v_pk_mul_f32 v[24:25], v[152:153], v[28:29]
    v_pk_mul_f32 v[26:27], v[154:155], v[28:29]
    v_exp_f32 v24, v24
    v_exp_f32 v25, v25
    v_exp_f32 v26, v26
    v_exp_f32 v27, v27
    v_pk_mul_f32 v[152:153], v[152:153], v[224:225]
    v_pk_mul_f32 v[154:155], v[154:155], v[226:227]
    v_pk_add_f32 v[24:25], v[24:25], v[22:23]
    v_pk_add_f32 v[26:27], v[26:27], v[22:23]
    v_rcp_f32 v24, v24
    v_rcp_f32 v25, v25
    v_rcp_f32 v26, v26
    v_rcp_f32 v27, v27
    s_nop 0
    v_pk_mul_f32 v[152:153], v[152:153], v[24:25]
    v_pk_mul_f32 v[154:155], v[154:155], v[26:27]
    v_cvt_pk_bf16_f32 v224, v152, v153
    v_cvt_pk_bf16_f32 v225, v154, v155
    buffer_store_dwordx2 v[224:225], v12, s[24:27], 0 offen offset:2560
    v_pk_mul_f32 v[24:25], v[160:161], v[28:29]
    v_pk_mul_f32 v[26:27], v[162:163], v[28:29]
    v_exp_f32 v24, v24
    v_exp_f32 v25, v25
    v_exp_f32 v26, v26
    v_exp_f32 v27, v27
    v_pk_mul_f32 v[160:161], v[160:161], v[232:233]
    v_pk_mul_f32 v[162:163], v[162:163], v[234:235]
    v_pk_add_f32 v[24:25], v[24:25], v[22:23]
    v_pk_add_f32 v[26:27], v[26:27], v[22:23]
    v_rcp_f32 v24, v24
    v_rcp_f32 v25, v25
    v_rcp_f32 v26, v26
    v_rcp_f32 v27, v27
    s_nop 0
    v_pk_mul_f32 v[160:161], v[160:161], v[24:25]
    v_pk_mul_f32 v[162:163], v[162:163], v[26:27]
    v_cvt_pk_bf16_f32 v232, v160, v161
    v_cvt_pk_bf16_f32 v233, v162, v163
    buffer_store_dwordx2 v[232:233], v12, s[24:27], 0 offen offset:3072
    v_pk_mul_f32 v[24:25], v[168:169], v[28:29]
    v_pk_mul_f32 v[26:27], v[170:171], v[28:29]
    v_exp_f32 v24, v24
    v_exp_f32 v25, v25
    v_exp_f32 v26, v26
    v_exp_f32 v27, v27
    v_pk_mul_f32 v[168:169], v[168:169], v[240:241]
    v_pk_mul_f32 v[170:171], v[170:171], v[242:243]
    v_pk_add_f32 v[24:25], v[24:25], v[22:23]
    v_pk_add_f32 v[26:27], v[26:27], v[22:23]
    v_rcp_f32 v24, v24
    v_rcp_f32 v25, v25
    v_rcp_f32 v26, v26
    v_rcp_f32 v27, v27
    s_nop 0
    v_pk_mul_f32 v[168:169], v[168:169], v[24:25]
    v_pk_mul_f32 v[170:171], v[170:171], v[26:27]
    v_cvt_pk_bf16_f32 v240, v168, v169
    v_cvt_pk_bf16_f32 v241, v170, v171
    buffer_store_dwordx2 v[240:241], v12, s[24:27], 0 offen offset:3584
    v_pk_mul_f32 v[24:25], v[176:177], v[28:29]
    v_pk_mul_f32 v[26:27], v[178:179], v[28:29]
    v_exp_f32 v24, v24
    v_exp_f32 v25, v25
    v_exp_f32 v26, v26
    v_exp_f32 v27, v27
    v_pk_mul_f32 v[176:177], v[176:177], v[248:249]
    v_pk_mul_f32 v[178:179], v[178:179], v[250:251]
    v_pk_add_f32 v[24:25], v[24:25], v[22:23]
    v_pk_add_f32 v[26:27], v[26:27], v[22:23]
    v_rcp_f32 v24, v24
    v_rcp_f32 v25, v25
    v_rcp_f32 v26, v26
    v_rcp_f32 v27, v27
    s_nop 0
    v_pk_mul_f32 v[176:177], v[176:177], v[24:25]
    v_pk_mul_f32 v[178:179], v[178:179], v[26:27]
    v_cvt_pk_bf16_f32 v248, v176, v177
    v_cvt_pk_bf16_f32 v249, v178, v179
    buffer_store_dwordx2 v[248:249], v12, s[24:27], s61 offen
    v_pk_mul_f32 v[24:25], v[156:157], v[28:29]
    v_pk_mul_f32 v[26:27], v[158:159], v[28:29]
    v_exp_f32 v24, v24
    v_exp_f32 v25, v25
    v_exp_f32 v26, v26
    v_exp_f32 v27, v27
    v_pk_mul_f32 v[156:157], v[156:157], v[228:229]
    v_pk_mul_f32 v[158:159], v[158:159], v[230:231]
    v_pk_add_f32 v[24:25], v[24:25], v[22:23]
    v_pk_add_f32 v[26:27], v[26:27], v[22:23]
    v_rcp_f32 v24, v24
    v_rcp_f32 v25, v25
    v_rcp_f32 v26, v26
    v_rcp_f32 v27, v27
    s_nop 0
    v_pk_mul_f32 v[156:157], v[156:157], v[24:25]
    v_pk_mul_f32 v[158:159], v[158:159], v[26:27]
    v_cvt_pk_bf16_f32 v228, v156, v157
    v_cvt_pk_bf16_f32 v229, v158, v159
    buffer_store_dwordx2 v[228:229], v13, s[24:27], 0 offen offset:2560
    v_pk_mul_f32 v[24:25], v[164:165], v[28:29]
    v_pk_mul_f32 v[26:27], v[166:167], v[28:29]
    v_exp_f32 v24, v24
    v_exp_f32 v25, v25
    v_exp_f32 v26, v26
    v_exp_f32 v27, v27
    v_pk_mul_f32 v[164:165], v[164:165], v[236:237]
    v_pk_mul_f32 v[166:167], v[166:167], v[238:239]
    v_pk_add_f32 v[24:25], v[24:25], v[22:23]
    v_pk_add_f32 v[26:27], v[26:27], v[22:23]
    v_rcp_f32 v24, v24
    v_rcp_f32 v25, v25
    v_rcp_f32 v26, v26
    v_rcp_f32 v27, v27
    s_nop 0
    v_pk_mul_f32 v[164:165], v[164:165], v[24:25]
    v_pk_mul_f32 v[166:167], v[166:167], v[26:27]
    v_cvt_pk_bf16_f32 v236, v164, v165
    v_cvt_pk_bf16_f32 v237, v166, v167
    buffer_store_dwordx2 v[236:237], v13, s[24:27], 0 offen offset:3072
    v_pk_mul_f32 v[24:25], v[172:173], v[28:29]
    v_pk_mul_f32 v[26:27], v[174:175], v[28:29]
    v_exp_f32 v24, v24
    v_exp_f32 v25, v25
    v_exp_f32 v26, v26
    v_exp_f32 v27, v27
    v_pk_mul_f32 v[172:173], v[172:173], v[244:245]
    v_pk_mul_f32 v[174:175], v[174:175], v[246:247]
    v_pk_add_f32 v[24:25], v[24:25], v[22:23]
    v_pk_add_f32 v[26:27], v[26:27], v[22:23]
    v_rcp_f32 v24, v24
    v_rcp_f32 v25, v25
    v_rcp_f32 v26, v26
    v_rcp_f32 v27, v27
    s_nop 0
    v_pk_mul_f32 v[172:173], v[172:173], v[24:25]
    v_pk_mul_f32 v[174:175], v[174:175], v[26:27]
    v_cvt_pk_bf16_f32 v244, v172, v173
    v_cvt_pk_bf16_f32 v245, v174, v175
    buffer_store_dwordx2 v[244:245], v13, s[24:27], 0 offen offset:3584
    v_pk_mul_f32 v[24:25], v[180:181], v[28:29]
    v_pk_mul_f32 v[26:27], v[182:183], v[28:29]
    v_exp_f32 v24, v24
    v_exp_f32 v25, v25
    v_exp_f32 v26, v26
    v_exp_f32 v27, v27
    v_pk_mul_f32 v[180:181], v[180:181], v[252:253]
    v_pk_mul_f32 v[182:183], v[182:183], v[254:255]
    v_pk_add_f32 v[24:25], v[24:25], v[22:23]
    v_pk_add_f32 v[26:27], v[26:27], v[22:23]
    v_rcp_f32 v24, v24
    v_rcp_f32 v25, v25
    v_rcp_f32 v26, v26
    v_rcp_f32 v27, v27
    s_nop 0
    v_pk_mul_f32 v[180:181], v[180:181], v[24:25]
    v_pk_mul_f32 v[182:183], v[182:183], v[26:27]
    v_cvt_pk_bf16_f32 v252, v180, v181
    v_cvt_pk_bf16_f32 v253, v182, v183
    buffer_store_dwordx2 v[252:253], v13, s[24:27], s61 offen
    s_waitcnt vmcnt(0)
gemm1_kernel_done:
    s_endpgm
.globl gemm2_kernel
.p2align 8
.type gemm2_kernel,@function
gemm2_kernel:
    s_cmp_ge_u32 s2, 256
    s_cbranch_scc1 gemm2_kernel_done
    s_load_dwordx2 s[8:9], s[0:1], 96
    s_and_b32 s3, s2, 7
    s_lshr_b32 s44, s2, 3
    s_and_b32 s46, s44, 3
    s_bfe_u32 s49, s44, 0x20002
    s_lshr_b32 s44, s44, 4
    s_lshl_b32 s3, s3, 1
    s_add_u32 s45, s3, s44
    v_lshrrev_b32 v1, 6, v0
    v_and_b32 v2, 63, v0
    v_readfirstlane_b32 s42, v1
    v_lshlrev_b32 v10, 4, v2
    v_and_b32 v3, 15, v2
    v_lshrrev_b32 v4, 4, v2
    s_waitcnt lgkmcnt(0)
    s_add_u32 s12, s8, 0x6000000
    s_addc_u32 s13, s9, 0
    s_mov_b32 s14, 0x510000
    s_mov_b32 s15, 0x00020000
    s_add_u32 s20, s8, 0x1000000
    s_addc_u32 s21, s9, 0
    s_mov_b32 s22, 0x1200000
    s_mov_b32 s23, 0x00020000
    s_add_u32 s24, s8, 0x3000000
    s_addc_u32 s25, s9, 0
    s_mov_b32 s26, 0x1200000
    s_mov_b32 s27, 0x00020000
    s_lshl_b32 s50, s46, 2
    s_add_u32 s50, s50, s49
    s_mul_i32 s50, s50, 331776
    s_lshr_b32 s43, s42, 1
    s_lshl_b32 s48, s45, 3
    s_and_b32 s3, s42, 1
    s_lshl_b32 s3, s3, 2
    s_add_u32 s48, s48, s3
    s_mul_i32 s58, s48, 144
    s_mul_i32 s3, s49, 36
    s_add_u32 s58, s58, s3
    s_mul_i32 s3, s43, 9
    s_add_u32 s58, s58, s3
    s_lshl_b32 s58, s58, 10
    s_mul_i32 s59, s48, 36
    s_mul_i32 s3, s46, 9
    s_add_u32 s59, s59, s3
    s_lshl_b32 s59, s59, 10
    s_mul_i32 s3, s49, 4718592
    s_add_u32 s59, s59, s3
    s_mul_i32 s3, s43, 9216
    v_add_u32 v14, s3, v10
    s_lshl_b32 s53, s42, 12
    s_and_b32 s54, s42, 3
    s_lshl_b32 s54, s54, 10
    s_add_u32 s54, s54, 32768
    v_mov_b32 v112, 0
    v_mov_b32 v113, 0
    v_mov_b32 v114, 0
    v_mov_b32 v115, 0
    v_mov_b32 v116, 0
    v_mov_b32 v117, 0
    v_mov_b32 v118, 0
    v_mov_b32 v119, 0
    v_mov_b32 v120, 0
    v_mov_b32 v121, 0
    v_mov_b32 v122, 0
    v_mov_b32 v123, 0
    v_mov_b32 v124, 0
    v_mov_b32 v125, 0
    v_mov_b32 v126, 0
    v_mov_b32 v127, 0
    v_mov_b32 v128, 0
    v_mov_b32 v129, 0
    v_mov_b32 v130, 0
    v_mov_b32 v131, 0
    v_mov_b32 v132, 0
    v_mov_b32 v133, 0
    v_mov_b32 v134, 0
    v_mov_b32 v135, 0
    v_mov_b32 v136, 0
    v_mov_b32 v137, 0
    v_mov_b32 v138, 0
    v_mov_b32 v139, 0
    v_mov_b32 v140, 0
    v_mov_b32 v141, 0
    v_mov_b32 v142, 0
    v_mov_b32 v143, 0
    v_mov_b32 v144, 0
    v_mov_b32 v145, 0
    v_mov_b32 v146, 0
    v_mov_b32 v147, 0
    v_mov_b32 v148, 0
    v_mov_b32 v149, 0
    v_mov_b32 v150, 0
    v_mov_b32 v151, 0
    v_mov_b32 v152, 0
    v_mov_b32 v153, 0
    v_mov_b32 v154, 0
    v_mov_b32 v155, 0
    v_mov_b32 v156, 0
    v_mov_b32 v157, 0
    v_mov_b32 v158, 0
    v_mov_b32 v159, 0
    v_mov_b32 v160, 0
    v_mov_b32 v161, 0
    v_mov_b32 v162, 0
    v_mov_b32 v163, 0
    v_mov_b32 v164, 0
    v_mov_b32 v165, 0
    v_mov_b32 v166, 0
    v_mov_b32 v167, 0
    v_mov_b32 v168, 0
    v_mov_b32 v169, 0
    v_mov_b32 v170, 0
    v_mov_b32 v171, 0
    v_mov_b32 v172, 0
    v_mov_b32 v173, 0
    v_mov_b32 v174, 0
    v_mov_b32 v175, 0
    v_mov_b32 v176, 0
    v_mov_b32 v177, 0
    v_mov_b32 v178, 0
    v_mov_b32 v179, 0
    v_mov_b32 v180, 0
    v_mov_b32 v181, 0
    v_mov_b32 v182, 0
    v_mov_b32 v183, 0
    v_mov_b32 v184, 0
    v_mov_b32 v185, 0
    v_mov_b32 v186, 0
    v_mov_b32 v187, 0
    v_mov_b32 v188, 0
    v_mov_b32 v189, 0
    v_mov_b32 v190, 0
    v_mov_b32 v191, 0
    v_mov_b32 v192, 0
    v_mov_b32 v193, 0
    v_mov_b32 v194, 0
    v_mov_b32 v195, 0
    v_mov_b32 v196, 0
    v_mov_b32 v197, 0
    v_mov_b32 v198, 0
    v_mov_b32 v199, 0
    v_mov_b32 v200, 0
    v_mov_b32 v201, 0
    v_mov_b32 v202, 0
    v_mov_b32 v203, 0
    v_mov_b32 v204, 0
    v_mov_b32 v205, 0
    v_mov_b32 v206, 0
    v_mov_b32 v207, 0
    v_mov_b32 v208, 0
    v_mov_b32 v209, 0
    v_mov_b32 v210, 0
    v_mov_b32 v211, 0
    v_mov_b32 v212, 0
    v_mov_b32 v213, 0
    v_mov_b32 v214, 0
    v_mov_b32 v215, 0
    v_mov_b32 v216, 0
    v_mov_b32 v217, 0
    v_mov_b32 v218, 0
    v_mov_b32 v219, 0
    v_mov_b32 v220, 0
    v_mov_b32 v221, 0
    v_mov_b32 v222, 0
    v_mov_b32 v223, 0
    v_mov_b32 v224, 0
    v_mov_b32 v225, 0
    v_mov_b32 v226, 0
    v_mov_b32 v227, 0
    v_mov_b32 v228, 0
    v_mov_b32 v229, 0
    v_mov_b32 v230, 0
    v_mov_b32 v231, 0
    v_mov_b32 v232, 0
    v_mov_b32 v233, 0
    v_mov_b32 v234, 0
    v_mov_b32 v235, 0
    v_mov_b32 v236, 0
    v_mov_b32 v237, 0
    v_mov_b32 v238, 0
    v_mov_b32 v239, 0
    v_mov_b32 v240, 0
    v_mov_b32 v241, 0
    v_mov_b32 v242, 0
    v_mov_b32 v243, 0
    v_mov_b32 v244, 0
    v_mov_b32 v245, 0
    v_mov_b32 v246, 0
    v_mov_b32 v247, 0
    v_mov_b32 v248, 0
    v_mov_b32 v249, 0
    v_mov_b32 v250, 0
    v_mov_b32 v251, 0
    v_mov_b32 v252, 0
    v_mov_b32 v253, 0
    v_mov_b32 v254, 0
    v_mov_b32 v255, 0
    s_add_u32 s55, s58, 0
    buffer_load_dwordx4 v[64:67], v10, s[20:23], s55 offen
    s_add_u32 s55, s58, 147456
    buffer_load_dwordx4 v[68:71], v10, s[20:23], s55 offen
    s_add_u32 s55, s58, 294912
    buffer_load_dwordx4 v[72:75], v10, s[20:23], s55 offen
    s_add_u32 s55, s58, 442368
    buffer_load_dwordx4 v[76:79], v10, s[20:23], s55 offen
    s_add_u32 m0, s53, 0
    s_add_u32 s56, s50, 0
    s_add_u32 s57, s56, s53
    buffer_load_dwordx4 v10, s[12:15], s57 offen offset:0 lds
    buffer_load_dwordx4 v10, s[12:15], s57 offen offset:1024 lds
    buffer_load_dwordx4 v10, s[12:15], s57 offen offset:2048 lds
    buffer_load_dwordx4 v10, s[12:15], s57 offen offset:3072 lds
    s_add_u32 m0, s54, 0
    s_add_u32 s57, s56, s54
    buffer_load_dwordx4 v10, s[12:15], s57 offen lds
    s_add_u32 s55, s58, 1024
    buffer_load_dwordx4 v[80:83], v10, s[20:23], s55 offen
    s_add_u32 s55, s58, 148480
    buffer_load_dwordx4 v[84:87], v10, s[20:23], s55 offen
    s_add_u32 s55, s58, 295936
    buffer_load_dwordx4 v[88:91], v10, s[20:23], s55 offen
    s_add_u32 s55, s58, 443392
    buffer_load_dwordx4 v[92:95], v10, s[20:23], s55 offen
    s_add_u32 m0, s53, 36864
    s_add_u32 s56, s50, 36864
    s_add_u32 s57, s56, s53
    buffer_load_dwordx4 v10, s[12:15], s57 offen offset:0 lds
    buffer_load_dwordx4 v10, s[12:15], s57 offen offset:1024 lds
    buffer_load_dwordx4 v10, s[12:15], s57 offen offset:2048 lds
    buffer_load_dwordx4 v10, s[12:15], s57 offen offset:3072 lds
    s_add_u32 m0, s54, 36864
    s_add_u32 s57, s56, s54
    buffer_load_dwordx4 v10, s[12:15], s57 offen lds
    s_add_u32 m0, s53, 73728
    s_add_u32 s56, s50, 73728
    s_add_u32 s57, s56, s53
    buffer_load_dwordx4 v10, s[12:15], s57 offen offset:0 lds
    buffer_load_dwordx4 v10, s[12:15], s57 offen offset:1024 lds
    buffer_load_dwordx4 v10, s[12:15], s57 offen offset:2048 lds
    buffer_load_dwordx4 v10, s[12:15], s57 offen offset:3072 lds
    s_add_u32 m0, s54, 73728
    s_add_u32 s57, s56, s54
    buffer_load_dwordx4 v10, s[12:15], s57 offen lds
    s_waitcnt vmcnt(14)
    s_barrier
    v_add_u32 v20, 0, v14
    ds_read_b128 v[40:43], v20 offset:0
    ds_read_b128 v[44:47], v20 offset:1024
    ds_read_b128 v[48:51], v20 offset:2048
    ds_read_b128 v[52:55], v20 offset:3072
    ds_read_b128 v[56:59], v20 offset:4096
    s_waitcnt lgkmcnt(4)
    v_mfma_f32_16x16x32_bf16 v[112:115], v[40:43], v[64:67], v[112:115]
    v_mfma_f32_16x16x32_bf16 v[116:119], v[40:43], v[68:71], v[116:119]
    v_mfma_f32_16x16x32_bf16 v[120:123], v[40:43], v[72:75], v[120:123]
    v_mfma_f32_16x16x32_bf16 v[124:127], v[40:43], v[76:79], v[124:127]
    ds_read_b128 v[60:63], v20 offset:5120
    s_waitcnt lgkmcnt(4)
    v_mfma_f32_16x16x32_bf16 v[128:131], v[44:47], v[64:67], v[128:131]
    v_mfma_f32_16x16x32_bf16 v[132:135], v[44:47], v[68:71], v[132:135]
    v_mfma_f32_16x16x32_bf16 v[136:139], v[44:47], v[72:75], v[136:139]
    v_mfma_f32_16x16x32_bf16 v[140:143], v[44:47], v[76:79], v[140:143]
    ds_read_b128 v[40:43], v20 offset:6144
    s_waitcnt lgkmcnt(4)
    v_mfma_f32_16x16x32_bf16 v[144:147], v[48:51], v[64:67], v[144:147]
    v_mfma_f32_16x16x32_bf16 v[148:151], v[48:51], v[68:71], v[148:151]
    v_mfma_f32_16x16x32_bf16 v[152:155], v[48:51], v[72:75], v[152:155]
    v_mfma_f32_16x16x32_bf16 v[156:159], v[48:51], v[76:79], v[156:159]
    s_waitcnt vmcnt(5)
    s_barrier
    v_add_u32 v21, 36864, v14
    ds_read_b128 v[44:47], v20 offset:7168
    s_waitcnt lgkmcnt(4)
    v_mfma_f32_16x16x32_bf16 v[160:163], v[52:55], v[64:67], v[160:163]
    s_add_u32 s55, s58, 2048
    v_mfma_f32_16x16x32_bf16 v[164:167], v[52:55], v[68:71], v[164:167]
    buffer_load_dwordx4 v[96:99], v10, s[20:23], s55 offen
    v_mfma_f32_16x16x32_bf16 v[168:171], v[52:55], v[72:75], v[168:171]
    s_add_u32 s55, s58, 149504
    v_mfma_f32_16x16x32_bf16 v[172:175], v[52:55], v[76:79], v[172:175]
    buffer_load_dwordx4 v[100:103], v10, s[20:23], s55 offen
    ds_read_b128 v[48:51], v20 offset:8192
    s_waitcnt lgkmcnt(4)
    v_mfma_f32_16x16x32_bf16 v[176:179], v[56:59], v[64:67], v[176:179]
    s_add_u32 s55, s58, 296960
    v_mfma_f32_16x16x32_bf16 v[180:183], v[56:59], v[68:71], v[180:183]
    buffer_load_dwordx4 v[104:107], v10, s[20:23], s55 offen
    v_mfma_f32_16x16x32_bf16 v[184:187], v[56:59], v[72:75], v[184:187]
    s_add_u32 s55, s58, 444416
    v_mfma_f32_16x16x32_bf16 v[188:191], v[56:59], v[76:79], v[188:191]
    buffer_load_dwordx4 v[108:111], v10, s[20:23], s55 offen
    ds_read_b128 v[52:55], v21 offset:0
    s_waitcnt lgkmcnt(4)
    v_mfma_f32_16x16x32_bf16 v[192:195], v[60:63], v[64:67], v[192:195]
    s_add_u32 m0, s53, 110592
    v_mfma_f32_16x16x32_bf16 v[196:199], v[60:63], v[68:71], v[196:199]
    s_add_u32 s56, s50, 110592
    v_mfma_f32_16x16x32_bf16 v[200:203], v[60:63], v[72:75], v[200:203]
    s_add_u32 s57, s56, s53
    v_mfma_f32_16x16x32_bf16 v[204:207], v[60:63], v[76:79], v[204:207]
    buffer_load_dwordx4 v10, s[12:15], s57 offen offset:0 lds
    ds_read_b128 v[56:59], v21 offset:1024
    s_waitcnt lgkmcnt(4)
    v_mfma_f32_16x16x32_bf16 v[208:211], v[40:43], v[64:67], v[208:211]
    buffer_load_dwordx4 v10, s[12:15], s57 offen offset:1024 lds
    v_mfma_f32_16x16x32_bf16 v[212:215], v[40:43], v[68:71], v[212:215]
    buffer_load_dwordx4 v10, s[12:15], s57 offen offset:2048 lds
    v_mfma_f32_16x16x32_bf16 v[216:219], v[40:43], v[72:75], v[216:219]
    buffer_load_dwordx4 v10, s[12:15], s57 offen offset:3072 lds
    v_mfma_f32_16x16x32_bf16 v[220:223], v[40:43], v[76:79], v[220:223]
    s_add_u32 m0, s54, 110592
    ds_read_b128 v[60:63], v21 offset:2048
    s_waitcnt lgkmcnt(4)
    v_mfma_f32_16x16x32_bf16 v[224:227], v[44:47], v[64:67], v[224:227]
    s_add_u32 s57, s56, s54
    v_mfma_f32_16x16x32_bf16 v[228:231], v[44:47], v[68:71], v[228:231]
    buffer_load_dwordx4 v10, s[12:15], s57 offen lds
    v_mfma_f32_16x16x32_bf16 v[232:235], v[44:47], v[72:75], v[232:235]
    v_mfma_f32_16x16x32_bf16 v[236:239], v[44:47], v[76:79], v[236:239]
    ds_read_b128 v[40:43], v21 offset:3072
    s_waitcnt lgkmcnt(4)
    v_mfma_f32_16x16x32_bf16 v[240:243], v[48:51], v[64:67], v[240:243]
    v_mfma_f32_16x16x32_bf16 v[244:247], v[48:51], v[68:71], v[244:247]
    v_mfma_f32_16x16x32_bf16 v[248:251], v[48:51], v[72:75], v[248:251]
    v_mfma_f32_16x16x32_bf16 v[252:255], v[48:51], v[76:79], v[252:255]
    ds_read_b128 v[44:47], v21 offset:4096
    s_waitcnt lgkmcnt(4)
    v_mfma_f32_16x16x32_bf16 v[112:115], v[52:55], v[80:83], v[112:115]
    v_mfma_f32_16x16x32_bf16 v[116:119], v[52:55], v[84:87], v[116:119]
    v_mfma_f32_16x16x32_bf16 v[120:123], v[52:55], v[88:91], v[120:123]
    v_mfma_f32_16x16x32_bf16 v[124:127], v[52:55], v[92:95], v[124:127]
    ds_read_b128 v[48:51], v21 offset:5120
    s_waitcnt lgkmcnt(4)
    v_mfma_f32_16x16x32_bf16 v[128:131], v[56:59], v[80:83], v[128:131]
    v_mfma_f32_16x16x32_bf16 v[132:135], v[56:59], v[84:87], v[132:135]
    v_mfma_f32_16x16x32_bf16 v[136:139], v[56:59], v[88:91], v[136:139]
    v_mfma_f32_16x16x32_bf16 v[140:143], v[56:59], v[92:95], v[140:143]
    ds_read_b128 v[52:55], v21 offset:6144
    s_waitcnt lgkmcnt(4)
    v_mfma_f32_16x16x32_bf16 v[144:147], v[60:63], v[80:83], v[144:147]
    v_mfma_f32_16x16x32_bf16 v[148:151], v[60:63], v[84:87], v[148:151]
    v_mfma_f32_16x16x32_bf16 v[152:155], v[60:63], v[88:91], v[152:155]
    v_mfma_f32_16x16x32_bf16 v[156:159], v[60:63], v[92:95], v[156:159]
    s_waitcnt vmcnt(5)
    s_barrier
    v_add_u32 v20, 73728, v14
    ds_read_b128 v[56:59], v21 offset:7168
    s_waitcnt lgkmcnt(4)
    v_mfma_f32_16x16x32_bf16 v[160:163], v[40:43], v[80:83], v[160:163]
    s_add_u32 s55, s58, 3072
    v_mfma_f32_16x16x32_bf16 v[164:167], v[40:43], v[84:87], v[164:167]
    buffer_load_dwordx4 v[64:67], v10, s[20:23], s55 offen
    v_mfma_f32_16x16x32_bf16 v[168:171], v[40:43], v[88:91], v[168:171]
    s_add_u32 s55, s58, 150528
    v_mfma_f32_16x16x32_bf16 v[172:175], v[40:43], v[92:95], v[172:175]
    buffer_load_dwordx4 v[68:71], v10, s[20:23], s55 offen
    ds_read_b128 v[60:63], v21 offset:8192
    s_waitcnt lgkmcnt(4)
    v_mfma_f32_16x16x32_bf16 v[176:179], v[44:47], v[80:83], v[176:179]
    s_add_u32 s55, s58, 297984
    v_mfma_f32_16x16x32_bf16 v[180:183], v[44:47], v[84:87], v[180:183]
    buffer_load_dwordx4 v[72:75], v10, s[20:23], s55 offen
    v_mfma_f32_16x16x32_bf16 v[184:187], v[44:47], v[88:91], v[184:187]
    s_add_u32 s55, s58, 445440
    v_mfma_f32_16x16x32_bf16 v[188:191], v[44:47], v[92:95], v[188:191]
    buffer_load_dwordx4 v[76:79], v10, s[20:23], s55 offen
    ds_read_b128 v[40:43], v20 offset:0
    s_waitcnt lgkmcnt(4)
    v_mfma_f32_16x16x32_bf16 v[192:195], v[48:51], v[80:83], v[192:195]
    s_add_u32 m0, s53, 0
    v_mfma_f32_16x16x32_bf16 v[196:199], v[48:51], v[84:87], v[196:199]
    s_add_u32 s56, s50, 147456
    v_mfma_f32_16x16x32_bf16 v[200:203], v[48:51], v[88:91], v[200:203]
    s_add_u32 s57, s56, s53
    v_mfma_f32_16x16x32_bf16 v[204:207], v[48:51], v[92:95], v[204:207]
    buffer_load_dwordx4 v10, s[12:15], s57 offen offset:0 lds
    ds_read_b128 v[44:47], v20 offset:1024
    s_waitcnt lgkmcnt(4)
    v_mfma_f32_16x16x32_bf16 v[208:211], v[52:55], v[80:83], v[208:211]
    buffer_load_dwordx4 v10, s[12:15], s57 offen offset:1024 lds
    v_mfma_f32_16x16x32_bf16 v[212:215], v[52:55], v[84:87], v[212:215]
    buffer_load_dwordx4 v10, s[12:15], s57 offen offset:2048 lds
    v_mfma_f32_16x16x32_bf16 v[216:219], v[52:55], v[88:91], v[216:219]
    buffer_load_dwordx4 v10, s[12:15], s57 offen offset:3072 lds
    v_mfma_f32_16x16x32_bf16 v[220:223], v[52:55], v[92:95], v[220:223]
    s_add_u32 m0, s54, 0
    ds_read_b128 v[48:51], v20 offset:2048
    s_waitcnt lgkmcnt(4)
    v_mfma_f32_16x16x32_bf16 v[224:227], v[56:59], v[80:83], v[224:227]
    s_add_u32 s57, s56, s54
    v_mfma_f32_16x16x32_bf16 v[228:231], v[56:59], v[84:87], v[228:231]
    buffer_load_dwordx4 v10, s[12:15], s57 offen lds
    v_mfma_f32_16x16x32_bf16 v[232:235], v[56:59], v[88:91], v[232:235]
    v_mfma_f32_16x16x32_bf16 v[236:239], v[56:59], v[92:95], v[236:239]
    ds_read_b128 v[52:55], v20 offset:3072
    s_waitcnt lgkmcnt(4)
    v_mfma_f32_16x16x32_bf16 v[240:243], v[60:63], v[80:83], v[240:243]
    v_mfma_f32_16x16x32_bf16 v[244:247], v[60:63], v[84:87], v[244:247]
    v_mfma_f32_16x16x32_bf16 v[248:251], v[60:63], v[88:91], v[248:251]
    v_mfma_f32_16x16x32_bf16 v[252:255], v[60:63], v[92:95], v[252:255]
    ds_read_b128 v[56:59], v20 offset:4096
    s_waitcnt lgkmcnt(4)
    v_mfma_f32_16x16x32_bf16 v[112:115], v[40:43], v[96:99], v[112:115]
    v_mfma_f32_16x16x32_bf16 v[116:119], v[40:43], v[100:103], v[116:119]
    v_mfma_f32_16x16x32_bf16 v[120:123], v[40:43], v[104:107], v[120:123]
    v_mfma_f32_16x16x32_bf16 v[124:127], v[40:43], v[108:111], v[124:127]
    ds_read_b128 v[60:63], v20 offset:5120
    s_waitcnt lgkmcnt(4)
    v_mfma_f32_16x16x32_bf16 v[128:131], v[44:47], v[96:99], v[128:131]
    v_mfma_f32_16x16x32_bf16 v[132:135], v[44:47], v[100:103], v[132:135]
    v_mfma_f32_16x16x32_bf16 v[136:139], v[44:47], v[104:107], v[136:139]
    v_mfma_f32_16x16x32_bf16 v[140:143], v[44:47], v[108:111], v[140:143]
    ds_read_b128 v[40:43], v20 offset:6144
    s_waitcnt lgkmcnt(4)
    v_mfma_f32_16x16x32_bf16 v[144:147], v[48:51], v[96:99], v[144:147]
    v_mfma_f32_16x16x32_bf16 v[148:151], v[48:51], v[100:103], v[148:151]
    v_mfma_f32_16x16x32_bf16 v[152:155], v[48:51], v[104:107], v[152:155]
    v_mfma_f32_16x16x32_bf16 v[156:159], v[48:51], v[108:111], v[156:159]
    s_waitcnt vmcnt(5)
    s_barrier
    v_add_u32 v21, 110592, v14
    ds_read_b128 v[44:47], v20 offset:7168
    s_waitcnt lgkmcnt(4)
    v_mfma_f32_16x16x32_bf16 v[160:163], v[52:55], v[96:99], v[160:163]
    s_add_u32 s55, s58, 4096
    v_mfma_f32_16x16x32_bf16 v[164:167], v[52:55], v[100:103], v[164:167]
    buffer_load_dwordx4 v[80:83], v10, s[20:23], s55 offen
    v_mfma_f32_16x16x32_bf16 v[168:171], v[52:55], v[104:107], v[168:171]
    s_add_u32 s55, s58, 151552
    v_mfma_f32_16x16x32_bf16 v[172:175], v[52:55], v[108:111], v[172:175]
    buffer_load_dwordx4 v[84:87], v10, s[20:23], s55 offen
    ds_read_b128 v[48:51], v20 offset:8192
    s_waitcnt lgkmcnt(4)
    v_mfma_f32_16x16x32_bf16 v[176:179], v[56:59], v[96:99], v[176:179]
    s_add_u32 s55, s58, 299008
    v_mfma_f32_16x16x32_bf16 v[180:183], v[56:59], v[100:103], v[180:183]
    buffer_load_dwordx4 v[88:91], v10, s[20:23], s55 offen
    v_mfma_f32_16x16x32_bf16 v[184:187], v[56:59], v[104:107], v[184:187]
    s_add_u32 s55, s58, 446464
    v_mfma_f32_16x16x32_bf16 v[188:191], v[56:59], v[108:111], v[188:191]
    buffer_load_dwordx4 v[92:95], v10, s[20:23], s55 offen
    ds_read_b128 v[52:55], v21 offset:0
    s_waitcnt lgkmcnt(4)
    v_mfma_f32_16x16x32_bf16 v[192:195], v[60:63], v[96:99], v[192:195]
    s_add_u32 m0, s53, 36864
    v_mfma_f32_16x16x32_bf16 v[196:199], v[60:63], v[100:103], v[196:199]
    s_add_u32 s56, s50, 184320
    v_mfma_f32_16x16x32_bf16 v[200:203], v[60:63], v[104:107], v[200:203]
    s_add_u32 s57, s56, s53
    v_mfma_f32_16x16x32_bf16 v[204:207], v[60:63], v[108:111], v[204:207]
    buffer_load_dwordx4 v10, s[12:15], s57 offen offset:0 lds
    ds_read_b128 v[56:59], v21 offset:1024
    s_waitcnt lgkmcnt(4)
    v_mfma_f32_16x16x32_bf16 v[208:211], v[40:43], v[96:99], v[208:211]
    buffer_load_dwordx4 v10, s[12:15], s57 offen offset:1024 lds
    v_mfma_f32_16x16x32_bf16 v[212:215], v[40:43], v[100:103], v[212:215]
    buffer_load_dwordx4 v10, s[12:15], s57 offen offset:2048 lds
    v_mfma_f32_16x16x32_bf16 v[216:219], v[40:43], v[104:107], v[216:219]
    buffer_load_dwordx4 v10, s[12:15], s57 offen offset:3072 lds
    v_mfma_f32_16x16x32_bf16 v[220:223], v[40:43], v[108:111], v[220:223]
    s_add_u32 m0, s54, 36864
    ds_read_b128 v[60:63], v21 offset:2048
    s_waitcnt lgkmcnt(4)
    v_mfma_f32_16x16x32_bf16 v[224:227], v[44:47], v[96:99], v[224:227]
    s_add_u32 s57, s56, s54
    v_mfma_f32_16x16x32_bf16 v[228:231], v[44:47], v[100:103], v[228:231]
    buffer_load_dwordx4 v10, s[12:15], s57 offen lds
    v_mfma_f32_16x16x32_bf16 v[232:235], v[44:47], v[104:107], v[232:235]
    v_mfma_f32_16x16x32_bf16 v[236:239], v[44:47], v[108:111], v[236:239]
    ds_read_b128 v[40:43], v21 offset:3072
    s_waitcnt lgkmcnt(4)
    v_mfma_f32_16x16x32_bf16 v[240:243], v[48:51], v[96:99], v[240:243]
    v_mfma_f32_16x16x32_bf16 v[244:247], v[48:51], v[100:103], v[244:247]
    v_mfma_f32_16x16x32_bf16 v[248:251], v[48:51], v[104:107], v[248:251]
    v_mfma_f32_16x16x32_bf16 v[252:255], v[48:51], v[108:111], v[252:255]
    ds_read_b128 v[44:47], v21 offset:4096
    s_waitcnt lgkmcnt(4)
    v_mfma_f32_16x16x32_bf16 v[112:115], v[52:55], v[64:67], v[112:115]
    v_mfma_f32_16x16x32_bf16 v[116:119], v[52:55], v[68:71], v[116:119]
    v_mfma_f32_16x16x32_bf16 v[120:123], v[52:55], v[72:75], v[120:123]
    v_mfma_f32_16x16x32_bf16 v[124:127], v[52:55], v[76:79], v[124:127]
    ds_read_b128 v[48:51], v21 offset:5120
    s_waitcnt lgkmcnt(4)
    v_mfma_f32_16x16x32_bf16 v[128:131], v[56:59], v[64:67], v[128:131]
    v_mfma_f32_16x16x32_bf16 v[132:135], v[56:59], v[68:71], v[132:135]
    v_mfma_f32_16x16x32_bf16 v[136:139], v[56:59], v[72:75], v[136:139]
    v_mfma_f32_16x16x32_bf16 v[140:143], v[56:59], v[76:79], v[140:143]
    ds_read_b128 v[52:55], v21 offset:6144
    s_waitcnt lgkmcnt(4)
    v_mfma_f32_16x16x32_bf16 v[144:147], v[60:63], v[64:67], v[144:147]
    v_mfma_f32_16x16x32_bf16 v[148:151], v[60:63], v[68:71], v[148:151]
    v_mfma_f32_16x16x32_bf16 v[152:155], v[60:63], v[72:75], v[152:155]
    v_mfma_f32_16x16x32_bf16 v[156:159], v[60:63], v[76:79], v[156:159]
    s_waitcnt vmcnt(5)
    s_barrier
    v_add_u32 v20, 0, v14
    ds_read_b128 v[56:59], v21 offset:7168
    s_waitcnt lgkmcnt(4)
    v_mfma_f32_16x16x32_bf16 v[160:163], v[40:43], v[64:67], v[160:163]
    s_add_u32 s55, s58, 5120
    v_mfma_f32_16x16x32_bf16 v[164:167], v[40:43], v[68:71], v[164:167]
    buffer_load_dwordx4 v[96:99], v10, s[20:23], s55 offen
    v_mfma_f32_16x16x32_bf16 v[168:171], v[40:43], v[72:75], v[168:171]
    s_add_u32 s55, s58, 152576
    v_mfma_f32_16x16x32_bf16 v[172:175], v[40:43], v[76:79], v[172:175]
    buffer_load_dwordx4 v[100:103], v10, s[20:23], s55 offen
    ds_read_b128 v[60:63], v21 offset:8192
    s_waitcnt lgkmcnt(4)
    v_mfma_f32_16x16x32_bf16 v[176:179], v[44:47], v[64:67], v[176:179]
    s_add_u32 s55, s58, 300032
    v_mfma_f32_16x16x32_bf16 v[180:183], v[44:47], v[68:71], v[180:183]
    buffer_load_dwordx4 v[104:107], v10, s[20:23], s55 offen
    v_mfma_f32_16x16x32_bf16 v[184:187], v[44:47], v[72:75], v[184:187]
    s_add_u32 s55, s58, 447488
    v_mfma_f32_16x16x32_bf16 v[188:191], v[44:47], v[76:79], v[188:191]
    buffer_load_dwordx4 v[108:111], v10, s[20:23], s55 offen
    ds_read_b128 v[40:43], v20 offset:0
    s_waitcnt lgkmcnt(4)
    v_mfma_f32_16x16x32_bf16 v[192:195], v[48:51], v[64:67], v[192:195]
    s_add_u32 m0, s53, 73728
    v_mfma_f32_16x16x32_bf16 v[196:199], v[48:51], v[68:71], v[196:199]
    s_add_u32 s56, s50, 221184
    v_mfma_f32_16x16x32_bf16 v[200:203], v[48:51], v[72:75], v[200:203]
    s_add_u32 s57, s56, s53
    v_mfma_f32_16x16x32_bf16 v[204:207], v[48:51], v[76:79], v[204:207]
    buffer_load_dwordx4 v10, s[12:15], s57 offen offset:0 lds
    ds_read_b128 v[44:47], v20 offset:1024
    s_waitcnt lgkmcnt(4)
    v_mfma_f32_16x16x32_bf16 v[208:211], v[52:55], v[64:67], v[208:211]
    buffer_load_dwordx4 v10, s[12:15], s57 offen offset:1024 lds
    v_mfma_f32_16x16x32_bf16 v[212:215], v[52:55], v[68:71], v[212:215]
    buffer_load_dwordx4 v10, s[12:15], s57 offen offset:2048 lds
    v_mfma_f32_16x16x32_bf16 v[216:219], v[52:55], v[72:75], v[216:219]
    buffer_load_dwordx4 v10, s[12:15], s57 offen offset:3072 lds
    v_mfma_f32_16x16x32_bf16 v[220:223], v[52:55], v[76:79], v[220:223]
    s_add_u32 m0, s54, 73728
    ds_read_b128 v[48:51], v20 offset:2048
    s_waitcnt lgkmcnt(4)
    v_mfma_f32_16x16x32_bf16 v[224:227], v[56:59], v[64:67], v[224:227]
    s_add_u32 s57, s56, s54
    v_mfma_f32_16x16x32_bf16 v[228:231], v[56:59], v[68:71], v[228:231]
    buffer_load_dwordx4 v10, s[12:15], s57 offen lds
    v_mfma_f32_16x16x32_bf16 v[232:235], v[56:59], v[72:75], v[232:235]
    v_mfma_f32_16x16x32_bf16 v[236:239], v[56:59], v[76:79], v[236:239]
    ds_read_b128 v[52:55], v20 offset:3072
    s_waitcnt lgkmcnt(4)
    v_mfma_f32_16x16x32_bf16 v[240:243], v[60:63], v[64:67], v[240:243]
    v_mfma_f32_16x16x32_bf16 v[244:247], v[60:63], v[68:71], v[244:247]
    v_mfma_f32_16x16x32_bf16 v[248:251], v[60:63], v[72:75], v[248:251]
    v_mfma_f32_16x16x32_bf16 v[252:255], v[60:63], v[76:79], v[252:255]
    ds_read_b128 v[56:59], v20 offset:4096
    s_waitcnt lgkmcnt(4)
    v_mfma_f32_16x16x32_bf16 v[112:115], v[40:43], v[80:83], v[112:115]
    v_mfma_f32_16x16x32_bf16 v[116:119], v[40:43], v[84:87], v[116:119]
    v_mfma_f32_16x16x32_bf16 v[120:123], v[40:43], v[88:91], v[120:123]
    v_mfma_f32_16x16x32_bf16 v[124:127], v[40:43], v[92:95], v[124:127]
    ds_read_b128 v[60:63], v20 offset:5120
    s_waitcnt lgkmcnt(4)
    v_mfma_f32_16x16x32_bf16 v[128:131], v[44:47], v[80:83], v[128:131]
    v_mfma_f32_16x16x32_bf16 v[132:135], v[44:47], v[84:87], v[132:135]
    v_mfma_f32_16x16x32_bf16 v[136:139], v[44:47], v[88:91], v[136:139]
    v_mfma_f32_16x16x32_bf16 v[140:143], v[44:47], v[92:95], v[140:143]
    ds_read_b128 v[40:43], v20 offset:6144
    s_waitcnt lgkmcnt(4)
    v_mfma_f32_16x16x32_bf16 v[144:147], v[48:51], v[80:83], v[144:147]
    v_mfma_f32_16x16x32_bf16 v[148:151], v[48:51], v[84:87], v[148:151]
    v_mfma_f32_16x16x32_bf16 v[152:155], v[48:51], v[88:91], v[152:155]
    v_mfma_f32_16x16x32_bf16 v[156:159], v[48:51], v[92:95], v[156:159]
    s_waitcnt vmcnt(5)
    s_barrier
    v_add_u32 v21, 36864, v14
    ds_read_b128 v[44:47], v20 offset:7168
    s_waitcnt lgkmcnt(4)
    v_mfma_f32_16x16x32_bf16 v[160:163], v[52:55], v[80:83], v[160:163]
    s_add_u32 s55, s58, 6144
    v_mfma_f32_16x16x32_bf16 v[164:167], v[52:55], v[84:87], v[164:167]
    buffer_load_dwordx4 v[64:67], v10, s[20:23], s55 offen
    v_mfma_f32_16x16x32_bf16 v[168:171], v[52:55], v[88:91], v[168:171]
    s_add_u32 s55, s58, 153600
    v_mfma_f32_16x16x32_bf16 v[172:175], v[52:55], v[92:95], v[172:175]
    buffer_load_dwordx4 v[68:71], v10, s[20:23], s55 offen
    ds_read_b128 v[48:51], v20 offset:8192
    s_waitcnt lgkmcnt(4)
    v_mfma_f32_16x16x32_bf16 v[176:179], v[56:59], v[80:83], v[176:179]
    s_add_u32 s55, s58, 301056
    v_mfma_f32_16x16x32_bf16 v[180:183], v[56:59], v[84:87], v[180:183]
    buffer_load_dwordx4 v[72:75], v10, s[20:23], s55 offen
    v_mfma_f32_16x16x32_bf16 v[184:187], v[56:59], v[88:91], v[184:187]
    s_add_u32 s55, s58, 448512
    v_mfma_f32_16x16x32_bf16 v[188:191], v[56:59], v[92:95], v[188:191]
    buffer_load_dwordx4 v[76:79], v10, s[20:23], s55 offen
    ds_read_b128 v[52:55], v21 offset:0
    s_waitcnt lgkmcnt(4)
    v_mfma_f32_16x16x32_bf16 v[192:195], v[60:63], v[80:83], v[192:195]
    s_add_u32 m0, s53, 110592
    v_mfma_f32_16x16x32_bf16 v[196:199], v[60:63], v[84:87], v[196:199]
    s_add_u32 s56, s50, 258048
    v_mfma_f32_16x16x32_bf16 v[200:203], v[60:63], v[88:91], v[200:203]
    s_add_u32 s57, s56, s53
    v_mfma_f32_16x16x32_bf16 v[204:207], v[60:63], v[92:95], v[204:207]
    buffer_load_dwordx4 v10, s[12:15], s57 offen offset:0 lds
    ds_read_b128 v[56:59], v21 offset:1024
    s_waitcnt lgkmcnt(4)
    v_mfma_f32_16x16x32_bf16 v[208:211], v[40:43], v[80:83], v[208:211]
    buffer_load_dwordx4 v10, s[12:15], s57 offen offset:1024 lds
    v_mfma_f32_16x16x32_bf16 v[212:215], v[40:43], v[84:87], v[212:215]
    buffer_load_dwordx4 v10, s[12:15], s57 offen offset:2048 lds
    v_mfma_f32_16x16x32_bf16 v[216:219], v[40:43], v[88:91], v[216:219]
    buffer_load_dwordx4 v10, s[12:15], s57 offen offset:3072 lds
    v_mfma_f32_16x16x32_bf16 v[220:223], v[40:43], v[92:95], v[220:223]
    s_add_u32 m0, s54, 110592
    ds_read_b128 v[60:63], v21 offset:2048
    s_waitcnt lgkmcnt(4)
    v_mfma_f32_16x16x32_bf16 v[224:227], v[44:47], v[80:83], v[224:227]
    s_add_u32 s57, s56, s54
    v_mfma_f32_16x16x32_bf16 v[228:231], v[44:47], v[84:87], v[228:231]
    buffer_load_dwordx4 v10, s[12:15], s57 offen lds
    v_mfma_f32_16x16x32_bf16 v[232:235], v[44:47], v[88:91], v[232:235]
    v_mfma_f32_16x16x32_bf16 v[236:239], v[44:47], v[92:95], v[236:239]
    ds_read_b128 v[40:43], v21 offset:3072
    s_waitcnt lgkmcnt(4)
    v_mfma_f32_16x16x32_bf16 v[240:243], v[48:51], v[80:83], v[240:243]
    v_mfma_f32_16x16x32_bf16 v[244:247], v[48:51], v[84:87], v[244:247]
    v_mfma_f32_16x16x32_bf16 v[248:251], v[48:51], v[88:91], v[248:251]
    v_mfma_f32_16x16x32_bf16 v[252:255], v[48:51], v[92:95], v[252:255]
    ds_read_b128 v[44:47], v21 offset:4096
    s_waitcnt lgkmcnt(4)
    v_mfma_f32_16x16x32_bf16 v[112:115], v[52:55], v[96:99], v[112:115]
    v_mfma_f32_16x16x32_bf16 v[116:119], v[52:55], v[100:103], v[116:119]
    v_mfma_f32_16x16x32_bf16 v[120:123], v[52:55], v[104:107], v[120:123]
    v_mfma_f32_16x16x32_bf16 v[124:127], v[52:55], v[108:111], v[124:127]
    ds_read_b128 v[48:51], v21 offset:5120
    s_waitcnt lgkmcnt(4)
    v_mfma_f32_16x16x32_bf16 v[128:131], v[56:59], v[96:99], v[128:131]
    v_mfma_f32_16x16x32_bf16 v[132:135], v[56:59], v[100:103], v[132:135]
    v_mfma_f32_16x16x32_bf16 v[136:139], v[56:59], v[104:107], v[136:139]
    v_mfma_f32_16x16x32_bf16 v[140:143], v[56:59], v[108:111], v[140:143]
    ds_read_b128 v[52:55], v21 offset:6144
    s_waitcnt lgkmcnt(4)
    v_mfma_f32_16x16x32_bf16 v[144:147], v[60:63], v[96:99], v[144:147]
    v_mfma_f32_16x16x32_bf16 v[148:151], v[60:63], v[100:103], v[148:151]
    v_mfma_f32_16x16x32_bf16 v[152:155], v[60:63], v[104:107], v[152:155]
    v_mfma_f32_16x16x32_bf16 v[156:159], v[60:63], v[108:111], v[156:159]
    s_waitcnt vmcnt(5)
    s_barrier
    v_add_u32 v20, 73728, v14
    ds_read_b128 v[56:59], v21 offset:7168
    s_waitcnt lgkmcnt(4)
    v_mfma_f32_16x16x32_bf16 v[160:163], v[40:43], v[96:99], v[160:163]
    s_add_u32 s55, s58, 7168
    v_mfma_f32_16x16x32_bf16 v[164:167], v[40:43], v[100:103], v[164:167]
    buffer_load_dwordx4 v[80:83], v10, s[20:23], s55 offen
    v_mfma_f32_16x16x32_bf16 v[168:171], v[40:43], v[104:107], v[168:171]
    s_add_u32 s55, s58, 154624
    v_mfma_f32_16x16x32_bf16 v[172:175], v[40:43], v[108:111], v[172:175]
    buffer_load_dwordx4 v[84:87], v10, s[20:23], s55 offen
    ds_read_b128 v[60:63], v21 offset:8192
    s_waitcnt lgkmcnt(4)
    v_mfma_f32_16x16x32_bf16 v[176:179], v[44:47], v[96:99], v[176:179]
    s_add_u32 s55, s58, 302080
    v_mfma_f32_16x16x32_bf16 v[180:183], v[44:47], v[100:103], v[180:183]
    buffer_load_dwordx4 v[88:91], v10, s[20:23], s55 offen
    v_mfma_f32_16x16x32_bf16 v[184:187], v[44:47], v[104:107], v[184:187]
    s_add_u32 s55, s58, 449536
    v_mfma_f32_16x16x32_bf16 v[188:191], v[44:47], v[108:111], v[188:191]
    buffer_load_dwordx4 v[92:95], v10, s[20:23], s55 offen
    ds_read_b128 v[40:43], v20 offset:0
    s_waitcnt lgkmcnt(4)
    v_mfma_f32_16x16x32_bf16 v[192:195], v[48:51], v[96:99], v[192:195]
    s_add_u32 m0, s53, 0
    v_mfma_f32_16x16x32_bf16 v[196:199], v[48:51], v[100:103], v[196:199]
    s_add_u32 s56, s50, 294912
    v_mfma_f32_16x16x32_bf16 v[200:203], v[48:51], v[104:107], v[200:203]
    s_add_u32 s57, s56, s53
    v_mfma_f32_16x16x32_bf16 v[204:207], v[48:51], v[108:111], v[204:207]
    buffer_load_dwordx4 v10, s[12:15], s57 offen offset:0 lds
    ds_read_b128 v[44:47], v20 offset:1024
    s_waitcnt lgkmcnt(4)
    v_mfma_f32_16x16x32_bf16 v[208:211], v[52:55], v[96:99], v[208:211]
    buffer_load_dwordx4 v10, s[12:15], s57 offen offset:1024 lds
    v_mfma_f32_16x16x32_bf16 v[212:215], v[52:55], v[100:103], v[212:215]
    buffer_load_dwordx4 v10, s[12:15], s57 offen offset:2048 lds
    v_mfma_f32_16x16x32_bf16 v[216:219], v[52:55], v[104:107], v[216:219]
    buffer_load_dwordx4 v10, s[12:15], s57 offen offset:3072 lds
    v_mfma_f32_16x16x32_bf16 v[220:223], v[52:55], v[108:111], v[220:223]
    s_add_u32 m0, s54, 0
    ds_read_b128 v[48:51], v20 offset:2048
    s_waitcnt lgkmcnt(4)
    v_mfma_f32_16x16x32_bf16 v[224:227], v[56:59], v[96:99], v[224:227]
    s_add_u32 s57, s56, s54
    v_mfma_f32_16x16x32_bf16 v[228:231], v[56:59], v[100:103], v[228:231]
    buffer_load_dwordx4 v10, s[12:15], s57 offen lds
    v_mfma_f32_16x16x32_bf16 v[232:235], v[56:59], v[104:107], v[232:235]
    v_mfma_f32_16x16x32_bf16 v[236:239], v[56:59], v[108:111], v[236:239]
    ds_read_b128 v[52:55], v20 offset:3072
    s_waitcnt lgkmcnt(4)
    v_mfma_f32_16x16x32_bf16 v[240:243], v[60:63], v[96:99], v[240:243]
    v_mfma_f32_16x16x32_bf16 v[244:247], v[60:63], v[100:103], v[244:247]
    v_mfma_f32_16x16x32_bf16 v[248:251], v[60:63], v[104:107], v[248:251]
    v_mfma_f32_16x16x32_bf16 v[252:255], v[60:63], v[108:111], v[252:255]
    ds_read_b128 v[56:59], v20 offset:4096
    s_waitcnt lgkmcnt(4)
    v_mfma_f32_16x16x32_bf16 v[112:115], v[40:43], v[64:67], v[112:115]
    v_mfma_f32_16x16x32_bf16 v[116:119], v[40:43], v[68:71], v[116:119]
    v_mfma_f32_16x16x32_bf16 v[120:123], v[40:43], v[72:75], v[120:123]
    v_mfma_f32_16x16x32_bf16 v[124:127], v[40:43], v[76:79], v[124:127]
    ds_read_b128 v[60:63], v20 offset:5120
    s_waitcnt lgkmcnt(4)
    v_mfma_f32_16x16x32_bf16 v[128:131], v[44:47], v[64:67], v[128:131]
    v_mfma_f32_16x16x32_bf16 v[132:135], v[44:47], v[68:71], v[132:135]
    v_mfma_f32_16x16x32_bf16 v[136:139], v[44:47], v[72:75], v[136:139]
    v_mfma_f32_16x16x32_bf16 v[140:143], v[44:47], v[76:79], v[140:143]
    ds_read_b128 v[40:43], v20 offset:6144
    s_waitcnt lgkmcnt(4)
    v_mfma_f32_16x16x32_bf16 v[144:147], v[48:51], v[64:67], v[144:147]
    v_mfma_f32_16x16x32_bf16 v[148:151], v[48:51], v[68:71], v[148:151]
    v_mfma_f32_16x16x32_bf16 v[152:155], v[48:51], v[72:75], v[152:155]
    v_mfma_f32_16x16x32_bf16 v[156:159], v[48:51], v[76:79], v[156:159]
    s_waitcnt vmcnt(5)
    s_barrier
    v_add_u32 v21, 110592, v14
    ds_read_b128 v[44:47], v20 offset:7168
    s_waitcnt lgkmcnt(4)
    v_mfma_f32_16x16x32_bf16 v[160:163], v[52:55], v[64:67], v[160:163]
    s_add_u32 s55, s58, 8192
    v_mfma_f32_16x16x32_bf16 v[164:167], v[52:55], v[68:71], v[164:167]
    buffer_load_dwordx4 v[96:99], v10, s[20:23], s55 offen
    v_mfma_f32_16x16x32_bf16 v[168:171], v[52:55], v[72:75], v[168:171]
    s_add_u32 s55, s58, 155648
    v_mfma_f32_16x16x32_bf16 v[172:175], v[52:55], v[76:79], v[172:175]
    buffer_load_dwordx4 v[100:103], v10, s[20:23], s55 offen
    ds_read_b128 v[48:51], v20 offset:8192
    s_waitcnt lgkmcnt(4)
    v_mfma_f32_16x16x32_bf16 v[176:179], v[56:59], v[64:67], v[176:179]
    s_add_u32 s55, s58, 303104
    v_mfma_f32_16x16x32_bf16 v[180:183], v[56:59], v[68:71], v[180:183]
    buffer_load_dwordx4 v[104:107], v10, s[20:23], s55 offen
    v_mfma_f32_16x16x32_bf16 v[184:187], v[56:59], v[72:75], v[184:187]
    s_add_u32 s55, s58, 450560
    v_mfma_f32_16x16x32_bf16 v[188:191], v[56:59], v[76:79], v[188:191]
    buffer_load_dwordx4 v[108:111], v10, s[20:23], s55 offen
    ds_read_b128 v[52:55], v21 offset:0
    s_waitcnt lgkmcnt(4)
    v_mfma_f32_16x16x32_bf16 v[192:195], v[60:63], v[64:67], v[192:195]
    v_mfma_f32_16x16x32_bf16 v[196:199], v[60:63], v[68:71], v[196:199]
    v_mfma_f32_16x16x32_bf16 v[200:203], v[60:63], v[72:75], v[200:203]
    v_mfma_f32_16x16x32_bf16 v[204:207], v[60:63], v[76:79], v[204:207]
    ds_read_b128 v[56:59], v21 offset:1024
    s_waitcnt lgkmcnt(4)
    v_mfma_f32_16x16x32_bf16 v[208:211], v[40:43], v[64:67], v[208:211]
    v_mfma_f32_16x16x32_bf16 v[212:215], v[40:43], v[68:71], v[212:215]
    v_mfma_f32_16x16x32_bf16 v[216:219], v[40:43], v[72:75], v[216:219]
    v_mfma_f32_16x16x32_bf16 v[220:223], v[40:43], v[76:79], v[220:223]
    ds_read_b128 v[60:63], v21 offset:2048
    s_waitcnt lgkmcnt(4)
    v_mfma_f32_16x16x32_bf16 v[224:227], v[44:47], v[64:67], v[224:227]
    v_mfma_f32_16x16x32_bf16 v[228:231], v[44:47], v[68:71], v[228:231]
    v_mfma_f32_16x16x32_bf16 v[232:235], v[44:47], v[72:75], v[232:235]
    v_mfma_f32_16x16x32_bf16 v[236:239], v[44:47], v[76:79], v[236:239]
    ds_read_b128 v[40:43], v21 offset:3072
    s_waitcnt lgkmcnt(4)
    v_mfma_f32_16x16x32_bf16 v[240:243], v[48:51], v[64:67], v[240:243]
    v_mfma_f32_16x16x32_bf16 v[244:247], v[48:51], v[68:71], v[244:247]
    v_mfma_f32_16x16x32_bf16 v[248:251], v[48:51], v[72:75], v[248:251]
    v_mfma_f32_16x16x32_bf16 v[252:255], v[48:51], v[76:79], v[252:255]
    ds_read_b128 v[44:47], v21 offset:4096
    s_waitcnt lgkmcnt(4)
    v_mfma_f32_16x16x32_bf16 v[112:115], v[52:55], v[80:83], v[112:115]
    v_mfma_f32_16x16x32_bf16 v[116:119], v[52:55], v[84:87], v[116:119]
    v_mfma_f32_16x16x32_bf16 v[120:123], v[52:55], v[88:91], v[120:123]
    v_mfma_f32_16x16x32_bf16 v[124:127], v[52:55], v[92:95], v[124:127]
    ds_read_b128 v[48:51], v21 offset:5120
    s_waitcnt lgkmcnt(4)
    v_mfma_f32_16x16x32_bf16 v[128:131], v[56:59], v[80:83], v[128:131]
    v_mfma_f32_16x16x32_bf16 v[132:135], v[56:59], v[84:87], v[132:135]
    v_mfma_f32_16x16x32_bf16 v[136:139], v[56:59], v[88:91], v[136:139]
    v_mfma_f32_16x16x32_bf16 v[140:143], v[56:59], v[92:95], v[140:143]
    ds_read_b128 v[52:55], v21 offset:6144
    s_waitcnt lgkmcnt(4)
    v_mfma_f32_16x16x32_bf16 v[144:147], v[60:63], v[80:83], v[144:147]
    v_mfma_f32_16x16x32_bf16 v[148:151], v[60:63], v[84:87], v[148:151]
    v_mfma_f32_16x16x32_bf16 v[152:155], v[60:63], v[88:91], v[152:155]
    v_mfma_f32_16x16x32_bf16 v[156:159], v[60:63], v[92:95], v[156:159]
    s_waitcnt vmcnt(0)
    s_barrier
    v_add_u32 v20, 0, v14
    ds_read_b128 v[56:59], v21 offset:7168
    s_waitcnt lgkmcnt(4)
    v_mfma_f32_16x16x32_bf16 v[160:163], v[40:43], v[80:83], v[160:163]
    v_mfma_f32_16x16x32_bf16 v[164:167], v[40:43], v[84:87], v[164:167]
    v_mfma_f32_16x16x32_bf16 v[168:171], v[40:43], v[88:91], v[168:171]
    v_mfma_f32_16x16x32_bf16 v[172:175], v[40:43], v[92:95], v[172:175]
    ds_read_b128 v[60:63], v21 offset:8192
    s_waitcnt lgkmcnt(4)
    v_mfma_f32_16x16x32_bf16 v[176:179], v[44:47], v[80:83], v[176:179]
    v_mfma_f32_16x16x32_bf16 v[180:183], v[44:47], v[84:87], v[180:183]
    v_mfma_f32_16x16x32_bf16 v[184:187], v[44:47], v[88:91], v[184:187]
    v_mfma_f32_16x16x32_bf16 v[188:191], v[44:47], v[92:95], v[188:191]
    ds_read_b128 v[40:43], v20 offset:0
    s_waitcnt lgkmcnt(4)
    v_mfma_f32_16x16x32_bf16 v[192:195], v[48:51], v[80:83], v[192:195]
    v_mfma_f32_16x16x32_bf16 v[196:199], v[48:51], v[84:87], v[196:199]
    v_mfma_f32_16x16x32_bf16 v[200:203], v[48:51], v[88:91], v[200:203]
    v_mfma_f32_16x16x32_bf16 v[204:207], v[48:51], v[92:95], v[204:207]
    ds_read_b128 v[44:47], v20 offset:1024
    s_waitcnt lgkmcnt(4)
    v_mfma_f32_16x16x32_bf16 v[208:211], v[52:55], v[80:83], v[208:211]
    v_mfma_f32_16x16x32_bf16 v[212:215], v[52:55], v[84:87], v[212:215]
    v_mfma_f32_16x16x32_bf16 v[216:219], v[52:55], v[88:91], v[216:219]
    v_mfma_f32_16x16x32_bf16 v[220:223], v[52:55], v[92:95], v[220:223]
    ds_read_b128 v[48:51], v20 offset:2048
    s_waitcnt lgkmcnt(4)
    v_mfma_f32_16x16x32_bf16 v[224:227], v[56:59], v[80:83], v[224:227]
    v_mfma_f32_16x16x32_bf16 v[228:231], v[56:59], v[84:87], v[228:231]
    v_mfma_f32_16x16x32_bf16 v[232:235], v[56:59], v[88:91], v[232:235]
    v_mfma_f32_16x16x32_bf16 v[236:239], v[56:59], v[92:95], v[236:239]
    ds_read_b128 v[52:55], v20 offset:3072
    s_waitcnt lgkmcnt(4)
    v_mfma_f32_16x16x32_bf16 v[240:243], v[60:63], v[80:83], v[240:243]
    v_mfma_f32_16x16x32_bf16 v[244:247], v[60:63], v[84:87], v[244:247]
    v_mfma_f32_16x16x32_bf16 v[248:251], v[60:63], v[88:91], v[248:251]
    v_mfma_f32_16x16x32_bf16 v[252:255], v[60:63], v[92:95], v[252:255]
    ds_read_b128 v[56:59], v20 offset:4096
    s_waitcnt lgkmcnt(4)
    v_mfma_f32_16x16x32_bf16 v[112:115], v[40:43], v[96:99], v[112:115]
    v_mfma_f32_16x16x32_bf16 v[116:119], v[40:43], v[100:103], v[116:119]
    v_mfma_f32_16x16x32_bf16 v[120:123], v[40:43], v[104:107], v[120:123]
    v_mfma_f32_16x16x32_bf16 v[124:127], v[40:43], v[108:111], v[124:127]
    ds_read_b128 v[60:63], v20 offset:5120
    s_waitcnt lgkmcnt(4)
    v_mfma_f32_16x16x32_bf16 v[128:131], v[44:47], v[96:99], v[128:131]
    v_mfma_f32_16x16x32_bf16 v[132:135], v[44:47], v[100:103], v[132:135]
    v_mfma_f32_16x16x32_bf16 v[136:139], v[44:47], v[104:107], v[136:139]
    v_mfma_f32_16x16x32_bf16 v[140:143], v[44:47], v[108:111], v[140:143]
    ds_read_b128 v[40:43], v20 offset:6144
    s_waitcnt lgkmcnt(4)
    v_mfma_f32_16x16x32_bf16 v[144:147], v[48:51], v[96:99], v[144:147]
    v_mfma_f32_16x16x32_bf16 v[148:151], v[48:51], v[100:103], v[148:151]
    v_mfma_f32_16x16x32_bf16 v[152:155], v[48:51], v[104:107], v[152:155]
    v_mfma_f32_16x16x32_bf16 v[156:159], v[48:51], v[108:111], v[156:159]
    ds_read_b128 v[44:47], v20 offset:7168
    s_waitcnt lgkmcnt(4)
    v_mfma_f32_16x16x32_bf16 v[160:163], v[52:55], v[96:99], v[160:163]
    v_mfma_f32_16x16x32_bf16 v[164:167], v[52:55], v[100:103], v[164:167]
    v_mfma_f32_16x16x32_bf16 v[168:171], v[52:55], v[104:107], v[168:171]
    v_mfma_f32_16x16x32_bf16 v[172:175], v[52:55], v[108:111], v[172:175]
    ds_read_b128 v[48:51], v20 offset:8192
    s_waitcnt lgkmcnt(4)
    v_mfma_f32_16x16x32_bf16 v[176:179], v[56:59], v[96:99], v[176:179]
    v_mfma_f32_16x16x32_bf16 v[180:183], v[56:59], v[100:103], v[180:183]
    v_mfma_f32_16x16x32_bf16 v[184:187], v[56:59], v[104:107], v[184:187]
    v_mfma_f32_16x16x32_bf16 v[188:191], v[56:59], v[108:111], v[188:191]
    s_waitcnt lgkmcnt(3)
    v_mfma_f32_16x16x32_bf16 v[192:195], v[60:63], v[96:99], v[192:195]
    v_mfma_f32_16x16x32_bf16 v[196:199], v[60:63], v[100:103], v[196:199]
    v_mfma_f32_16x16x32_bf16 v[200:203], v[60:63], v[104:107], v[200:203]
    v_mfma_f32_16x16x32_bf16 v[204:207], v[60:63], v[108:111], v[204:207]
    s_waitcnt lgkmcnt(2)
    v_mfma_f32_16x16x32_bf16 v[208:211], v[40:43], v[96:99], v[208:211]
    v_mfma_f32_16x16x32_bf16 v[212:215], v[40:43], v[100:103], v[212:215]
    v_mfma_f32_16x16x32_bf16 v[216:219], v[40:43], v[104:107], v[216:219]
    v_mfma_f32_16x16x32_bf16 v[220:223], v[40:43], v[108:111], v[220:223]
    s_waitcnt lgkmcnt(1)
    v_mfma_f32_16x16x32_bf16 v[224:227], v[44:47], v[96:99], v[224:227]
    v_mfma_f32_16x16x32_bf16 v[228:231], v[44:47], v[100:103], v[228:231]
    v_mfma_f32_16x16x32_bf16 v[232:235], v[44:47], v[104:107], v[232:235]
    v_mfma_f32_16x16x32_bf16 v[236:239], v[44:47], v[108:111], v[236:239]
    s_waitcnt lgkmcnt(0)
    v_mfma_f32_16x16x32_bf16 v[240:243], v[48:51], v[96:99], v[240:243]
    v_mfma_f32_16x16x32_bf16 v[244:247], v[48:51], v[100:103], v[244:247]
    v_mfma_f32_16x16x32_bf16 v[248:251], v[48:51], v[104:107], v[248:251]
    v_mfma_f32_16x16x32_bf16 v[252:255], v[48:51], v[108:111], v[252:255]
    s_nop 15
    s_barrier
    v_lshlrev_b32 v5, 4, v2
    s_mul_i32 s3, s42, 18432
    v_add_u32 v5, s3, v5
    s_xor_b32 s3, s42, 4
    s_mul_i32 s3, s3, 18432
    v_lshlrev_b32 v6, 4, v2
    v_add_u32 v6, s3, v6
    s_xor_b32 s3, s42, 2
    s_mul_i32 s3, s3, 18432
    v_lshlrev_b32 v7, 4, v2
    v_add_u32 v7, s3, v7
    s_cmp_ge_u32 s42, 4
    s_cbranch_scc1 gemm2_kernel_h1
    ds_write_b128 v5, v[184:187] offset:0
    ds_write_b128 v5, v[188:191] offset:1024
    ds_write_b128 v5, v[192:195] offset:2048
    ds_write_b128 v5, v[196:199] offset:3072
    ds_write_b128 v5, v[200:203] offset:4096
    ds_write_b128 v5, v[204:207] offset:5120
    ds_write_b128 v5, v[208:211] offset:6144
    ds_write_b128 v5, v[212:215] offset:7168
    ds_write_b128 v5, v[216:219] offset:8192
    ds_write_b128 v5, v[220:223] offset:9216
    ds_write_b128 v5, v[224:227] offset:10240
    ds_write_b128 v5, v[228:231] offset:11264
    ds_write_b128 v5, v[232:235] offset:12288
    ds_write_b128 v5, v[236:239] offset:13312
    ds_write_b128 v5, v[240:243] offset:14336
    ds_write_b128 v5, v[244:247] offset:15360
    ds_write_b128 v5, v[248:251] offset:16384
    ds_write_b128 v5, v[252:255] offset:17408
    s_waitcnt lgkmcnt(0)
    s_barrier
    ds_read_b128 v[40:43], v6 offset:0
    ds_read_b128 v[44:47], v6 offset:1024
    ds_read_b128 v[48:51], v6 offset:2048
    ds_read_b128 v[52:55], v6 offset:3072
    ds_read_b128 v[56:59], v6 offset:4096
    ds_read_b128 v[60:63], v6 offset:5120
    s_waitcnt lgkmcnt(0)
    v_add_f32 v112, v112, v40
    v_add_f32 v113, v113, v41
    v_add_f32 v114, v114, v42
    v_add_f32 v115, v115, v43
    v_add_f32 v116, v116, v44
    v_add_f32 v117, v117, v45
    v_add_f32 v118, v118, v46
    v_add_f32 v119, v119, v47
    v_add_f32 v120, v120, v48
    v_add_f32 v121, v121, v49
    v_add_f32 v122, v122, v50
    v_add_f32 v123, v123, v51
    v_add_f32 v124, v124, v52
    v_add_f32 v125, v125, v53
    v_add_f32 v126, v126, v54
    v_add_f32 v127, v127, v55
    v_add_f32 v128, v128, v56
    v_add_f32 v129, v129, v57
    v_add_f32 v130, v130, v58
    v_add_f32 v131, v131, v59
    v_add_f32 v132, v132, v60
    v_add_f32 v133, v133, v61
    v_add_f32 v134, v134, v62
    v_add_f32 v135, v135, v63
    ds_read_b128 v[40:43], v6 offset:6144
    ds_read_b128 v[44:47], v6 offset:7168
    ds_read_b128 v[48:51], v6 offset:8192
    ds_read_b128 v[52:55], v6 offset:9216
    ds_read_b128 v[56:59], v6 offset:10240
    ds_read_b128 v[60:63], v6 offset:11264
    s_waitcnt lgkmcnt(0)
    v_add_f32 v136, v136, v40
    v_add_f32 v137, v137, v41
    v_add_f32 v138, v138, v42
    v_add_f32 v139, v139, v43
    v_add_f32 v140, v140, v44
    v_add_f32 v141, v141, v45
    v_add_f32 v142, v142, v46
    v_add_f32 v143, v143, v47
    v_add_f32 v144, v144, v48
    v_add_f32 v145, v145, v49
    v_add_f32 v146, v146, v50
    v_add_f32 v147, v147, v51
    v_add_f32 v148, v148, v52
    v_add_f32 v149, v149, v53
    v_add_f32 v150, v150, v54
    v_add_f32 v151, v151, v55
    v_add_f32 v152, v152, v56
    v_add_f32 v153, v153, v57
    v_add_f32 v154, v154, v58
    v_add_f32 v155, v155, v59
    v_add_f32 v156, v156, v60
    v_add_f32 v157, v157, v61
    v_add_f32 v158, v158, v62
    v_add_f32 v159, v159, v63
    ds_read_b128 v[40:43], v6 offset:12288
    ds_read_b128 v[44:47], v6 offset:13312
    ds_read_b128 v[48:51], v6 offset:14336
    ds_read_b128 v[52:55], v6 offset:15360
    ds_read_b128 v[56:59], v6 offset:16384
    ds_read_b128 v[60:63], v6 offset:17408
    s_waitcnt lgkmcnt(0)
    v_add_f32 v160, v160, v40
    v_add_f32 v161, v161, v41
    v_add_f32 v162, v162, v42
    v_add_f32 v163, v163, v43
    v_add_f32 v164, v164, v44
    v_add_f32 v165, v165, v45
    v_add_f32 v166, v166, v46
    v_add_f32 v167, v167, v47
    v_add_f32 v168, v168, v48
    v_add_f32 v169, v169, v49
    v_add_f32 v170, v170, v50
    v_add_f32 v171, v171, v51
    v_add_f32 v172, v172, v52
    v_add_f32 v173, v173, v53
    v_add_f32 v174, v174, v54
    v_add_f32 v175, v175, v55
    v_add_f32 v176, v176, v56
    v_add_f32 v177, v177, v57
    v_add_f32 v178, v178, v58
    v_add_f32 v179, v179, v59
    v_add_f32 v180, v180, v60
    v_add_f32 v181, v181, v61
    v_add_f32 v182, v182, v62
    v_add_f32 v183, v183, v63
    s_barrier
    s_bitcmp1_b32 s42, 1
    s_cbranch_scc1 gemm2_kernel_h0l1
    ds_write_b128 v5, v[148:151] offset:0
    ds_write_b128 v5, v[152:155] offset:1024
    ds_write_b128 v5, v[156:159] offset:2048
    ds_write_b128 v5, v[160:163] offset:3072
    ds_write_b128 v5, v[164:167] offset:4096
    ds_write_b128 v5, v[168:171] offset:5120
    ds_write_b128 v5, v[172:175] offset:6144
    ds_write_b128 v5, v[176:179] offset:7168
    ds_write_b128 v5, v[180:183] offset:8192
    s_waitcnt lgkmcnt(0)
    s_barrier
    ds_read_b128 v[40:43], v7 offset:0
    ds_read_b128 v[44:47], v7 offset:1024
    ds_read_b128 v[48:51], v7 offset:2048
    ds_read_b128 v[52:55], v7 offset:3072
    ds_read_b128 v[56:59], v7 offset:4096
    ds_read_b128 v[60:63], v7 offset:5120
    s_waitcnt lgkmcnt(0)
    v_add_f32 v112, v112, v40
    v_add_f32 v113, v113, v41
    v_add_f32 v114, v114, v42
    v_add_f32 v115, v115, v43
    v_add_f32 v116, v116, v44
    v_add_f32 v117, v117, v45
    v_add_f32 v118, v118, v46
    v_add_f32 v119, v119, v47
    v_add_f32 v120, v120, v48
    v_add_f32 v121, v121, v49
    v_add_f32 v122, v122, v50
    v_add_f32 v123, v123, v51
    v_add_f32 v124, v124, v52
    v_add_f32 v125, v125, v53
    v_add_f32 v126, v126, v54
    v_add_f32 v127, v127, v55
    v_add_f32 v128, v128, v56
    v_add_f32 v129, v129, v57
    v_add_f32 v130, v130, v58
    v_add_f32 v131, v131, v59
    v_add_f32 v132, v132, v60
    v_add_f32 v133, v133, v61
    v_add_f32 v134, v134, v62
    v_add_f32 v135, v135, v63
    ds_read_b128 v[40:43], v7 offset:6144
    ds_read_b128 v[44:47], v7 offset:7168
    ds_read_b128 v[48:51], v7 offset:8192
    s_waitcnt lgkmcnt(0)
    v_add_f32 v136, v136, v40
    v_add_f32 v137, v137, v41
    v_add_f32 v138, v138, v42
    v_add_f32 v139, v139, v43
    v_add_f32 v140, v140, v44
    v_add_f32 v141, v141, v45
    v_add_f32 v142, v142, v46
    v_add_f32 v143, v143, v47
    v_add_f32 v144, v144, v48
    v_add_f32 v145, v145, v49
    v_add_f32 v146, v146, v50
    v_add_f32 v147, v147, v51
    s_add_u32 s61, s59, 0
    buffer_store_dwordx4 v[112:115], v10, s[24:27], s61 offen
    s_add_u32 s61, s59, 36864
    buffer_store_dwordx4 v[116:119], v10, s[24:27], s61 offen
    s_add_u32 s61, s59, 73728
    buffer_store_dwordx4 v[120:123], v10, s[24:27], s61 offen
    s_add_u32 s61, s59, 110592
    buffer_store_dwordx4 v[124:127], v10, s[24:27], s61 offen
    s_add_u32 s61, s59, 1024
    buffer_store_dwordx4 v[128:131], v10, s[24:27], s61 offen
    s_add_u32 s61, s59, 37888
    buffer_store_dwordx4 v[132:135], v10, s[24:27], s61 offen
    s_add_u32 s61, s59, 74752
    buffer_store_dwordx4 v[136:139], v10, s[24:27], s61 offen
    s_add_u32 s61, s59, 111616
    buffer_store_dwordx4 v[140:143], v10, s[24:27], s61 offen
    s_add_u32 s61, s59, 2048
    buffer_store_dwordx4 v[144:147], v10, s[24:27], s61 offen
    s_waitcnt vmcnt(0)
    s_endpgm
gemm2_kernel_h0l1:
    ds_write_b128 v5, v[112:115] offset:0
    ds_write_b128 v5, v[116:119] offset:1024
    ds_write_b128 v5, v[120:123] offset:2048
    ds_write_b128 v5, v[124:127] offset:3072
    ds_write_b128 v5, v[128:131] offset:4096
    ds_write_b128 v5, v[132:135] offset:5120
    ds_write_b128 v5, v[136:139] offset:6144
    ds_write_b128 v5, v[140:143] offset:7168
    ds_write_b128 v5, v[144:147] offset:8192
    s_waitcnt lgkmcnt(0)
    s_barrier
    ds_read_b128 v[40:43], v7 offset:0
    ds_read_b128 v[44:47], v7 offset:1024
    ds_read_b128 v[48:51], v7 offset:2048
    ds_read_b128 v[52:55], v7 offset:3072
    ds_read_b128 v[56:59], v7 offset:4096
    ds_read_b128 v[60:63], v7 offset:5120
    s_waitcnt lgkmcnt(0)
    v_add_f32 v148, v148, v40
    v_add_f32 v149, v149, v41
    v_add_f32 v150, v150, v42
    v_add_f32 v151, v151, v43
    v_add_f32 v152, v152, v44
    v_add_f32 v153, v153, v45
    v_add_f32 v154, v154, v46
    v_add_f32 v155, v155, v47
    v_add_f32 v156, v156, v48
    v_add_f32 v157, v157, v49
    v_add_f32 v158, v158, v50
    v_add_f32 v159, v159, v51
    v_add_f32 v160, v160, v52
    v_add_f32 v161, v161, v53
    v_add_f32 v162, v162, v54
    v_add_f32 v163, v163, v55
    v_add_f32 v164, v164, v56
    v_add_f32 v165, v165, v57
    v_add_f32 v166, v166, v58
    v_add_f32 v167, v167, v59
    v_add_f32 v168, v168, v60
    v_add_f32 v169, v169, v61
    v_add_f32 v170, v170, v62
    v_add_f32 v171, v171, v63
    ds_read_b128 v[40:43], v7 offset:6144
    ds_read_b128 v[44:47], v7 offset:7168
    ds_read_b128 v[48:51], v7 offset:8192
    s_waitcnt lgkmcnt(0)
    v_add_f32 v172, v172, v40
    v_add_f32 v173, v173, v41
    v_add_f32 v174, v174, v42
    v_add_f32 v175, v175, v43
    v_add_f32 v176, v176, v44
    v_add_f32 v177, v177, v45
    v_add_f32 v178, v178, v46
    v_add_f32 v179, v179, v47
    v_add_f32 v180, v180, v48
    v_add_f32 v181, v181, v49
    v_add_f32 v182, v182, v50
    v_add_f32 v183, v183, v51
    s_add_u32 s61, s59, 38912
    buffer_store_dwordx4 v[148:151], v10, s[24:27], s61 offen
    s_add_u32 s61, s59, 75776
    buffer_store_dwordx4 v[152:155], v10, s[24:27], s61 offen
    s_add_u32 s61, s59, 112640
    buffer_store_dwordx4 v[156:159], v10, s[24:27], s61 offen
    s_add_u32 s61, s59, 3072
    buffer_store_dwordx4 v[160:163], v10, s[24:27], s61 offen
    s_add_u32 s61, s59, 39936
    buffer_store_dwordx4 v[164:167], v10, s[24:27], s61 offen
    s_add_u32 s61, s59, 76800
    buffer_store_dwordx4 v[168:171], v10, s[24:27], s61 offen
    s_add_u32 s61, s59, 113664
    buffer_store_dwordx4 v[172:175], v10, s[24:27], s61 offen
    s_add_u32 s61, s59, 4096
    buffer_store_dwordx4 v[176:179], v10, s[24:27], s61 offen
    s_add_u32 s61, s59, 40960
    buffer_store_dwordx4 v[180:183], v10, s[24:27], s61 offen
    s_waitcnt vmcnt(0)
    s_endpgm
gemm2_kernel_h1:
    ds_write_b128 v5, v[112:115] offset:0
    ds_write_b128 v5, v[116:119] offset:1024
    ds_write_b128 v5, v[120:123] offset:2048
    ds_write_b128 v5, v[124:127] offset:3072
    ds_write_b128 v5, v[128:131] offset:4096
    ds_write_b128 v5, v[132:135] offset:5120
    ds_write_b128 v5, v[136:139] offset:6144
    ds_write_b128 v5, v[140:143] offset:7168
    ds_write_b128 v5, v[144:147] offset:8192
    ds_write_b128 v5, v[148:151] offset:9216
    ds_write_b128 v5, v[152:155] offset:10240
    ds_write_b128 v5, v[156:159] offset:11264
    ds_write_b128 v5, v[160:163] offset:12288
    ds_write_b128 v5, v[164:167] offset:13312
    ds_write_b128 v5, v[168:171] offset:14336
    ds_write_b128 v5, v[172:175] offset:15360
    ds_write_b128 v5, v[176:179] offset:16384
    ds_write_b128 v5, v[180:183] offset:17408
    s_waitcnt lgkmcnt(0)
    s_barrier
    ds_read_b128 v[40:43], v6 offset:0
    ds_read_b128 v[44:47], v6 offset:1024
    ds_read_b128 v[48:51], v6 offset:2048
    ds_read_b128 v[52:55], v6 offset:3072
    ds_read_b128 v[56:59], v6 offset:4096
    ds_read_b128 v[60:63], v6 offset:5120
    s_waitcnt lgkmcnt(0)
    v_add_f32 v184, v184, v40
    v_add_f32 v185, v185, v41
    v_add_f32 v186, v186, v42
    v_add_f32 v187, v187, v43
    v_add_f32 v188, v188, v44
    v_add_f32 v189, v189, v45
    v_add_f32 v190, v190, v46
    v_add_f32 v191, v191, v47
    v_add_f32 v192, v192, v48
    v_add_f32 v193, v193, v49
    v_add_f32 v194, v194, v50
    v_add_f32 v195, v195, v51
    v_add_f32 v196, v196, v52
    v_add_f32 v197, v197, v53
    v_add_f32 v198, v198, v54
    v_add_f32 v199, v199, v55
    v_add_f32 v200, v200, v56
    v_add_f32 v201, v201, v57
    v_add_f32 v202, v202, v58
    v_add_f32 v203, v203, v59
    v_add_f32 v204, v204, v60
    v_add_f32 v205, v205, v61
    v_add_f32 v206, v206, v62
    v_add_f32 v207, v207, v63
    ds_read_b128 v[40:43], v6 offset:6144
    ds_read_b128 v[44:47], v6 offset:7168
    ds_read_b128 v[48:51], v6 offset:8192
    ds_read_b128 v[52:55], v6 offset:9216
    ds_read_b128 v[56:59], v6 offset:10240
    ds_read_b128 v[60:63], v6 offset:11264
    s_waitcnt lgkmcnt(0)
    v_add_f32 v208, v208, v40
    v_add_f32 v209, v209, v41
    v_add_f32 v210, v210, v42
    v_add_f32 v211, v211, v43
    v_add_f32 v212, v212, v44
    v_add_f32 v213, v213, v45
    v_add_f32 v214, v214, v46
    v_add_f32 v215, v215, v47
    v_add_f32 v216, v216, v48
    v_add_f32 v217, v217, v49
    v_add_f32 v218, v218, v50
    v_add_f32 v219, v219, v51
    v_add_f32 v220, v220, v52
    v_add_f32 v221, v221, v53
    v_add_f32 v222, v222, v54
    v_add_f32 v223, v223, v55
    v_add_f32 v224, v224, v56
    v_add_f32 v225, v225, v57
    v_add_f32 v226, v226, v58
    v_add_f32 v227, v227, v59
    v_add_f32 v228, v228, v60
    v_add_f32 v229, v229, v61
    v_add_f32 v230, v230, v62
    v_add_f32 v231, v231, v63
    ds_read_b128 v[40:43], v6 offset:12288
    ds_read_b128 v[44:47], v6 offset:13312
    ds_read_b128 v[48:51], v6 offset:14336
    ds_read_b128 v[52:55], v6 offset:15360
    ds_read_b128 v[56:59], v6 offset:16384
    ds_read_b128 v[60:63], v6 offset:17408
    s_waitcnt lgkmcnt(0)
    v_add_f32 v232, v232, v40
    v_add_f32 v233, v233, v41
    v_add_f32 v234, v234, v42
    v_add_f32 v235, v235, v43
    v_add_f32 v236, v236, v44
    v_add_f32 v237, v237, v45
    v_add_f32 v238, v238, v46
    v_add_f32 v239, v239, v47
    v_add_f32 v240, v240, v48
    v_add_f32 v241, v241, v49
    v_add_f32 v242, v242, v50
    v_add_f32 v243, v243, v51
    v_add_f32 v244, v244, v52
    v_add_f32 v245, v245, v53
    v_add_f32 v246, v246, v54
    v_add_f32 v247, v247, v55
    v_add_f32 v248, v248, v56
    v_add_f32 v249, v249, v57
    v_add_f32 v250, v250, v58
    v_add_f32 v251, v251, v59
    v_add_f32 v252, v252, v60
    v_add_f32 v253, v253, v61
    v_add_f32 v254, v254, v62
    v_add_f32 v255, v255, v63
    s_barrier
    s_bitcmp1_b32 s42, 1
    s_cbranch_scc1 gemm2_kernel_h1l1
    ds_write_b128 v5, v[220:223] offset:0
    ds_write_b128 v5, v[224:227] offset:1024
    ds_write_b128 v5, v[228:231] offset:2048
    ds_write_b128 v5, v[232:235] offset:3072
    ds_write_b128 v5, v[236:239] offset:4096
    ds_write_b128 v5, v[240:243] offset:5120
    ds_write_b128 v5, v[244:247] offset:6144
    ds_write_b128 v5, v[248:251] offset:7168
    ds_write_b128 v5, v[252:255] offset:8192
    s_waitcnt lgkmcnt(0)
    s_barrier
    ds_read_b128 v[40:43], v7 offset:0
    ds_read_b128 v[44:47], v7 offset:1024
    ds_read_b128 v[48:51], v7 offset:2048
    ds_read_b128 v[52:55], v7 offset:3072
    ds_read_b128 v[56:59], v7 offset:4096
    ds_read_b128 v[60:63], v7 offset:5120
    s_waitcnt lgkmcnt(0)
    v_add_f32 v184, v184, v40
    v_add_f32 v185, v185, v41
    v_add_f32 v186, v186, v42
    v_add_f32 v187, v187, v43
    v_add_f32 v188, v188, v44
    v_add_f32 v189, v189, v45
    v_add_f32 v190, v190, v46
    v_add_f32 v191, v191, v47
    v_add_f32 v192, v192, v48
    v_add_f32 v193, v193, v49
    v_add_f32 v194, v194, v50
    v_add_f32 v195, v195, v51
    v_add_f32 v196, v196, v52
    v_add_f32 v197, v197, v53
    v_add_f32 v198, v198, v54
    v_add_f32 v199, v199, v55
    v_add_f32 v200, v200, v56
    v_add_f32 v201, v201, v57
    v_add_f32 v202, v202, v58
    v_add_f32 v203, v203, v59
    v_add_f32 v204, v204, v60
    v_add_f32 v205, v205, v61
    v_add_f32 v206, v206, v62
    v_add_f32 v207, v207, v63
    ds_read_b128 v[40:43], v7 offset:6144
    ds_read_b128 v[44:47], v7 offset:7168
    ds_read_b128 v[48:51], v7 offset:8192
    s_waitcnt lgkmcnt(0)
    v_add_f32 v208, v208, v40
    v_add_f32 v209, v209, v41
    v_add_f32 v210, v210, v42
    v_add_f32 v211, v211, v43
    v_add_f32 v212, v212, v44
    v_add_f32 v213, v213, v45
    v_add_f32 v214, v214, v46
    v_add_f32 v215, v215, v47
    v_add_f32 v216, v216, v48
    v_add_f32 v217, v217, v49
    v_add_f32 v218, v218, v50
    v_add_f32 v219, v219, v51
    s_add_u32 s61, s59, 77824
    buffer_store_dwordx4 v[184:187], v10, s[24:27], s61 offen
    s_add_u32 s61, s59, 114688
    buffer_store_dwordx4 v[188:191], v10, s[24:27], s61 offen
    s_add_u32 s61, s59, 5120
    buffer_store_dwordx4 v[192:195], v10, s[24:27], s61 offen
    s_add_u32 s61, s59, 41984
    buffer_store_dwordx4 v[196:199], v10, s[24:27], s61 offen
    s_add_u32 s61, s59, 78848
    buffer_store_dwordx4 v[200:203], v10, s[24:27], s61 offen
    s_add_u32 s61, s59, 115712
    buffer_store_dwordx4 v[204:207], v10, s[24:27], s61 offen
    s_add_u32 s61, s59, 6144
    buffer_store_dwordx4 v[208:211], v10, s[24:27], s61 offen
    s_add_u32 s61, s59, 43008
    buffer_store_dwordx4 v[212:215], v10, s[24:27], s61 offen
    s_add_u32 s61, s59, 79872
    buffer_store_dwordx4 v[216:219], v10, s[24:27], s61 offen
    s_waitcnt vmcnt(0)
    s_endpgm
gemm2_kernel_h1l1:
    ds_write_b128 v5, v[184:187] offset:0
    ds_write_b128 v5, v[188:191] offset:1024
    ds_write_b128 v5, v[192:195] offset:2048
    ds_write_b128 v5, v[196:199] offset:3072
    ds_write_b128 v5, v[200:203] offset:4096
    ds_write_b128 v5, v[204:207] offset:5120
    ds_write_b128 v5, v[208:211] offset:6144
    ds_write_b128 v5, v[212:215] offset:7168
    ds_write_b128 v5, v[216:219] offset:8192
    s_waitcnt lgkmcnt(0)
    s_barrier
    ds_read_b128 v[40:43], v7 offset:0
    ds_read_b128 v[44:47], v7 offset:1024
    ds_read_b128 v[48:51], v7 offset:2048
    ds_read_b128 v[52:55], v7 offset:3072
    ds_read_b128 v[56:59], v7 offset:4096
    ds_read_b128 v[60:63], v7 offset:5120
    s_waitcnt lgkmcnt(0)
    v_add_f32 v220, v220, v40
    v_add_f32 v221, v221, v41
    v_add_f32 v222, v222, v42
    v_add_f32 v223, v223, v43
    v_add_f32 v224, v224, v44
    v_add_f32 v225, v225, v45
    v_add_f32 v226, v226, v46
    v_add_f32 v227, v227, v47
    v_add_f32 v228, v228, v48
    v_add_f32 v229, v229, v49
    v_add_f32 v230, v230, v50
    v_add_f32 v231, v231, v51
    v_add_f32 v232, v232, v52
    v_add_f32 v233, v233, v53
    v_add_f32 v234, v234, v54
    v_add_f32 v235, v235, v55
    v_add_f32 v236, v236, v56
    v_add_f32 v237, v237, v57
    v_add_f32 v238, v238, v58
    v_add_f32 v239, v239, v59
    v_add_f32 v240, v240, v60
    v_add_f32 v241, v241, v61
    v_add_f32 v242, v242, v62
    v_add_f32 v243, v243, v63
    ds_read_b128 v[40:43], v7 offset:6144
    ds_read_b128 v[44:47], v7 offset:7168
    ds_read_b128 v[48:51], v7 offset:8192
    s_waitcnt lgkmcnt(0)
    v_add_f32 v244, v244, v40
    v_add_f32 v245, v245, v41
    v_add_f32 v246, v246, v42
    v_add_f32 v247, v247, v43
    v_add_f32 v248, v248, v44
    v_add_f32 v249, v249, v45
    v_add_f32 v250, v250, v46
    v_add_f32 v251, v251, v47
    v_add_f32 v252, v252, v48
    v_add_f32 v253, v253, v49
    v_add_f32 v254, v254, v50
    v_add_f32 v255, v255, v51
    s_add_u32 s61, s59, 116736
    buffer_store_dwordx4 v[220:223], v10, s[24:27], s61 offen
    s_add_u32 s61, s59, 7168
    buffer_store_dwordx4 v[224:227], v10, s[24:27], s61 offen
    s_add_u32 s61, s59, 44032
    buffer_store_dwordx4 v[228:231], v10, s[24:27], s61 offen
    s_add_u32 s61, s59, 80896
    buffer_store_dwordx4 v[232:235], v10, s[24:27], s61 offen
    s_add_u32 s61, s59, 117760
    buffer_store_dwordx4 v[236:239], v10, s[24:27], s61 offen
    s_add_u32 s61, s59, 8192
    buffer_store_dwordx4 v[240:243], v10, s[24:27], s61 offen
    s_add_u32 s61, s59, 45056
    buffer_store_dwordx4 v[244:247], v10, s[24:27], s61 offen
    s_add_u32 s61, s59, 81920
    buffer_store_dwordx4 v[248:251], v10, s[24:27], s61 offen
    s_add_u32 s61, s59, 118784
    buffer_store_dwordx4 v[252:255], v10, s[24:27], s61 offen
    s_waitcnt vmcnt(0)
    s_endpgm
gemm2_kernel_done:
    s_endpgm
.section .rodata,"a"
.p2align 6
.amdhsa_kernel conv_kernel
  .amdhsa_next_free_vgpr 168
  .amdhsa_next_free_sgpr 96
  .amdhsa_accum_offset 168
  .amdhsa_group_segment_fixed_size 0
  .amdhsa_kernarg_size 104
  .amdhsa_user_sgpr_count 2
  .amdhsa_user_sgpr_kernarg_segment_ptr 1
  .amdhsa_system_sgpr_workgroup_id_x 1
.end_amdhsa_kernel
.p2align 6
.amdhsa_kernel rowa_kernel
  .amdhsa_next_free_vgpr 160
  .amdhsa_next_free_sgpr 96
  .amdhsa_accum_offset 160
  .amdhsa_group_segment_fixed_size 0
  .amdhsa_kernarg_size 104
  .amdhsa_user_sgpr_count 2
  .amdhsa_user_sgpr_kernarg_segment_ptr 1
  .amdhsa_system_sgpr_workgroup_id_x 1
.end_amdhsa_kernel
.p2align 6
.amdhsa_kernel rowb_kernel
  .amdhsa_next_free_vgpr 232
  .amdhsa_next_free_sgpr 96
  .amdhsa_accum_offset 232
  .amdhsa_group_segment_fixed_size 0
  .amdhsa_kernarg_size 104
  .amdhsa_user_sgpr_count 2
  .amdhsa_user_sgpr_kernarg_segment_ptr 1
  .amdhsa_system_sgpr_workgroup_id_x 1
.end_amdhsa_kernel
.p2align 6
.amdhsa_kernel rowc_kernel
  .amdhsa_next_free_vgpr 232
  .amdhsa_next_free_sgpr 96
  .amdhsa_accum_offset 232
  .amdhsa_group_segment_fixed_size 0
  .amdhsa_kernarg_size 104
  .amdhsa_user_sgpr_count 2
  .amdhsa_user_sgpr_kernarg_segment_ptr 1
  .amdhsa_system_sgpr_workgroup_id_x 1
.end_amdhsa_kernel
.p2align 6
.amdhsa_kernel gemm1_kernel
  .amdhsa_next_free_vgpr 256
  .amdhsa_next_free_sgpr 96
  .amdhsa_accum_offset 256
  .amdhsa_group_segment_fixed_size 0
  .amdhsa_kernarg_size 104
  .amdhsa_user_sgpr_count 2
  .amdhsa_user_sgpr_kernarg_segment_ptr 1
  .amdhsa_system_sgpr_workgroup_id_x 1
.end_amdhsa_kernel
.p2align 6
.amdhsa_kernel gemm2_kernel
  .amdhsa_next_free_vgpr 256
  .amdhsa_next_free_sgpr 96
  .amdhsa_accum_offset 256
  .amdhsa_group_segment_fixed_size 0
  .amdhsa_kernarg_size 104
  .amdhsa_user_sgpr_count 2
  .amdhsa_user_sgpr_kernarg_segment_ptr 1
  .amdhsa_system_sgpr_workgroup_id_x 1
.end_amdhsa_kernel
```
